```python
import torch

def _softmax(x, axis=-1):
    return torch.softmax(x, dim=axis)
def _gelu(x):
    return torch.nn.functional.gelu(x, approximate="tanh")
def _silu(x):
    return torch.nn.functional.silu(x)
def _sigmoid(x):
    return torch.sigmoid(x)
def _layernorm(x, axis=-1, eps=1e-5):
    m = x.mean(dim=axis, keepdim=True)
    v = x.var(dim=axis, keepdim=True, unbiased=False)
    return (x - m) / torch.sqrt(v + eps)
def _scatter_add(tgt, idx, src, axis=0):
    return tgt.clone().index_add_(axis, idx, src)
def _segment_sum(src, seg, n):
    out = torch.zeros((n,) + src.shape[1:], dtype=src.dtype)
    return out.index_add_(0, seg, src)
def _pad(x, pw):
    flat = tuple(v for pair in reversed(pw) for v in pair)
    return torch.nn.functional.pad(x, flat)

kernel_name = 'interleave_layers__linear_kernel_hedgehog__glu_gated_glu__prompt'

def setup_inputs():

    _w = (lambda a: (lambda t: t.to(torch.bfloat16) if t.is_floating_point() else t)(torch.as_tensor(a)))
    def _A_setup():
        B, S, D, H = 1, 2048, 512, 32
        Dh = D // H
        return {
            "x": _w((lambda *s: torch.randn(*s, dtype=torch.bfloat16) * 0.05)(B, S, D)),
            "wqkv": _w((lambda *s: torch.randn(*s, dtype=torch.bfloat16) * 0.4)(D, 3 * D)),
            "w_phi": _w((lambda *s: torch.randn(*s, dtype=torch.bfloat16) * 0.4)(H, Dh, Dh) * (Dh ** -0.5)),
            "wo": _w((lambda *s: torch.randn(*s, dtype=torch.bfloat16) * 0.05)(D, D)),
        }
    _A_in = _A_setup()

    def _B_setup():
        B, S, D, F = 1, 2048, 512, 1792
        return {
            "x": _w((lambda *s: torch.randn(*s, dtype=torch.bfloat16) * 0.05)(B, S, D)),
            "w_gate": _w((lambda *s: torch.randn(*s, dtype=torch.bfloat16) * 0.05)(D, F)),
            "w_up": _w((lambda *s: torch.randn(*s, dtype=torch.bfloat16) * 0.05)(D, F)),
            "w_down": _w((lambda *s: torch.randn(*s, dtype=torch.bfloat16) * 0.05)(F, D)),
        }
    _B_in = _B_setup()

    return {
        "A_x": _A_in["x"],
        "A_wqkv": _A_in["wqkv"],
        "A_w_phi": _A_in["w_phi"],
        "A_wo": _A_in["wo"],
        "B_x": _B_in["x"],
        "B_w_gate": _B_in["w_gate"],
        "B_w_up": _B_in["w_up"],
        "B_w_down": _B_in["w_down"],
    }

def reference(A_x, A_wqkv, A_w_phi, A_wo, B_x, B_w_gate, B_w_up, B_w_down):
    def _A_ref(x, wqkv, w_phi, wo):
        B, S, D = x.shape
        H = 32; Dh = D // H
        qkv = (lambda x, *d: x.permute(*d))((x @ wqkv).reshape(B, S, 3, H, Dh), 2, 0, 3, 1, 4)
        q, k, v = qkv[0], qkv[1], qkv[2]
        pq = torch.einsum("bhsd,hdf->bhsf", q, w_phi)
        pk = torch.einsum("bhsd,hdf->bhsf", k, w_phi)
        phi_q = torch.concatenate([_softmax(pq, axis=-1), _softmax(-pq, axis=-1)], axis=-1)
        phi_k = torch.concatenate([_softmax(pk, axis=-1), _softmax(-pk, axis=-1)], axis=-1)
        kv = torch.einsum("bhsf,bhsd->bhfd", phi_k, v)
        z  = torch.einsum("bhsf->bhf", phi_k)
        num = torch.einsum("bhqf,bhfd->bhqd", phi_q, kv)
        den = torch.einsum("bhqf,bhf->bhq", phi_q, z)[..., None] + 1e-6
        o = num / den
        return (lambda x, *d: x.permute(*d))(o, 0, 2, 1, 3).reshape(B, S, D) @ wo

    def _B_ref(x, w_gate, w_up, w_down):
        g = torch.einsum("bsd,df->bsf", x, w_gate)
        u = torch.einsum("bsd,df->bsf", x, w_up)
        h = _sigmoid(g) * u
        return torch.einsum("bsf,fd->bsd", h, w_down)

    x = A_x
    x = x + _A_ref(_layernorm(x, axis=-1), A_wqkv, A_w_phi, A_wo)
    x = x + _B_ref(_layernorm(x, axis=-1), B_w_gate, B_w_up, B_w_down)
    x = x + _A_ref(_layernorm(x, axis=-1), A_wqkv, A_w_phi, A_wo)
    x = x + _B_ref(_layernorm(x, axis=-1), B_w_gate, B_w_up, B_w_down)
    return x
```

```asm
; @launch grid=(256,1,1) block=(256,1,1) lds=163840
.amdgcn_target "amdgcn-amd-amdhsa--gfx950"
.text
.globl interleave_layers__linear_kernel_hedgehog__glu_gated_glu__prompt_kernel
.p2align 8
.type interleave_layers__linear_kernel_hedgehog__glu_gated_glu__prompt_kernel,@function
interleave_layers__linear_kernel_hedgehog__glu_gated_glu__prompt_kernel:
    s_cmp_ge_u32 s2, 256
    s_cbranch_scc1 L_end
    s_load_dwordx16 s[80:95], s[0:1], 0
    s_load_dwordx4 s[96:99], s[0:1], 64
    s_load_dwordx2 s[100:101], s[0:1], 80
    v_lshrrev_b32 v14, 6, v0
    v_and_b32 v15, 63, v0
    v_readfirstlane_b32 s28, v14
    v_lshlrev_b32 v1, 4, v15
    v_lshlrev_b32 v11, 2, v15
    s_getpc_b64 s[4:5]
L_pc:
    s_lshr_b32 s66, s2, 3
    s_lshl_b32 s66, s66, 2
    s_add_u32 s66, s66, s28
    s_lshl_b32 s66, s66, 9
    s_add_u32 s66, s66, L_pc-L_pc
    v_lshl_add_u32 v62, v1, 3, s66
    v_min_u32 v62, L_end-L_pc-4, v62
    s_mov_b64 exec, 15
    global_load_dword v62, v62, s[4:5]
    s_mov_b64 exec, -1
    s_and_b32 s30, s2, 7
    s_lshl_b32 s30, s30, 1
    s_lshr_b32 s56, s2, 7
    s_add_u32 s30, s30, s56
    s_lshr_b32 s29, s2, 3
    s_and_b32 s29, s29, 15
    s_lshr_b32 s31, s29, 3
    s_add_u32 s32, s29, s30
    s_and_b32 s32, s32, 7
    s_lshl_b32 s53, s28, 12
    v_lshrrev_b32 v14, 3, v15
    v_lshrrev_b32 v12, 4, v15
    v_xor_b32 v12, v12, v15
    v_and_b32 v12, 7, v12
    v_lshlrev_b32 v12, 4, v12
    v_lshl_add_u32 v40, v14, 10, v12
    v_xor_b32 v41, 64, v40
    v_add_u32 v42, 14336, v40
    v_add_u32 v43, 21504, v41
    v_add_u32 v41, 7168, v41
    v_lshrrev_b32 v14, 2, v15
    v_mul_u32_u24 v14, 3072, v14
    v_and_b32 v12, 0x30, v1
    v_add_u32 v45, v14, v12
    s_mov_b32 s70, 0x200000
    s_mov_b32 s71, 0x20000
    s_mov_b32 s18, 1572864
    s_mov_b32 s19, 0x20000
    s_mov_b32 s23, 0x20000
    s_mov_b32 s27, 0x20000
    s_mov_b32 s11, 0x20000
    s_and_b32 s7, s2, 7
    s_lshr_b32 s64, s2, 3
    s_cmp_lt_u32 s2, 224
    s_cselect_b32 s56, 7, 2
    s_cselect_b32 s57, 0, 28
    s_cselect_b32 s58, 7, 8
    s_cselect_b32 s67, 0, 128
    s_lshl_b32 s56, s56, 9
    s_lshl_b32 s22, s56, 9
    s_mov_b32 s26, s22
    s_sub_u32 s64, s64, s57
    s_lshl_b32 s57, s64, s58
    s_lshl_b32 s64, s64, 2
    s_add_u32 s3, s64, s28
    v_lshrrev_b32 v60, 7, v1
    v_mul_lo_u32 v60, v60, s56
    v_and_b32 v14, 0x70, v1
    v_add_u32 v60, v60, v14
    s_lshl_b32 s73, s7, 2
    s_add_u32 s73, s73, s28
    s_lshl_b32 s73, s73, 4
    s_mul_i32 s73, s73, s56
    s_add_u32 s73, s73, s57
    s_add_u32 s67, s67, s73
    s_lshl_b32 s59, s56, 3
    s_lshl_b32 s56, s30, 2
    s_add_u32 s56, s56, s28
    s_mul_i32 s57, s28, 49152
    s_lshl_b32 s58, s29, 6
    s_waitcnt lgkmcnt(0)
    s_lshl_b32 s0, s56, 8
    s_add_u32 s0, s0, s32
    s_lshl_b32 s0, s0, 7
    s_add_u32 s1, s57, s58
    s_lshl_b32 s88, s28, 10
    s_mov_b32 s68, s80
    s_mov_b32 s69, s81
    s_mov_b32 s16, s82
    s_mov_b32 s17, s83
    s_cmp_lt_u32 s2, 224
    s_cselect_b32 s20, s90, s86
    s_cselect_b32 s21, s91, s87
    s_cselect_b32 s24, s92, s86
    s_cselect_b32 s25, s93, s87
    s_lshl_b32 s60, s28, 11
    s_add_u32 m0, s60, 67584
    s_nop 0
    buffer_load_dwordx4 v60, s[20:23], s73 offen lds
    s_add_u32 m0, s60, 75776
    s_nop 0
    buffer_load_dwordx4 v60, s[24:27], s67 offen lds
    s_add_u32 m0, s60, 68608
    s_add_u32 s73, s73, s59
    buffer_load_dwordx4 v60, s[20:23], s73 offen lds
    s_add_u32 m0, s60, 76800
    s_add_u32 s67, s67, s59
    buffer_load_dwordx4 v60, s[24:27], s67 offen lds
    s_xor_b32 s15, s32, 0
    s_mul_i32 s15, s15, 196608
    s_add_u32 s15, s15, s1
    s_add_u32 m0, s88, 0
    s_add_u32 s63, s15, 1024
    buffer_load_dwordx4 v45, s[16:19], s63 offen lds
    s_add_u32 m0, s88, 31744
    s_nop 0
    buffer_load_dwordx4 v45, s[16:19], s15 offen offset:2048 lds
    s_load_dword s33, s[100:101], 0
    s_mov_b32 s8, s84
    s_mov_b32 s9, s85
    s_mov_b32 s10, 16384
    s_lshl_b32 s56, s28, 8
    s_add_u32 m0, s56, 161792
    s_lshl_b32 s57, s29, 10
    s_add_u32 s56, s56, s57
    buffer_load_dword v11, s[8:11], s56 offen lds
    s_mov_b32 s8, s100
    s_mov_b32 s9, s101
    s_mov_b32 s10, 268435456
    v_lshrrev_b32 v15, 4, v1
    v_bfe_u32 v57, v15, 2, 2
    v_lshrrev_b32 v14, 5, v15
    v_lshl_add_u32 v57, v14, 2, v57
    v_lshlrev_b32 v57, 7, v57
    v_and_b32 v14, 3, v15
    v_lshl_add_u32 v57, v14, 3, v57
    v_bfe_u32 v14, v15, 4, 1
    s_lshr_b32 s56, s28, 1
    s_lshl_b32 s56, s56, 13
    s_and_b32 s57, s28, 1
    s_lshl_b32 s57, s57, 6
    s_add_u32 s56, s56, s57
    s_lshl_b32 s57, s28, 5
    s_mul_i32 s58, s3, 33792
    s_add_u32 s58, s58, 1245184
    s_lshr_b32 s59, s3, 1
    s_lshl_b32 s59, s59, 16
    s_and_b32 s60, s3, 1
    s_lshl_b32 s60, s60, 10
    s_add_u32 s59, s59, s60
    s_add_u32 s59, s59, 6864896
    s_cmp_lt_u32 s2, 224
    s_cselect_b32 s64, 8192, 32
    s_cselect_b32 s56, s57, s56
    s_cselect_b32 s3, s58, s59
    s_cselect_b32 s6, 10, 11
    s_cselect_b32 s26, 268435456, 0
    s_cselect_b32 s22, 1835008, 0
    v_mul_lo_u32 v14, v14, s64
    v_add_u32 v57, v57, v14
    s_add_u32 s56, s56, 67584
    v_add_u32 v57, s56, v57
    s_mov_b32 s20, s94
    s_mov_b32 s21, s95
    s_mov_b32 s24, s100
    s_mov_b32 s25, s101
    s_lshr_b32 s56, s7, 2
    s_lshl_b32 s56, s56, 9
    s_and_b32 s57, s7, 3
    s_lshl_b32 s57, s57, 2
    s_add_u32 s56, s56, s57
    s_add_u32 s56, s56, s3
    s_add_u32 s67, s56, 32768
    s_lshl_b32 s56, s7, 2
    s_lshl_b32 s56, s56, s6
    s_add_u32 s3, s56, s3
    s_lshl_b32 s6, 1, s6
    s_getreg_b32 s36, hwreg(HW_REG_XCC_ID, 0, 4)
    v_lshrrev_b32 v15, 4, v1
    v_add_u32 v2, 0, v1
    v_add_u32 v3, 33792, v1
    v_add_u32 v4, 67584, v1
    v_add_u32 v5, 101376, v1
    v_mov_b32 v10, 0
    s_lshl_b32 s72, s30, 1
    s_add_u32 s72, s72, s31
    s_lshl_b32 s72, s72, 16
    s_lshl_b32 s56, s32, 7
    s_lshl_b32 s57, s28, 5
    s_add_u32 s72, s72, s56
    s_add_u32 s72, s72, s57
    s_lshl_b32 s52, s28, 13
    s_lshl_b32 s56, s28, 4
    s_mov_b64 s[54:55], 0xffff
    s_lshl_b64 s[54:55], s[54:55], s56
    s_and_b32 s56, s28, 1
    s_lshl_b32 s56, s56, 8
    v_xor_b32 v6, s56, v1
    s_lshr_b32 s56, s28, 1
    s_lshl_b32 s56, s56, 10
    v_add_u32 v6, s56, v6
    v_xor_b32 v7, 0x400, v6
    s_lshl_b32 s37, s30, 9
    s_add_u32 s37, s37, 8192
    s_lshl_b32 s56, s28, 7
    s_lshl_b32 s57, s29, 2
    s_add_u32 s38, s37, s56
    s_add_u32 s38, s38, s57
    v_bfe_u32 v14, v15, 3, 2
    v_lshlrev_b32 v14, 7, v14
    v_and_b32 v12, 7, v15
    v_lshl_add_u32 v8, v12, 2, v14
    s_lshr_b32 s56, s28, 1
    s_lshl_b32 s56, s56, 5
    v_add_u32 v8, s56, v8
    v_bfe_u32 v14, v15, 2, 1
    v_lshlrev_b32 v14, 7, v14
    v_and_b32 v12, 3, v15
    v_lshl_add_u32 v9, v12, 2, v14
    s_lshl_b32 s56, s31, 8
    s_lshl_b32 s57, s28, 4
    s_add_u32 s56, s56, s57
    v_add_u32 v9, s56, v9
    s_lshl_b32 s56, s30, 17
    s_add_u32 s56, s56, 7536640
    s_lshl_b32 s57, s28, 15
    s_add_u32 s39, s56, s57
    s_lshl_b32 s57, s31, 16
    s_add_u32 s56, s56, s57
    s_lshl_b32 s57, s32, 2
    s_add_u32 s57, s57, s28
    s_lshl_b32 s57, s57, 10
    s_add_u32 s40, s56, s57
    s_lshr_b32 s56, s56, 4
    s_lshr_b32 s57, s32, 2
    s_lshl_b32 s57, s57, 10
    s_add_u32 s41, s56, s57
    s_and_b32 s57, s32, 3
    s_lshl_b32 s57, s57, 2
    s_add_u32 s41, s41, s57
    s_add_u32 s41, s41, 6918144
    s_mul_i32 s56, s30, 458752
    s_add_u32 s56, s56, 9633792
    s_mul_i32 s57, s28, 114688
    s_mul_i32 s58, s29, 7168
    s_add_u32 s44, s56, s57
    s_lshl_b32 s42, s29, 11
    s_add_u32 s42, s42, s44
    s_add_u32 s44, s44, s58
    s_mul_i32 s57, s31, 229376
    s_mul_i32 s58, s28, 28672
    s_add_u32 s45, s56, s57
    s_add_u32 s43, s45, s52
    s_add_u32 s45, s45, s58
    s_mul_i32 s47, s29, 236544
    s_add_u32 s47, s47, 1245184
    s_lshl_b32 s14, s28, 8
    s_add_u32 s14, s14, 32768
    s_add_u32 s46, s47, s14
    s_add_u32 s47, s47, s52
    s_mul_i32 s48, s32, 229376
    s_mul_i32 s56, s28, 57344
    s_add_u32 s48, s48, s56
    s_add_u32 s48, s48, 5029888
    s_mul_i32 s49, s32, 65536
    s_lshl_b32 s56, s28, 14
    s_add_u32 s49, s49, s56
    s_add_u32 s49, s49, 6864896
    s_mul_i32 s51, s29, 34816
    s_add_u32 s51, s51, 131072
    s_mul_i32 s56, s30, 2176
    s_add_u32 s50, s51, s56
    v_and_b32 v14, 15, v15
    v_bfe_u32 v12, v15, 4, 1
    v_lshlrev_b32 v12, 2, v12
    v_sub_u32 v14, v14, v12
    v_mov_b32 v12, 0x3f803f80
    v_mov_b32 v37, 0x3f80
    v_cmp_eq_u32 vcc, 0, v14
    v_accvgpr_write_b32 a252, v12
    s_nop 0
    v_cndmask_b32 v36, 0, v37, vcc
    v_cmp_eq_u32 vcc, 1, v14
    s_nop 1
    v_cndmask_b32 v36, v36, 1.0, vcc
    v_accvgpr_write_b32 a248, v36
    v_cmp_eq_u32 vcc, 2, v14
    v_accvgpr_write_b32 a253, v12
    s_nop 0
    v_cndmask_b32 v36, 0, v37, vcc
    v_cmp_eq_u32 vcc, 3, v14
    s_nop 1
    v_cndmask_b32 v36, v36, 1.0, vcc
    v_accvgpr_write_b32 a249, v36
    v_cmp_eq_u32 vcc, 8, v14
    v_accvgpr_write_b32 a254, v12
    s_nop 0
    v_cndmask_b32 v36, 0, v37, vcc
    v_cmp_eq_u32 vcc, 9, v14
    s_nop 1
    v_cndmask_b32 v36, v36, 1.0, vcc
    v_accvgpr_write_b32 a250, v36
    v_cmp_eq_u32 vcc, 10, v14
    v_accvgpr_write_b32 a255, v12
    s_nop 0
    v_cndmask_b32 v36, 0, v37, vcc
    v_cmp_eq_u32 vcc, 11, v14
    s_nop 1
    v_cndmask_b32 v36, v36, 1.0, vcc
    v_accvgpr_write_b32 a251, v36
    v_and_b32 v14, 0x1f0, v1
    v_lshlrev_b32 v14, 3, v14
    v_lshrrev_b32 v12, 1, v15
    v_lshrrev_b32 v13, 5, v15
    v_xor_b32 v12, v12, v13
    v_and_b32 v12, 7, v12
    v_lshl_add_u32 v14, v12, 4, v14
    s_add_u32 s56, s53, 101376
    v_xor_b32 v46, 0, v14
    v_add_u32 v46, s56, v46
    v_xor_b32 v47, 32, v14
    v_add_u32 v47, s56, v47
    v_xor_b32 v48, 64, v14
    v_add_u32 v48, s56, v48
    v_xor_b32 v49, 96, v14
    v_add_u32 v49, s56, v49
    s_lshl_b32 s56, s28, 5
    v_xor_b32 v54, s56, v14
    s_lshl_b32 s56, s31, 13
    s_add_u32 s56, s56, 101376
    v_add_u32 v54, s56, v54
    v_and_b32 v14, 1, v15
    v_lshlrev_b32 v55, 9, v14
    v_lshl_add_u32 v55, v13, 7, v55
    v_bfe_u32 v14, v15, 2, 2
    v_lshl_add_u32 v55, v14, 5, v55
    v_bfe_u32 v14, v15, 4, 1
    v_lshl_add_u32 v55, v14, 4, v55
    v_bfe_u32 v14, v15, 1, 1
    v_lshl_add_u32 v55, v14, 3, v55
    v_add_u32 v55, 161792, v55
    v_and_b32 v14, 15, v15
    v_lshlrev_b32 v59, 3, v14
    s_and_b32 s56, s2, 0x87
    v_add_u32 v59, s56, v59
    v_lshlrev_b32 v59, 7, v59
    s_mul_i32 s56, s29, 7
    s_add_u32 s57, s56, 6
    s_lshr_b32 s56, s56, 2
    s_lshr_b32 s57, s57, 2
    s_add_u32 s58, s56, 1
    s_lshr_b32 s61, s32, 1
    s_add_u32 s61, s61, 28
    s_add_u32 s60, s29, 16
    s_cmp_eq_u32 s28, 0
    s_cselect_b32 s56, s56, s57
    s_cselect_b32 s58, s58, s61
    s_cmp_lt_u32 s28, 2
    s_cselect_b32 s56, s56, s29
    s_cselect_b32 s58, s58, s60
    s_sub_u32 s58, s58, s56
    v_bfe_u32 v14, v1, 7, 1
    v_mul_lo_u32 v14, v14, s58
    v_add_u32 v14, s56, v14
    v_bfe_u32 v53, v1, 4, 3
    v_lshl_add_u32 v53, v14, 3, v53
    v_lshlrev_b32 v53, 7, v53
    s_cmp_eq_u32 s28, 3
    s_cselect_b64 vcc, -1, 0
    v_cndmask_b32 v53, v53, v59, vcc
    s_and_b32 s58, s29, 7
    s_lshl_b32 s58, s58, 8
    s_lshr_b32 s56, s39, 4
    s_add_u32 s58, s58, s56
    s_add_u32 s58, s58, 6918144
    v_and_b32 v61, 15, v15
    v_lshl_add_u32 v61, v61, 7, s42
    v_and_b32 v14, 1, v15
    v_lshl_add_u32 v14, v14, 7, s58
    v_cmp_lt_u32 vcc, 15, v15
    s_nop 1
    v_cndmask_b32 v61, v61, v14, vcc
    v_and_b32 v14, 7, v15
    v_lshl_add_u32 v14, v14, 7, s40
    v_bfe_u32 v12, v15, 3, 1
    v_lshl_add_u32 v14, v12, 15, v14
    v_cmp_lt_u32 vcc, 31, v15
    s_nop 1
    v_cndmask_b32 v61, v61, v14, vcc
    v_lshrrev_b32 v14, 9, v1
    v_lshlrev_b32 v50, 9, v14
    v_and_b32 v14, 0xc0, v1
    v_add_u32 v50, v50, v14
    v_bfe_u32 v14, v1, 8, 1
    v_lshl_add_u32 v50, v14, 5, v50
    v_bfe_u32 v14, v1, 4, 2
    v_lshl_add_u32 v50, v14, 3, v50
    v_add_u32 v52, 67584, v50
    v_add_u32 v51, 33792, v50
    v_add_u32 v50, 0, v50
    v_add_u32 v12, s88, v50
    v_add_u32 v13, s88, v51
    v_mov_b32 v224, -1
    v_mov_b32 v225, -1
    v_mov_b32 v226, -1
    v_mov_b32 v227, -1
    s_mul_i32 s64, s28, 544
    s_add_u32 s64, s64, s50
    s_add_u32 s65, s64, 557056
    s_lshl_b32 s89, s2, 7
    s_cmp_eq_u32 s28, 0
    s_cselect_b32 s89, s89, 268435456
    s_add_u32 m0, s53, 101376
    s_xor_b32 s63, s0, 0
    buffer_load_dwordx4 v40, s[68:71], s63 offen offset:0 lds
    buffer_load_dwordx4 v41, s[68:71], s63 offen offset:1024 lds
    buffer_load_dwordx4 v42, s[68:71], s63 offen offset:2048 lds
    buffer_load_dwordx4 v43, s[68:71], s63 offen offset:3072 lds
    s_add_u32 m0, s88, 3072
    s_xor_b32 s15, s32, 1
    s_mul_i32 s15, s15, 196608
    s_add_u32 s15, s15, s1
    buffer_load_dwordx4 v45, s[16:19], s15 offen offset:1024 lds
    s_add_u32 m0, s88, 35840
    s_nop 0
    buffer_load_dwordx4 v45, s[16:19], s15 offen offset:2048 lds
    s_waitcnt vmcnt(9)
    s_barrier
    ds_read_b64_tr_b16 a[0:1], v57 offset:0
    ds_read_b64_tr_b16 a[2:3], v57 offset:1024
    ds_read_b64_tr_b16 a[4:5], v57 offset:2048
    ds_read_b64_tr_b16 a[6:7], v57 offset:3072
    ds_read_b64_tr_b16 a[8:9], v57 offset:4096
    ds_read_b64_tr_b16 a[10:11], v57 offset:5120
    ds_read_b64_tr_b16 a[12:13], v57 offset:6144
    ds_read_b64_tr_b16 a[14:15], v57 offset:7168
    s_waitcnt lgkmcnt(0)
    v_mfma_f32_32x32x16_bf16 v[240:255], a[252:255], a[0:3], 0
    v_mfma_f32_32x32x16_bf16 v[240:255], a[252:255], a[4:7], v[240:255]
    v_mfma_f32_32x32x16_bf16 v[240:255], a[252:255], a[8:11], v[240:255]
    v_mfma_f32_32x32x16_bf16 v[240:255], a[252:255], a[12:15], v[240:255]
    s_add_u32 m0, s88, 7168
    s_xor_b32 s15, s32, 2
    s_mul_i32 s15, s15, 196608
    s_add_u32 s15, s15, s1
    buffer_load_dwordx4 v45, s[16:19], s15 offen offset:1024 lds
    s_add_u32 m0, s88, 39936
    s_nop 0
    buffer_load_dwordx4 v45, s[16:19], s15 offen offset:2048 lds
    s_add_u32 m0, s53, 117760
    s_xor_b32 s63, s0, 128
    buffer_load_dwordx4 v40, s[68:71], s63 offen offset:0 lds
    buffer_load_dwordx4 v41, s[68:71], s63 offen offset:1024 lds
    buffer_load_dwordx4 v42, s[68:71], s63 offen offset:2048 lds
    buffer_load_dwordx4 v43, s[68:71], s63 offen offset:3072 lds
    buffer_store_dwordx4 a[0:3], v1, s[8:11], s3 offen sc1
    s_add_u32 s3, s3, s6
    buffer_store_dwordx4 a[4:7], v1, s[8:11], s3 offen sc1
    s_add_u32 s3, s3, s6
    buffer_store_dwordx4 a[8:11], v1, s[8:11], s3 offen sc1
    s_add_u32 s3, s3, s6
    buffer_store_dwordx4 a[12:15], v1, s[8:11], s3 offen sc1
    v_cvt_pk_bf16_f32 v244, v240, v240
    v_and_b32 v244, 0xffff0000, v244
    v_sub_f32 v58, v240, v244
    v_cvt_pk_bf16_f32 v58, v244, v58
    s_mov_b32 exec_hi, 0
    buffer_store_dword v58, v1, s[24:27], s67 offen sc1
    s_mov_b64 exec, -1
    s_mov_b32 exec_hi, 3
    buffer_store_dwordx4 v[224:227], v1, s[8:11], s64 offen sc1
    buffer_store_dwordx4 v[224:227], v1, s[8:11], s65 offen sc1
    s_mov_b64 exec, 1
    buffer_store_dword v10, v10, s[8:11], s38 offen sc1
    s_mov_b64 exec, -1
    s_mul_i32 s34, s33, 0x9e3779b1
    s_add_u32 s34, s34, 0x7f4a7c15
    s_mul_i32 s35, s33, 0x85ebca6b
    s_add_u32 s35, s35, 0xc2b2ae35
    s_and_b32 s35, s35, 0xfffffff0
    s_waitcnt vmcnt(16)
    s_barrier
    ds_read_b128 v[192:195], v54
    ds_read_b128 v[196:199], v54 offset:4096
    ds_read_b64_tr_b16 v[216:217], v55
    ds_read_b64_tr_b16 v[218:219], v55 offset:256
    ds_read_b128 v[128:131], v46 offset:0
    ds_read_b128 v[132:135], v47 offset:0
    ds_read_b128 v[136:139], v48 offset:0
    ds_read_b128 v[140:143], v49 offset:0
    s_waitcnt lgkmcnt(7)
    v_permlane32_swap_b32 v192, v194
    v_permlane32_swap_b32 v193, v195
    s_waitcnt lgkmcnt(6)
    v_permlane32_swap_b32 v196, v198
    v_permlane32_swap_b32 v197, v199
    v_lshlrev_b32 v200, 16, v192
    v_and_b32 v201, 0xffff0000, v192
    v_lshlrev_b32 v202, 16, v193
    v_and_b32 v203, 0xffff0000, v193
    v_lshlrev_b32 v204, 16, v194
    v_and_b32 v205, 0xffff0000, v194
    v_lshlrev_b32 v206, 16, v195
    v_and_b32 v207, 0xffff0000, v195
    v_accvgpr_write_b32 a224, v200
    v_accvgpr_write_b32 a225, v201
    v_accvgpr_write_b32 a226, v202
    v_accvgpr_write_b32 a227, v203
    v_accvgpr_write_b32 a228, v204
    v_accvgpr_write_b32 a229, v205
    v_accvgpr_write_b32 a230, v206
    v_accvgpr_write_b32 a231, v207
    v_lshlrev_b32 v208, 16, v196
    v_and_b32 v209, 0xffff0000, v196
    v_lshlrev_b32 v210, 16, v197
    v_and_b32 v211, 0xffff0000, v197
    v_lshlrev_b32 v212, 16, v198
    v_and_b32 v213, 0xffff0000, v198
    v_lshlrev_b32 v214, 16, v199
    v_and_b32 v215, 0xffff0000, v199
    v_accvgpr_write_b32 a232, v208
    v_accvgpr_write_b32 a233, v209
    v_accvgpr_write_b32 a234, v210
    v_accvgpr_write_b32 a235, v211
    v_accvgpr_write_b32 a236, v212
    v_accvgpr_write_b32 a237, v213
    v_accvgpr_write_b32 a238, v214
    v_accvgpr_write_b32 a239, v215
    v_and_b32 v192, 64, v1
    v_cmp_eq_u32 vcc, 0, v192
    v_mov_b32 v56, 0x3f803f80
    s_waitcnt lgkmcnt(5)
    v_cndmask_b32 v192, 0, v216, vcc
    v_cndmask_b32 v193, v216, 0, vcc
    v_accvgpr_write_b32 a240, v192
    v_accvgpr_write_b32 a244, v193
    v_cndmask_b32 v192, 0, v217, vcc
    v_cndmask_b32 v193, v217, 0, vcc
    v_accvgpr_write_b32 a241, v192
    v_accvgpr_write_b32 a245, v193
    s_waitcnt lgkmcnt(4)
    v_cndmask_b32 v192, 0, v218, vcc
    v_cndmask_b32 v193, v218, 0, vcc
    v_accvgpr_write_b32 a242, v192
    v_accvgpr_write_b32 a246, v193
    v_cndmask_b32 v192, 0, v219, vcc
    v_cndmask_b32 v193, v219, 0, vcc
    v_accvgpr_write_b32 a243, v192
    v_accvgpr_write_b32 a247, v193
    ds_read_b64_tr_b16 v[20:21], v12 offset:0
    ds_read_b64_tr_b16 v[22:23], v12 offset:256
    ds_read_b64_tr_b16 v[24:25], v13 offset:0
    ds_read_b64_tr_b16 v[26:27], v13 offset:256
    ds_read_b64_tr_b16 v[28:29], v50 offset:0
    ds_read_b64_tr_b16 v[30:31], v50 offset:256
    ds_read_b64_tr_b16 v[32:33], v51 offset:0
    ds_read_b64_tr_b16 v[34:35], v51 offset:256
    ds_read_b64_tr_b16 v[36:37], v50 offset:1024
    ds_read_b64_tr_b16 v[38:39], v50 offset:1280
    s_waitcnt lgkmcnt(8)
    v_mfma_f32_32x32x16_bf16 v[96:111], a[252:255], v[20:23], 0
    ds_read_b64_tr_b16 v[20:21], v51 offset:1024
    ds_read_b64_tr_b16 v[22:23], v51 offset:1280
    s_add_u32 m0, s88, 11264
    s_xor_b32 s15, s32, 3
    s_mul_i32 s15, s15, 196608
    s_add_u32 s15, s15, s1
    buffer_load_dwordx4 v45, s[16:19], s15 offen offset:1024 lds
    s_waitcnt lgkmcnt(8)
    v_mfma_f32_32x32x16_bf16 v[112:127], a[252:255], v[24:27], 0
    ds_read_b64_tr_b16 v[24:25], v50 offset:2048
    ds_read_b64_tr_b16 v[26:27], v50 offset:2304
    s_add_u32 m0, s88, 44032
    s_nop 0
    buffer_load_dwordx4 v45, s[16:19], s15 offen offset:2048 lds
    s_waitcnt lgkmcnt(6)
    v_mfma_f32_32x32x16_bf16 v[64:79], v[28:31], v[128:131], 0
    ds_read_b64_tr_b16 v[28:29], v51 offset:2048
    ds_read_b64_tr_b16 v[30:31], v51 offset:2304
    v_mfma_f32_32x32x16_bf16 v[80:95], v[32:35], v[128:131], 0
    ds_read_b64_tr_b16 v[32:33], v50 offset:3072
    ds_read_b64_tr_b16 v[34:35], v50 offset:3328
    s_add_u32 m0, s53, 134144
    s_xor_b32 s63, s0, 256
    buffer_load_dwordx4 v40, s[68:71], s63 offen offset:0 lds
    s_waitcnt lgkmcnt(6)
    v_mfma_f32_32x32x16_bf16 v[64:79], v[36:39], v[132:135], v[64:79]
    ds_read_b64_tr_b16 v[36:37], v51 offset:3072
    ds_read_b64_tr_b16 v[38:39], v51 offset:3328
    s_waitcnt vmcnt(17)
    s_barrier
    buffer_load_dwordx4 v41, s[68:71], s63 offen offset:1024 lds
    v_mfma_f32_32x32x16_bf16 v[80:95], v[20:23], v[132:135], v[80:95]
    ds_read_b64_tr_b16 v[20:21], v12 offset:4096
    ds_read_b64_tr_b16 v[22:23], v12 offset:4352
    s_waitcnt lgkmcnt(6)
    v_mfma_f32_32x32x16_bf16 v[64:79], v[24:27], v[136:139], v[64:79]
    ds_read_b64_tr_b16 v[24:25], v13 offset:4096
    ds_read_b64_tr_b16 v[26:27], v13 offset:4352
    buffer_load_dwordx4 v42, s[68:71], s63 offen offset:2048 lds
    v_mfma_f32_32x32x16_bf16 v[80:95], v[28:31], v[136:139], v[80:95]
    ds_read_b64_tr_b16 v[28:29], v50 offset:4096
    ds_read_b64_tr_b16 v[30:31], v50 offset:4352
    buffer_load_dwordx4 v43, s[68:71], s63 offen offset:3072 lds
    s_waitcnt lgkmcnt(6)
    v_mfma_f32_32x32x16_bf16 v[64:79], v[32:35], v[140:143], v[64:79]
    ds_read_b64_tr_b16 v[32:33], v51 offset:4096
    ds_read_b64_tr_b16 v[34:35], v51 offset:4352
    v_mfma_f32_32x32x16_bf16 v[80:95], v[36:39], v[140:143], v[80:95]
    ds_read_b64_tr_b16 v[36:37], v50 offset:5120
    ds_read_b64_tr_b16 v[38:39], v50 offset:5376
    v_dot2_f32_bf16 v54, v128, v56, 0
    v_dot2_f32_bf16 v55, v128, v128, 0
    v_dot2_f32_bf16 v54, v129, v56, v54
    v_dot2_f32_bf16 v55, v129, v129, v55
    v_dot2_f32_bf16 v54, v130, v56, v54
    v_dot2_f32_bf16 v55, v130, v130, v55
    v_dot2_f32_bf16 v54, v131, v56, v54
    v_dot2_f32_bf16 v55, v131, v131, v55
    v_dot2_f32_bf16 v54, v132, v56, v54
    v_dot2_f32_bf16 v55, v132, v132, v55
    v_dot2_f32_bf16 v54, v133, v56, v54
    v_dot2_f32_bf16 v55, v133, v133, v55
    v_dot2_f32_bf16 v54, v134, v56, v54
    v_dot2_f32_bf16 v55, v134, v134, v55
    v_dot2_f32_bf16 v54, v135, v56, v54
    v_dot2_f32_bf16 v55, v135, v135, v55
    v_dot2_f32_bf16 v54, v136, v56, v54
    v_dot2_f32_bf16 v55, v136, v136, v55
    v_dot2_f32_bf16 v54, v137, v56, v54
    v_dot2_f32_bf16 v55, v137, v137, v55
    v_dot2_f32_bf16 v54, v138, v56, v54
    v_dot2_f32_bf16 v55, v138, v138, v55
    v_dot2_f32_bf16 v54, v139, v56, v54
    v_dot2_f32_bf16 v55, v139, v139, v55
    v_dot2_f32_bf16 v54, v140, v56, v54
    v_dot2_f32_bf16 v55, v140, v140, v55
    v_dot2_f32_bf16 v54, v141, v56, v54
    v_dot2_f32_bf16 v55, v141, v141, v55
    v_dot2_f32_bf16 v54, v142, v56, v54
    v_dot2_f32_bf16 v55, v142, v142, v55
    v_dot2_f32_bf16 v54, v143, v56, v54
    v_dot2_f32_bf16 v55, v143, v143, v55
    s_waitcnt vmcnt(14)
    ds_read_b128 v[144:147], v46 offset:16384
    ds_read_b128 v[148:151], v47 offset:16384
    ds_read_b128 v[152:155], v48 offset:16384
    ds_read_b128 v[156:159], v49 offset:16384
    s_waitcnt lgkmcnt(10)
    v_mfma_f32_32x32x16_bf16 v[96:111], a[252:255], v[20:23], v[96:111]
    ds_read_b64_tr_b16 v[20:21], v51 offset:5120
    ds_read_b64_tr_b16 v[22:23], v51 offset:5376
    s_add_u32 m0, s88, 15360
    s_xor_b32 s15, s32, 4
    s_mul_i32 s15, s15, 196608
    s_add_u32 s15, s15, s1
    buffer_load_dwordx4 v45, s[16:19], s15 offen offset:1024 lds
    v_mfma_f32_32x32x16_bf16 v[112:127], a[252:255], v[24:27], v[112:127]
    ds_read_b64_tr_b16 v[24:25], v50 offset:6144
    ds_read_b64_tr_b16 v[26:27], v50 offset:6400
    s_add_u32 m0, s88, 48128
    s_nop 0
    buffer_load_dwordx4 v45, s[16:19], s15 offen offset:2048 lds
    s_waitcnt lgkmcnt(7)
    v_mfma_f32_32x32x16_bf16 v[64:79], v[28:31], v[144:147], v[64:79]
    ds_read_b64_tr_b16 v[28:29], v51 offset:6144
    ds_read_b64_tr_b16 v[30:31], v51 offset:6400
    v_mfma_f32_32x32x16_bf16 v[80:95], v[32:35], v[144:147], v[80:95]
    ds_read_b64_tr_b16 v[32:33], v50 offset:7168
    ds_read_b64_tr_b16 v[34:35], v50 offset:7424
    s_add_u32 m0, s53, 101376
    s_xor_b32 s63, s0, 384
    buffer_load_dwordx4 v40, s[68:71], s63 offen offset:0 lds
    s_waitcnt lgkmcnt(6)
    v_mfma_f32_32x32x16_bf16 v[64:79], v[36:39], v[148:151], v[64:79]
    ds_read_b64_tr_b16 v[36:37], v51 offset:7168
    ds_read_b64_tr_b16 v[38:39], v51 offset:7424
    s_barrier
    buffer_load_dwordx4 v41, s[68:71], s63 offen offset:1024 lds
    v_mfma_f32_32x32x16_bf16 v[80:95], v[20:23], v[148:151], v[80:95]
    ds_read_b64_tr_b16 v[20:21], v12 offset:8192
    ds_read_b64_tr_b16 v[22:23], v12 offset:8448
    s_waitcnt lgkmcnt(6)
    v_mfma_f32_32x32x16_bf16 v[64:79], v[24:27], v[152:155], v[64:79]
    ds_read_b64_tr_b16 v[24:25], v13 offset:8192
    ds_read_b64_tr_b16 v[26:27], v13 offset:8448
    buffer_load_dwordx4 v42, s[68:71], s63 offen offset:2048 lds
    v_mfma_f32_32x32x16_bf16 v[80:95], v[28:31], v[152:155], v[80:95]
    ds_read_b64_tr_b16 v[28:29], v50 offset:8192
    ds_read_b64_tr_b16 v[30:31], v50 offset:8448
    buffer_load_dwordx4 v43, s[68:71], s63 offen offset:3072 lds
    s_waitcnt lgkmcnt(6)
    v_mfma_f32_32x32x16_bf16 v[64:79], v[32:35], v[156:159], v[64:79]
    ds_read_b64_tr_b16 v[32:33], v51 offset:8192
    ds_read_b64_tr_b16 v[34:35], v51 offset:8448
    v_mfma_f32_32x32x16_bf16 v[80:95], v[36:39], v[156:159], v[80:95]
    ds_read_b64_tr_b16 v[36:37], v50 offset:9216
    ds_read_b64_tr_b16 v[38:39], v50 offset:9472
    v_dot2_f32_bf16 v54, v144, v56, v54
    v_dot2_f32_bf16 v55, v144, v144, v55
    v_dot2_f32_bf16 v54, v145, v56, v54
    v_dot2_f32_bf16 v55, v145, v145, v55
    v_dot2_f32_bf16 v54, v146, v56, v54
    v_dot2_f32_bf16 v55, v146, v146, v55
    v_dot2_f32_bf16 v54, v147, v56, v54
    v_dot2_f32_bf16 v55, v147, v147, v55
    v_dot2_f32_bf16 v54, v148, v56, v54
    v_dot2_f32_bf16 v55, v148, v148, v55
    v_dot2_f32_bf16 v54, v149, v56, v54
    v_dot2_f32_bf16 v55, v149, v149, v55
    v_dot2_f32_bf16 v54, v150, v56, v54
    v_dot2_f32_bf16 v55, v150, v150, v55
    v_dot2_f32_bf16 v54, v151, v56, v54
    v_dot2_f32_bf16 v55, v151, v151, v55
    v_dot2_f32_bf16 v54, v152, v56, v54
    v_dot2_f32_bf16 v55, v152, v152, v55
    v_dot2_f32_bf16 v54, v153, v56, v54
    v_dot2_f32_bf16 v55, v153, v153, v55
    v_dot2_f32_bf16 v54, v154, v56, v54
    v_dot2_f32_bf16 v55, v154, v154, v55
    v_dot2_f32_bf16 v54, v155, v56, v54
    v_dot2_f32_bf16 v55, v155, v155, v55
    v_dot2_f32_bf16 v54, v156, v56, v54
    v_dot2_f32_bf16 v55, v156, v156, v55
    v_dot2_f32_bf16 v54, v157, v56, v54
    v_dot2_f32_bf16 v55, v157, v157, v55
    v_dot2_f32_bf16 v54, v158, v56, v54
    v_dot2_f32_bf16 v55, v158, v158, v55
    v_dot2_f32_bf16 v54, v159, v56, v54
    v_dot2_f32_bf16 v55, v159, v159, v55
    s_waitcnt vmcnt(6)
    ds_read_b128 v[160:163], v46 offset:32768
    ds_read_b128 v[164:167], v47 offset:32768
    ds_read_b128 v[168:171], v48 offset:32768
    ds_read_b128 v[172:175], v49 offset:32768
    s_waitcnt lgkmcnt(10)
    v_mfma_f32_32x32x16_bf16 v[96:111], a[252:255], v[20:23], v[96:111]
    ds_read_b64_tr_b16 v[20:21], v51 offset:9216
    ds_read_b64_tr_b16 v[22:23], v51 offset:9472
    s_add_u32 m0, s88, 19456
    s_xor_b32 s15, s32, 5
    s_mul_i32 s15, s15, 196608
    s_add_u32 s15, s15, s1
    buffer_load_dwordx4 v45, s[16:19], s15 offen offset:1024 lds
    v_mfma_f32_32x32x16_bf16 v[112:127], a[252:255], v[24:27], v[112:127]
    ds_read_b64_tr_b16 v[24:25], v50 offset:10240
    ds_read_b64_tr_b16 v[26:27], v50 offset:10496
    s_add_u32 m0, s88, 52224
    s_nop 0
    buffer_load_dwordx4 v45, s[16:19], s15 offen offset:2048 lds
    s_waitcnt lgkmcnt(7)
    v_mfma_f32_32x32x16_bf16 v[64:79], v[28:31], v[160:163], v[64:79]
    ds_read_b64_tr_b16 v[28:29], v51 offset:10240
    ds_read_b64_tr_b16 v[30:31], v51 offset:10496
    v_mfma_f32_32x32x16_bf16 v[80:95], v[32:35], v[160:163], v[80:95]
    ds_read_b64_tr_b16 v[32:33], v50 offset:11264
    ds_read_b64_tr_b16 v[34:35], v50 offset:11520
    s_add_u32 m0, s53, 117760
    s_xor_b32 s63, s0, 512
    buffer_load_dwordx4 v40, s[68:71], s63 offen offset:0 lds
    s_waitcnt lgkmcnt(6)
    v_mfma_f32_32x32x16_bf16 v[64:79], v[36:39], v[164:167], v[64:79]
    ds_read_b64_tr_b16 v[36:37], v51 offset:11264
    ds_read_b64_tr_b16 v[38:39], v51 offset:11520
    s_barrier
    s_or_b32 s66, s35, s36
    v_mov_b32 v16, s34
    v_mov_b32 v17, s66
    s_add_u32 s66, s89, 65536
    s_mov_b64 exec, 1
    buffer_store_dwordx2 v[16:17], v10, s[8:11], s66 offen sc1
    s_mov_b64 exec, -1
    buffer_load_dwordx4 v41, s[68:71], s63 offen offset:1024 lds
    v_mfma_f32_32x32x16_bf16 v[80:95], v[20:23], v[164:167], v[80:95]
    ds_read_b64_tr_b16 v[20:21], v12 offset:12288
    ds_read_b64_tr_b16 v[22:23], v12 offset:12544
    s_waitcnt lgkmcnt(6)
    v_mfma_f32_32x32x16_bf16 v[64:79], v[24:27], v[168:171], v[64:79]
    ds_read_b64_tr_b16 v[24:25], v13 offset:12288
    ds_read_b64_tr_b16 v[26:27], v13 offset:12544
    buffer_load_dwordx4 v42, s[68:71], s63 offen offset:2048 lds
    v_mfma_f32_32x32x16_bf16 v[80:95], v[28:31], v[168:171], v[80:95]
    ds_read_b64_tr_b16 v[28:29], v50 offset:12288
    ds_read_b64_tr_b16 v[30:31], v50 offset:12544
    buffer_load_dwordx4 v43, s[68:71], s63 offen offset:3072 lds
    s_waitcnt lgkmcnt(6)
    v_mfma_f32_32x32x16_bf16 v[64:79], v[32:35], v[172:175], v[64:79]
    ds_read_b64_tr_b16 v[32:33], v51 offset:12288
    ds_read_b64_tr_b16 v[34:35], v51 offset:12544
    v_mfma_f32_32x32x16_bf16 v[80:95], v[36:39], v[172:175], v[80:95]
    ds_read_b64_tr_b16 v[36:37], v50 offset:13312
    ds_read_b64_tr_b16 v[38:39], v50 offset:13568
    v_dot2_f32_bf16 v54, v160, v56, v54
    v_dot2_f32_bf16 v55, v160, v160, v55
    v_dot2_f32_bf16 v54, v161, v56, v54
    v_dot2_f32_bf16 v55, v161, v161, v55
    v_dot2_f32_bf16 v54, v162, v56, v54
    v_dot2_f32_bf16 v55, v162, v162, v55
    v_dot2_f32_bf16 v54, v163, v56, v54
    v_dot2_f32_bf16 v55, v163, v163, v55
    v_dot2_f32_bf16 v54, v164, v56, v54
    v_dot2_f32_bf16 v55, v164, v164, v55
    v_dot2_f32_bf16 v54, v165, v56, v54
    v_dot2_f32_bf16 v55, v165, v165, v55
    v_dot2_f32_bf16 v54, v166, v56, v54
    v_dot2_f32_bf16 v55, v166, v166, v55
    v_dot2_f32_bf16 v54, v167, v56, v54
    v_dot2_f32_bf16 v55, v167, v167, v55
    v_dot2_f32_bf16 v54, v168, v56, v54
    v_dot2_f32_bf16 v55, v168, v168, v55
    v_dot2_f32_bf16 v54, v169, v56, v54
    v_dot2_f32_bf16 v55, v169, v169, v55
    v_dot2_f32_bf16 v54, v170, v56, v54
    v_dot2_f32_bf16 v55, v170, v170, v55
    v_dot2_f32_bf16 v54, v171, v56, v54
    v_dot2_f32_bf16 v55, v171, v171, v55
    v_dot2_f32_bf16 v54, v172, v56, v54
    v_dot2_f32_bf16 v55, v172, v172, v55
    v_dot2_f32_bf16 v54, v173, v56, v54
    v_dot2_f32_bf16 v55, v173, v173, v55
    v_dot2_f32_bf16 v54, v174, v56, v54
    v_dot2_f32_bf16 v55, v174, v174, v55
    v_dot2_f32_bf16 v54, v175, v56, v54
    v_dot2_f32_bf16 v55, v175, v175, v55
    s_waitcnt vmcnt(7)
    ds_read_b128 v[176:179], v46 offset:0
    ds_read_b128 v[180:183], v47 offset:0
    ds_read_b128 v[184:187], v48 offset:0
    ds_read_b128 v[188:191], v49 offset:0
    s_waitcnt lgkmcnt(10)
    v_mfma_f32_32x32x16_bf16 v[96:111], a[252:255], v[20:23], v[96:111]
    ds_read_b64_tr_b16 v[20:21], v51 offset:13312
    ds_read_b64_tr_b16 v[22:23], v51 offset:13568
    s_add_u32 m0, s88, 23552
    s_xor_b32 s15, s32, 6
    s_mul_i32 s15, s15, 196608
    s_add_u32 s15, s15, s1
    buffer_load_dwordx4 v45, s[16:19], s15 offen offset:1024 lds
    v_mfma_f32_32x32x16_bf16 v[112:127], a[252:255], v[24:27], v[112:127]
    ds_read_b64_tr_b16 v[24:25], v50 offset:14336
    ds_read_b64_tr_b16 v[26:27], v50 offset:14592
    s_add_u32 m0, s88, 56320
    s_nop 0
    buffer_load_dwordx4 v45, s[16:19], s15 offen offset:2048 lds
    s_waitcnt lgkmcnt(7)
    v_mfma_f32_32x32x16_bf16 v[64:79], v[28:31], v[176:179], v[64:79]
    ds_read_b64_tr_b16 v[28:29], v51 offset:14336
    ds_read_b64_tr_b16 v[30:31], v51 offset:14592
    v_mfma_f32_32x32x16_bf16 v[80:95], v[32:35], v[176:179], v[80:95]
    ds_read_b64_tr_b16 v[32:33], v50 offset:15360
    ds_read_b64_tr_b16 v[34:35], v50 offset:15616
    s_add_u32 m0, s53, 134144
    s_xor_b32 s63, s0, 640
    buffer_load_dwordx4 v40, s[68:71], s63 offen offset:0 lds
    s_waitcnt lgkmcnt(6)
    v_mfma_f32_32x32x16_bf16 v[64:79], v[36:39], v[180:183], v[64:79]
    ds_read_b64_tr_b16 v[36:37], v51 offset:15360
    ds_read_b64_tr_b16 v[38:39], v51 offset:15616
    s_barrier
    buffer_load_dwordx4 v41, s[68:71], s63 offen offset:1024 lds
    v_mfma_f32_32x32x16_bf16 v[80:95], v[20:23], v[180:183], v[80:95]
    ds_read_b64_tr_b16 v[20:21], v12 offset:16384
    ds_read_b64_tr_b16 v[22:23], v12 offset:16640
    s_waitcnt lgkmcnt(6)
    v_mfma_f32_32x32x16_bf16 v[64:79], v[24:27], v[184:187], v[64:79]
    ds_read_b64_tr_b16 v[24:25], v13 offset:16384
    ds_read_b64_tr_b16 v[26:27], v13 offset:16640
    buffer_load_dwordx4 v42, s[68:71], s63 offen offset:2048 lds
    v_mfma_f32_32x32x16_bf16 v[80:95], v[28:31], v[184:187], v[80:95]
    ds_read_b64_tr_b16 v[28:29], v50 offset:16384
    ds_read_b64_tr_b16 v[30:31], v50 offset:16640
    buffer_load_dwordx4 v43, s[68:71], s63 offen offset:3072 lds
    s_waitcnt lgkmcnt(6)
    v_mfma_f32_32x32x16_bf16 v[64:79], v[32:35], v[188:191], v[64:79]
    ds_read_b64_tr_b16 v[32:33], v51 offset:16384
    ds_read_b64_tr_b16 v[34:35], v51 offset:16640
    v_mfma_f32_32x32x16_bf16 v[80:95], v[36:39], v[188:191], v[80:95]
    ds_read_b64_tr_b16 v[36:37], v50 offset:17408
    ds_read_b64_tr_b16 v[38:39], v50 offset:17664
    v_dot2_f32_bf16 v54, v176, v56, v54
    v_dot2_f32_bf16 v55, v176, v176, v55
    v_dot2_f32_bf16 v54, v177, v56, v54
    v_dot2_f32_bf16 v55, v177, v177, v55
    v_dot2_f32_bf16 v54, v178, v56, v54
    v_dot2_f32_bf16 v55, v178, v178, v55
    v_dot2_f32_bf16 v54, v179, v56, v54
    v_dot2_f32_bf16 v55, v179, v179, v55
    v_dot2_f32_bf16 v54, v180, v56, v54
    v_dot2_f32_bf16 v55, v180, v180, v55
    v_dot2_f32_bf16 v54, v181, v56, v54
    v_dot2_f32_bf16 v55, v181, v181, v55
    v_dot2_f32_bf16 v54, v182, v56, v54
    v_dot2_f32_bf16 v55, v182, v182, v55
    v_dot2_f32_bf16 v54, v183, v56, v54
    v_dot2_f32_bf16 v55, v183, v183, v55
    v_dot2_f32_bf16 v54, v184, v56, v54
    v_dot2_f32_bf16 v55, v184, v184, v55
    v_dot2_f32_bf16 v54, v185, v56, v54
    v_dot2_f32_bf16 v55, v185, v185, v55
    v_dot2_f32_bf16 v54, v186, v56, v54
    v_dot2_f32_bf16 v55, v186, v186, v55
    v_dot2_f32_bf16 v54, v187, v56, v54
    v_dot2_f32_bf16 v55, v187, v187, v55
    v_dot2_f32_bf16 v54, v188, v56, v54
    v_dot2_f32_bf16 v55, v188, v188, v55
    v_dot2_f32_bf16 v54, v189, v56, v54
    v_dot2_f32_bf16 v55, v189, v189, v55
    v_dot2_f32_bf16 v54, v190, v56, v54
    v_dot2_f32_bf16 v55, v190, v190, v55
    v_dot2_f32_bf16 v54, v191, v56, v54
    v_dot2_f32_bf16 v55, v191, v191, v55
    s_waitcnt vmcnt(6)
    ds_read_b128 v[192:195], v46 offset:16384
    ds_read_b128 v[196:199], v47 offset:16384
    ds_read_b128 v[200:203], v48 offset:16384
    ds_read_b128 v[204:207], v49 offset:16384
    s_waitcnt lgkmcnt(10)
    v_mfma_f32_32x32x16_bf16 v[96:111], a[252:255], v[20:23], v[96:111]
    ds_read_b64_tr_b16 v[20:21], v51 offset:17408
    ds_read_b64_tr_b16 v[22:23], v51 offset:17664
    s_add_u32 m0, s88, 27648
    s_xor_b32 s15, s32, 7
    s_mul_i32 s15, s15, 196608
    s_add_u32 s15, s15, s1
    buffer_load_dwordx4 v45, s[16:19], s15 offen offset:1024 lds
    v_mfma_f32_32x32x16_bf16 v[112:127], a[252:255], v[24:27], v[112:127]
    ds_read_b64_tr_b16 v[24:25], v50 offset:18432
    ds_read_b64_tr_b16 v[26:27], v50 offset:18688
    s_add_u32 m0, s88, 60416
    s_nop 0
    buffer_load_dwordx4 v45, s[16:19], s15 offen offset:2048 lds
    v_lshrrev_b32 v60, 6, v1
    s_waitcnt lgkmcnt(7)
    v_mfma_f32_32x32x16_bf16 v[64:79], v[28:31], v[192:195], v[64:79]
    ds_read_b64_tr_b16 v[28:29], v51 offset:18432
    ds_read_b64_tr_b16 v[30:31], v51 offset:18688
    v_and_b32 v14, 0x30, v1
    v_lshl_add_u32 v60, v60, 10, v14
    s_lshr_b32 s73, s2, 2
    s_and_b32 s67, s2, 3
    s_lshl_b32 s67, s67, 2
    s_add_u32 s67, s67, s28
    v_mfma_f32_32x32x16_bf16 v[80:95], v[32:35], v[192:195], v[80:95]
    ds_read_b64_tr_b16 v[32:33], v50 offset:19456
    ds_read_b64_tr_b16 v[34:35], v50 offset:19712
    s_add_u32 m0, s53, 101376
    s_xor_b32 s63, s0, 768
    buffer_load_dwordx4 v40, s[68:71], s63 offen offset:0 lds
    s_lshl_b32 s7, s73, 15
    s_waitcnt lgkmcnt(6)
    v_mfma_f32_32x32x16_bf16 v[64:79], v[36:39], v[196:199], v[64:79]
    ds_read_b64_tr_b16 v[36:37], v51 offset:19456
    ds_read_b64_tr_b16 v[38:39], v51 offset:19712
    s_barrier
    buffer_load_dwordx4 v41, s[68:71], s63 offen offset:1024 lds
    s_lshl_b32 s6, s67, 6
    s_add_u32 s7, s7, s6
    v_mfma_f32_32x32x16_bf16 v[80:95], v[20:23], v[196:199], v[80:95]
    ds_read_b64_tr_b16 v[20:21], v12 offset:20480
    ds_read_b64_tr_b16 v[22:23], v12 offset:20736
    v_lshrrev_b32 v14, 9, v1
    v_lshlrev_b32 v57, 8, v14
    v_and_b32 v14, 0xc0, v1
    v_add_u32 v57, v57, v14
    v_bfe_u32 v14, v1, 8, 1
    v_lshl_add_u32 v57, v14, 5, v57
    s_waitcnt lgkmcnt(6)
    v_mfma_f32_32x32x16_bf16 v[64:79], v[24:27], v[200:203], v[64:79]
    ds_read_b64_tr_b16 v[24:25], v13 offset:20480
    ds_read_b64_tr_b16 v[26:27], v13 offset:20736
    buffer_load_dwordx4 v42, s[68:71], s63 offen offset:2048 lds
    v_bfe_u32 v14, v1, 4, 2
    v_lshl_add_u32 v57, v14, 3, v57
    v_add_u32 v57, 101376, v57
    v_mfma_f32_32x32x16_bf16 v[80:95], v[28:31], v[200:203], v[80:95]
    ds_read_b64_tr_b16 v[28:29], v50 offset:20480
    ds_read_b64_tr_b16 v[30:31], v50 offset:20736
    buffer_load_dwordx4 v43, s[68:71], s63 offen offset:3072 lds
    v_add_u32 v57, s52, v57
    s_lshr_b32 s3, s67, 1
    s_mul_i32 s3, s3, 229376
    s_waitcnt lgkmcnt(6)
    v_mfma_f32_32x32x16_bf16 v[64:79], v[32:35], v[204:207], v[64:79]
    ds_read_b64_tr_b16 v[32:33], v51 offset:20480
    ds_read_b64_tr_b16 v[34:35], v51 offset:20736
    s_and_b32 s67, s67, 1
    s_lshl_b32 s67, s67, 10
    s_lshl_b32 s73, s73, 12
    s_add_u32 s3, s3, s67
    s_add_u32 s3, s3, s73
    s_add_u32 s3, s3, 5029888
    v_mfma_f32_32x32x16_bf16 v[80:95], v[36:39], v[204:207], v[80:95]
    ds_read_b64_tr_b16 v[36:37], v50 offset:21504
    ds_read_b64_tr_b16 v[38:39], v50 offset:21760
    v_dot2_f32_bf16 v54, v192, v56, v54
    v_dot2_f32_bf16 v55, v192, v192, v55
    v_dot2_f32_bf16 v54, v193, v56, v54
    v_dot2_f32_bf16 v55, v193, v193, v55
    v_dot2_f32_bf16 v54, v194, v56, v54
    v_dot2_f32_bf16 v55, v194, v194, v55
    v_dot2_f32_bf16 v54, v195, v56, v54
    v_dot2_f32_bf16 v55, v195, v195, v55
    v_dot2_f32_bf16 v54, v196, v56, v54
    v_dot2_f32_bf16 v55, v196, v196, v55
    v_dot2_f32_bf16 v54, v197, v56, v54
    v_dot2_f32_bf16 v55, v197, v197, v55
    v_dot2_f32_bf16 v54, v198, v56, v54
    v_dot2_f32_bf16 v55, v198, v198, v55
    v_dot2_f32_bf16 v54, v199, v56, v54
    v_dot2_f32_bf16 v55, v199, v199, v55
    v_dot2_f32_bf16 v54, v200, v56, v54
    v_dot2_f32_bf16 v55, v200, v200, v55
    v_dot2_f32_bf16 v54, v201, v56, v54
    v_dot2_f32_bf16 v55, v201, v201, v55
    v_dot2_f32_bf16 v54, v202, v56, v54
    v_dot2_f32_bf16 v55, v202, v202, v55
    v_dot2_f32_bf16 v54, v203, v56, v54
    v_dot2_f32_bf16 v55, v203, v203, v55
    v_dot2_f32_bf16 v54, v204, v56, v54
    v_dot2_f32_bf16 v55, v204, v204, v55
    v_dot2_f32_bf16 v54, v205, v56, v54
    v_dot2_f32_bf16 v55, v205, v205, v55
    v_dot2_f32_bf16 v54, v206, v56, v54
    v_dot2_f32_bf16 v55, v206, v206, v55
    v_dot2_f32_bf16 v54, v207, v56, v54
    v_dot2_f32_bf16 v55, v207, v207, v55
    s_waitcnt vmcnt(6)
    ds_read_b128 v[208:211], v46 offset:32768
    ds_read_b128 v[212:215], v47 offset:32768
    ds_read_b128 v[216:219], v48 offset:32768
    ds_read_b128 v[220:223], v49 offset:32768
    s_waitcnt lgkmcnt(10)
    v_mfma_f32_32x32x16_bf16 v[96:111], a[252:255], v[20:23], v[96:111]
    ds_read_b64_tr_b16 v[20:21], v51 offset:21504
    ds_read_b64_tr_b16 v[22:23], v51 offset:21760
    s_add_u32 m0, s53, 117760
    s_xor_b32 s63, s0, 896
    buffer_load_dwordx4 v40, s[68:71], s63 offen offset:0 lds
    v_mfma_f32_32x32x16_bf16 v[112:127], a[252:255], v[24:27], v[112:127]
    ds_read_b64_tr_b16 v[24:25], v50 offset:22528
    ds_read_b64_tr_b16 v[26:27], v50 offset:22784
    s_waitcnt lgkmcnt(7)
    v_mfma_f32_32x32x16_bf16 v[64:79], v[28:31], v[208:211], v[64:79]
    ds_read_b64_tr_b16 v[28:29], v51 offset:22528
    ds_read_b64_tr_b16 v[30:31], v51 offset:22784
    buffer_load_dwordx4 v41, s[68:71], s63 offen offset:1024 lds
    v_mfma_f32_32x32x16_bf16 v[80:95], v[32:35], v[208:211], v[80:95]
    ds_read_b64_tr_b16 v[32:33], v50 offset:23552
    ds_read_b64_tr_b16 v[34:35], v50 offset:23808
    s_waitcnt lgkmcnt(6)
    v_mfma_f32_32x32x16_bf16 v[64:79], v[36:39], v[212:215], v[64:79]
    ds_read_b64_tr_b16 v[36:37], v51 offset:23552
    ds_read_b64_tr_b16 v[38:39], v51 offset:23808
    s_barrier
    buffer_load_dwordx4 v42, s[68:71], s63 offen offset:2048 lds
    v_mfma_f32_32x32x16_bf16 v[80:95], v[20:23], v[212:215], v[80:95]
    ds_read_b64_tr_b16 v[20:21], v12 offset:24576
    ds_read_b64_tr_b16 v[22:23], v12 offset:24832
    s_waitcnt lgkmcnt(6)
    v_mfma_f32_32x32x16_bf16 v[64:79], v[24:27], v[216:219], v[64:79]
    ds_read_b64_tr_b16 v[24:25], v13 offset:24576
    ds_read_b64_tr_b16 v[26:27], v13 offset:24832
    buffer_load_dwordx4 v43, s[68:71], s63 offen offset:3072 lds
    v_mfma_f32_32x32x16_bf16 v[80:95], v[28:31], v[216:219], v[80:95]
    ds_read_b64_tr_b16 v[28:29], v50 offset:24576
    ds_read_b64_tr_b16 v[30:31], v50 offset:24832
    s_waitcnt lgkmcnt(6)
    v_mfma_f32_32x32x16_bf16 v[64:79], v[32:35], v[220:223], v[64:79]
    ds_read_b64_tr_b16 v[32:33], v51 offset:24576
    ds_read_b64_tr_b16 v[34:35], v51 offset:24832
    v_mfma_f32_32x32x16_bf16 v[80:95], v[36:39], v[220:223], v[80:95]
    ds_read_b64_tr_b16 v[36:37], v50 offset:25600
    ds_read_b64_tr_b16 v[38:39], v50 offset:25856
    v_dot2_f32_bf16 v54, v208, v56, v54
    v_dot2_f32_bf16 v55, v208, v208, v55
    v_dot2_f32_bf16 v54, v209, v56, v54
    v_dot2_f32_bf16 v55, v209, v209, v55
    v_dot2_f32_bf16 v54, v210, v56, v54
    v_dot2_f32_bf16 v55, v210, v210, v55
    v_dot2_f32_bf16 v54, v211, v56, v54
    v_dot2_f32_bf16 v55, v211, v211, v55
    v_dot2_f32_bf16 v54, v212, v56, v54
    v_dot2_f32_bf16 v55, v212, v212, v55
    v_dot2_f32_bf16 v54, v213, v56, v54
    v_dot2_f32_bf16 v55, v213, v213, v55
    v_dot2_f32_bf16 v54, v214, v56, v54
    v_dot2_f32_bf16 v55, v214, v214, v55
    v_dot2_f32_bf16 v54, v215, v56, v54
    v_dot2_f32_bf16 v55, v215, v215, v55
    v_dot2_f32_bf16 v54, v216, v56, v54
    v_dot2_f32_bf16 v55, v216, v216, v55
    v_dot2_f32_bf16 v54, v217, v56, v54
    v_dot2_f32_bf16 v55, v217, v217, v55
    v_dot2_f32_bf16 v54, v218, v56, v54
    v_dot2_f32_bf16 v55, v218, v218, v55
    v_dot2_f32_bf16 v54, v219, v56, v54
    v_dot2_f32_bf16 v55, v219, v219, v55
    v_dot2_f32_bf16 v54, v220, v56, v54
    v_dot2_f32_bf16 v55, v220, v220, v55
    v_dot2_f32_bf16 v54, v221, v56, v54
    v_dot2_f32_bf16 v55, v221, v221, v55
    v_dot2_f32_bf16 v54, v222, v56, v54
    v_dot2_f32_bf16 v55, v222, v222, v55
    v_dot2_f32_bf16 v54, v223, v56, v54
    v_dot2_f32_bf16 v55, v223, v223, v55
    s_waitcnt vmcnt(4)
    ds_read_b128 v[224:227], v46 offset:0
    ds_read_b128 v[228:231], v47 offset:0
    ds_read_b128 v[232:235], v48 offset:0
    ds_read_b128 v[236:239], v49 offset:0
    s_waitcnt lgkmcnt(10)
    v_mfma_f32_32x32x16_bf16 v[96:111], a[252:255], v[20:23], v[96:111]
    ds_read_b64_tr_b16 v[20:21], v51 offset:25600
    ds_read_b64_tr_b16 v[22:23], v51 offset:25856
    s_add_u32 m0, s88, 67584
    s_xor_b32 s15, s32, 0
    s_mul_i32 s15, s15, 196608
    s_add_u32 s15, s15, s1
    buffer_load_dwordx4 v45, s[16:19], s15 offen offset:0 lds
    v_and_b32 v40, 0x1f0, v1
    v_lshlrev_b32 v40, 1, v40
    s_lshl_b32 s56, s28, 10
    v_mfma_f32_32x32x16_bf16 v[112:127], a[252:255], v[24:27], v[112:127]
    ds_read_b64_tr_b16 v[24:25], v50 offset:26624
    ds_read_b64_tr_b16 v[26:27], v50 offset:26880
    s_add_u32 m0, s88, 71680
    s_xor_b32 s15, s32, 1
    s_mul_i32 s15, s15, 196608
    s_add_u32 s15, s15, s1
    buffer_load_dwordx4 v45, s[16:19], s15 offen offset:0 lds
    s_add_u32 s56, s56, 135168
    v_add_u32 v40, s56, v40
    v_lshrrev_b32 v42, 9, v1
    s_waitcnt lgkmcnt(7)
    v_mfma_f32_32x32x16_bf16 v[64:79], v[28:31], v[224:227], v[64:79]
    ds_read_b64_tr_b16 v[28:29], v51 offset:26624
    ds_read_b64_tr_b16 v[30:31], v51 offset:26880
    s_add_u32 m0, s88, 75776
    s_xor_b32 s15, s32, 2
    s_mul_i32 s15, s15, 196608
    s_add_u32 s15, s15, s1
    buffer_load_dwordx4 v45, s[16:19], s15 offen offset:0 lds
    v_lshl_add_u32 v41, v42, 4, v40
    v_lshl_add_u32 v40, v42, 13, v40
    v_lshrrev_b32 v42, 1, v1
    v_mfma_f32_32x32x16_bf16 v[80:95], v[32:35], v[224:227], v[80:95]
    ds_read_b64_tr_b16 v[32:33], v50 offset:27648
    ds_read_b64_tr_b16 v[34:35], v50 offset:27904
    s_add_u32 m0, s88, 79872
    s_xor_b32 s15, s32, 3
    s_mul_i32 s15, s15, 196608
    s_add_u32 s15, s15, s1
    buffer_load_dwordx4 v45, s[16:19], s15 offen offset:0 lds
    s_lshl_b32 s56, s28, 12
    s_add_u32 s56, s56, 135168
    s_waitcnt lgkmcnt(6)
    v_mfma_f32_32x32x16_bf16 v[64:79], v[36:39], v[228:231], v[64:79]
    ds_read_b64_tr_b16 v[36:37], v51 offset:27648
    ds_read_b64_tr_b16 v[38:39], v51 offset:27904
    s_barrier
    s_lshr_b32 s57, s28, 1
    s_lshl_b32 s57, s57, 12
    s_add_u32 s57, s57, 151552
    v_add_u32 v43, s57, v42
    v_add_u32 v42, s56, v42
    s_lshl_b32 s56, s28, 9
    v_add_u32 v44, s56, v1
    s_lshl_b32 s56, s28, 5
    s_add_u32 s56, s56, 2048
    s_add_u32 s57, s56, 16
    v_mfma_f32_32x32x16_bf16 v[80:95], v[20:23], v[228:231], v[80:95]
    ds_read_b64_tr_b16 v[20:21], v12 offset:28672
    ds_read_b64_tr_b16 v[22:23], v12 offset:28928
    s_add_u32 m0, s88, 83968
    s_xor_b32 s15, s32, 4
    s_mul_i32 s15, s15, 196608
    s_add_u32 s15, s15, s1
    buffer_load_dwordx4 v45, s[16:19], s15 offen offset:0 lds
    v_writelane_b32 v44, s56, 32
    v_writelane_b32 v44, s57, 48
    s_waitcnt lgkmcnt(6)
    v_mfma_f32_32x32x16_bf16 v[64:79], v[24:27], v[232:235], v[64:79]
    ds_read_b64_tr_b16 v[24:25], v13 offset:28672
    ds_read_b64_tr_b16 v[26:27], v13 offset:28928
    s_add_u32 m0, s88, 88064
    s_xor_b32 s15, s32, 5
    s_mul_i32 s15, s15, 196608
    s_add_u32 s15, s15, s1
    buffer_load_dwordx4 v45, s[16:19], s15 offen offset:0 lds
    s_add_u32 s61, s50, 0
    v_mfma_f32_32x32x16_bf16 v[80:95], v[28:31], v[232:235], v[80:95]
    ds_read_b64_tr_b16 v[28:29], v50 offset:28672
    ds_read_b64_tr_b16 v[30:31], v50 offset:28928
    s_add_u32 m0, s88, 92160
    s_xor_b32 s15, s32, 6
    s_mul_i32 s15, s15, 196608
    s_add_u32 s15, s15, s1
    buffer_load_dwordx4 v45, s[16:19], s15 offen offset:0 lds
    s_waitcnt lgkmcnt(6)
    v_mfma_f32_32x32x16_bf16 v[64:79], v[32:35], v[236:239], v[64:79]
    ds_read_b64_tr_b16 v[32:33], v51 offset:28672
    ds_read_b64_tr_b16 v[34:35], v51 offset:28928
    s_add_u32 m0, s88, 96256
    s_xor_b32 s15, s32, 7
    s_mul_i32 s15, s15, 196608
    s_add_u32 s15, s15, s1
    buffer_load_dwordx4 v45, s[16:19], s15 offen offset:0 lds
    v_mfma_f32_32x32x16_bf16 v[80:95], v[36:39], v[236:239], v[80:95]
    ds_read_b64_tr_b16 v[36:37], v50 offset:29696
    ds_read_b64_tr_b16 v[38:39], v50 offset:29952
    v_dot2_f32_bf16 v54, v224, v56, v54
    v_dot2_f32_bf16 v55, v224, v224, v55
    v_dot2_f32_bf16 v54, v225, v56, v54
    v_dot2_f32_bf16 v55, v225, v225, v55
    v_dot2_f32_bf16 v54, v226, v56, v54
    v_dot2_f32_bf16 v55, v226, v226, v55
    v_dot2_f32_bf16 v54, v227, v56, v54
    v_dot2_f32_bf16 v55, v227, v227, v55
    v_dot2_f32_bf16 v54, v228, v56, v54
    v_dot2_f32_bf16 v55, v228, v228, v55
    v_dot2_f32_bf16 v54, v229, v56, v54
    v_dot2_f32_bf16 v55, v229, v229, v55
    v_dot2_f32_bf16 v54, v230, v56, v54
    v_dot2_f32_bf16 v55, v230, v230, v55
    v_dot2_f32_bf16 v54, v231, v56, v54
    v_dot2_f32_bf16 v55, v231, v231, v55
    v_dot2_f32_bf16 v54, v232, v56, v54
    v_dot2_f32_bf16 v55, v232, v232, v55
    v_dot2_f32_bf16 v54, v233, v56, v54
    v_dot2_f32_bf16 v55, v233, v233, v55
    v_dot2_f32_bf16 v54, v234, v56, v54
    v_dot2_f32_bf16 v55, v234, v234, v55
    v_dot2_f32_bf16 v54, v235, v56, v54
    v_dot2_f32_bf16 v55, v235, v235, v55
    v_dot2_f32_bf16 v54, v236, v56, v54
    v_dot2_f32_bf16 v55, v236, v236, v55
    v_dot2_f32_bf16 v54, v237, v56, v54
    v_dot2_f32_bf16 v55, v237, v237, v55
    v_dot2_f32_bf16 v54, v238, v56, v54
    v_dot2_f32_bf16 v55, v238, v238, v55
    v_dot2_f32_bf16 v54, v239, v56, v54
    v_dot2_f32_bf16 v55, v239, v239, v55
    s_waitcnt vmcnt(8)
    ds_read_b128 v[240:243], v46 offset:16384
    ds_read_b128 v[244:247], v47 offset:16384
    ds_read_b128 v[248:251], v48 offset:16384
    ds_read_b128 v[252:255], v49 offset:16384
    s_waitcnt lgkmcnt(10)
    v_mfma_f32_32x32x16_bf16 v[96:111], a[252:255], v[20:23], v[96:111]
    ds_read_b64_tr_b16 v[20:21], v51 offset:29696
    ds_read_b64_tr_b16 v[22:23], v51 offset:29952
    v_mfma_f32_32x32x16_bf16 v[112:127], a[252:255], v[24:27], v[112:127]
    ds_read_b64_tr_b16 v[24:25], v50 offset:30720
    ds_read_b64_tr_b16 v[26:27], v50 offset:30976
    s_waitcnt lgkmcnt(7)
    v_mfma_f32_32x32x16_bf16 v[64:79], v[28:31], v[240:243], v[64:79]
    ds_read_b64_tr_b16 v[28:29], v51 offset:30720
    ds_read_b64_tr_b16 v[30:31], v51 offset:30976
    v_dot2_f32_bf16 v54, v240, v56, v54
    v_dot2_f32_bf16 v55, v240, v240, v55
    v_dot2_f32_bf16 v54, v241, v56, v54
    v_dot2_f32_bf16 v55, v241, v241, v55
    v_dot2_f32_bf16 v54, v242, v56, v54
    v_dot2_f32_bf16 v55, v242, v242, v55
    v_dot2_f32_bf16 v54, v243, v56, v54
    v_dot2_f32_bf16 v55, v243, v243, v55
    s_waitcnt lgkmcnt(8)
    v_dot2_f32_bf16 v54, v244, v56, v54
    v_dot2_f32_bf16 v55, v244, v244, v55
    v_dot2_f32_bf16 v54, v245, v56, v54
    v_dot2_f32_bf16 v55, v245, v245, v55
    v_dot2_f32_bf16 v54, v246, v56, v54
    v_dot2_f32_bf16 v55, v246, v246, v55
    v_dot2_f32_bf16 v54, v247, v56, v54
    v_dot2_f32_bf16 v55, v247, v247, v55
    s_waitcnt lgkmcnt(7)
    v_dot2_f32_bf16 v54, v248, v56, v54
    v_dot2_f32_bf16 v55, v248, v248, v55
    v_dot2_f32_bf16 v54, v249, v56, v54
    v_dot2_f32_bf16 v55, v249, v249, v55
    v_dot2_f32_bf16 v54, v250, v56, v54
    v_dot2_f32_bf16 v55, v250, v250, v55
    v_dot2_f32_bf16 v54, v251, v56, v54
    v_dot2_f32_bf16 v55, v251, v251, v55
    s_waitcnt lgkmcnt(6)
    v_dot2_f32_bf16 v54, v252, v56, v54
    v_dot2_f32_bf16 v55, v252, v252, v55
    v_dot2_f32_bf16 v54, v253, v56, v54
    v_dot2_f32_bf16 v55, v253, v253, v55
    v_dot2_f32_bf16 v54, v254, v56, v54
    v_dot2_f32_bf16 v55, v254, v254, v55
    v_dot2_f32_bf16 v54, v255, v56, v54
    v_dot2_f32_bf16 v55, v255, v255, v55
    v_mfma_f32_32x32x16_bf16 v[80:95], v[32:35], v[240:243], v[80:95]
    ds_read_b64_tr_b16 v[32:33], v50 offset:31744
    ds_read_b64_tr_b16 v[34:35], v50 offset:32000
    s_lshr_b32 s56, s28, 1
    s_lshl_b32 s56, s56, 9
    s_and_b32 s57, s28, 1
    s_lshl_b32 s57, s57, 3
    s_add_u32 s56, s56, s57
    v_cvt_pk_bf16_f32 v100, v96, v96
    v_and_b32 v100, 0xffff0000, v100
    v_sub_f32 v98, v96, v100
    v_cvt_pk_bf16_f32 v98, v100, v98
    v_mov_b32 v99, 0
    v_add_u32 v100, s56, v2
    s_waitcnt lgkmcnt(6)
    v_mfma_f32_32x32x16_bf16 v[64:79], v[36:39], v[244:247], v[64:79]
    ds_read_b64_tr_b16 v[36:37], v51 offset:31744
    ds_read_b64_tr_b16 v[38:39], v51 offset:32000
    s_mov_b32 exec_hi, 0
    ds_write_b64 v100, v[98:99] offset:32768
    s_mov_b64 exec, -1
    v_cvt_pk_bf16_f32 v116, v112, v112
    v_and_b32 v116, 0xffff0000, v116
    v_sub_f32 v114, v112, v116
    v_cvt_pk_bf16_f32 v114, v116, v114
    v_mov_b32 v115, 0
    v_add_u32 v116, s56, v3
    s_mov_b32 exec_hi, 0
    ds_write_b64 v116, v[114:115] offset:32768
    s_mov_b64 exec, -1
    s_waitcnt lgkmcnt(0)
    s_barrier
    v_mfma_f32_32x32x16_bf16 v[80:95], v[20:23], v[244:247], v[80:95]
    ds_read_b128 v[20:23], v2 offset:32768
    v_permlane32_swap_b32 v54, v55
    v_add_f32 v54, v54, v55
    v_mfma_f32_32x32x16_bf16 v[64:79], v[24:27], v[248:251], v[64:79]
    ds_read_b128 v[24:27], v3 offset:32768
    v_mov_b32 v55, v54
    s_nop 1
    v_permlane32_swap_b32 v54, v55
    v_mul_f32 v54, 0xbb000000, v54
    v_mul_f32 v55, 0x3b000000, v55
    v_mfma_f32_32x32x16_bf16 v[80:95], v[28:31], v[248:251], v[80:95]
    v_fma_f32 v55, -v54, v54, v55
    v_cvt_pk_bf16_f32 v16, v54, v54
    v_max_f32 v55, 0, v55
    v_mfma_f32_32x32x16_bf16 v[64:79], v[32:35], v[252:255], v[64:79]
    v_cvt_pk_bf16_f32 v17, v54, v54
    v_add_f32 v55, 0x3727c5ac, v55
    v_cvt_pk_bf16_f32 v18, v54, v54
    v_rsq_f32 v12, v55
    v_mfma_f32_32x32x16_bf16 v[80:95], v[36:39], v[252:255], v[80:95]
    v_cvt_pk_bf16_f32 v19, v54, v54
    v_mul_f32 v13, v55, v12
    v_mul_f32 v58, 0x3fb8aa3b, v12
    s_waitcnt lgkmcnt(0)
    v_mfma_f32_32x32x16_bf16 v[64:79], v[20:23], v[16:19], v[64:79]
    v_mfma_f32_32x32x16_bf16 v[80:95], v[24:27], v[16:19], v[80:95]
    s_mov_b32 s68, s96
    s_mov_b32 s69, s97
    s_nop 8
    v_cvt_pk_bf16_f32 v20, v64, v65
    v_cvt_pk_bf16_f32 v21, v66, v67
    v_cvt_pk_bf16_f32 v22, v68, v69
    v_cvt_pk_bf16_f32 v23, v70, v71
    v_cvt_pk_bf16_f32 v24, v72, v73
    v_cvt_pk_bf16_f32 v25, v74, v75
    v_cvt_pk_bf16_f32 v26, v76, v77
    v_cvt_pk_bf16_f32 v27, v78, v79
    v_mfma_f32_32x32x16_bf16 v[112:127], a[240:243], v[20:23], 0
    s_nop 0
    v_mfma_f32_32x32x16_bf16 v[112:127], a[244:247], v[24:27], v[112:127]
    s_mov_b32 s60, 65536
    buffer_load_dwordx2 v[62:63], v53, s[8:11], s60 offen sc1
    v_pk_mul_f32 v[80:81], v[80:81], v[12:13] op_sel:[0,0] op_sel_hi:[1,0]
    v_pk_mul_f32 v[82:83], v[82:83], v[12:13] op_sel:[0,0] op_sel_hi:[1,0]
    v_pk_mul_f32 v[84:85], v[84:85], v[12:13] op_sel:[0,0] op_sel_hi:[1,0]
    v_pk_mul_f32 v[86:87], v[86:87], v[12:13] op_sel:[0,0] op_sel_hi:[1,0]
    v_pk_mul_f32 v[88:89], v[88:89], v[12:13] op_sel:[0,0] op_sel_hi:[1,0]
    v_pk_mul_f32 v[90:91], v[90:91], v[12:13] op_sel:[0,0] op_sel_hi:[1,0]
    v_pk_mul_f32 v[92:93], v[92:93], v[12:13] op_sel:[0,0] op_sel_hi:[1,0]
    v_pk_mul_f32 v[94:95], v[94:95], v[12:13] op_sel:[0,0] op_sel_hi:[1,0]
    v_cvt_pk_bf16_f32 v28, v80, v81
    v_cvt_pk_bf16_f32 v29, v82, v83
    v_cvt_pk_bf16_f32 v30, v84, v85
    v_cvt_pk_bf16_f32 v31, v86, v87
    v_cvt_pk_bf16_f32 v32, v88, v89
    v_cvt_pk_bf16_f32 v33, v90, v91
    v_cvt_pk_bf16_f32 v34, v92, v93
    s_add_u32 m0, s52, 101376
    s_add_u32 s6, s7, 15360
    buffer_load_dwordx4 v60, s[20:23], s7 offen lds
    v_cvt_pk_bf16_f32 v35, v94, v95
    ds_write_b128 v41, v[28:31] offset:16384
    ds_write_b128 v41, v[32:35] offset:20480
    v_max3_f32 v14, v112, v113, v114
    v_min3_f32 v15, v112, v113, v114
    v_max3_f32 v14, v14, v115, v116
    v_min3_f32 v15, v15, v115, v116
    v_max3_f32 v14, v14, v117, v118
    v_min3_f32 v15, v15, v117, v118
    v_max3_f32 v14, v14, v119, v120
    v_min3_f32 v15, v15, v119, v120
    v_max3_f32 v14, v14, v121, v122
    v_min3_f32 v15, v15, v121, v122
    v_max3_f32 v14, v14, v123, v124
    v_min3_f32 v15, v15, v123, v124
    buffer_load_dwordx4 v60, s[20:23], s6 offen offset:1024 lds
    v_max3_f32 v14, v14, v125, v126
    v_min3_f32 v15, v15, v125, v126
    v_max_f32 v14, v14, v127
    v_min_f32 v15, v15, v127
    v_pk_mul_f32 v[14:15], v[14:15], v[58:59] op_sel:[0,0] op_sel_hi:[1,0]
    v_pk_fma_f32 v[64:65], v[112:113], v[58:59], v[14:15] op_sel:[0,0,0] op_sel_hi:[1,0,0] neg_lo:[0,0,1] neg_hi:[0,0,1]
    v_pk_fma_f32 v[66:67], v[114:115], v[58:59], v[14:15] op_sel:[0,0,0] op_sel_hi:[1,0,0] neg_lo:[0,0,1] neg_hi:[0,0,1]
    v_pk_fma_f32 v[68:69], v[116:117], v[58:59], v[14:15] op_sel:[0,0,0] op_sel_hi:[1,0,0] neg_lo:[0,0,1] neg_hi:[0,0,1]
    v_pk_fma_f32 v[70:71], v[118:119], v[58:59], v[14:15] op_sel:[0,0,0] op_sel_hi:[1,0,0] neg_lo:[0,0,1] neg_hi:[0,0,1]
    v_pk_fma_f32 v[72:73], v[120:121], v[58:59], v[14:15] op_sel:[0,0,0] op_sel_hi:[1,0,0] neg_lo:[0,0,1] neg_hi:[0,0,1]
    v_pk_fma_f32 v[74:75], v[122:123], v[58:59], v[14:15] op_sel:[0,0,0] op_sel_hi:[1,0,0] neg_lo:[0,0,1] neg_hi:[0,0,1]
    v_pk_fma_f32 v[76:77], v[124:125], v[58:59], v[14:15] op_sel:[0,0,0] op_sel_hi:[1,0,0] neg_lo:[0,0,1] neg_hi:[0,0,1]
    v_pk_fma_f32 v[78:79], v[126:127], v[58:59], v[14:15] op_sel:[0,0,0] op_sel_hi:[1,0,0] neg_lo:[0,0,1] neg_hi:[0,0,1]
    v_exp_f32 v64, v64
    v_exp_f32 v65, v65
    buffer_load_dword v61, v61, s[8:11], 0 offen sc1
    v_exp_f32 v66, v66
    v_exp_f32 v67, v67
    v_exp_f32 v68, v68
    v_exp_f32 v69, v69
    v_exp_f32 v70, v70
    v_exp_f32 v71, v71
    v_exp_f32 v72, v72
    v_exp_f32 v73, v73
    v_exp_f32 v74, v74
    v_exp_f32 v75, v75
    v_exp_f32 v76, v76
    v_exp_f32 v77, v77
    v_exp_f32 v78, v78
    v_exp_f32 v79, v79
    v_pk_add_f32 v[36:37], v[64:65], v[66:67] op_sel:[0,0] op_sel_hi:[1,1]
    v_pk_add_f32 v[36:37], v[36:37], v[68:69] op_sel:[0,0] op_sel_hi:[1,1]
    v_pk_add_f32 v[36:37], v[36:37], v[70:71] op_sel:[0,0] op_sel_hi:[1,1]
    v_pk_add_f32 v[36:37], v[36:37], v[72:73] op_sel:[0,0] op_sel_hi:[1,1]
    v_pk_add_f32 v[36:37], v[36:37], v[74:75] op_sel:[0,0] op_sel_hi:[1,1]
    v_pk_add_f32 v[36:37], v[36:37], v[76:77] op_sel:[0,0] op_sel_hi:[1,1]
    v_pk_add_f32 v[36:37], v[36:37], v[78:79] op_sel:[0,0] op_sel_hi:[1,1]
    v_add_f32 v36, v36, v37
    v_rcp_f32 v36, v36
    s_nop 0
    v_pk_mul_f32 v[64:65], v[64:65], v[36:37] op_sel:[0,0] op_sel_hi:[1,0]
    v_pk_mul_f32 v[66:67], v[66:67], v[36:37] op_sel:[0,0] op_sel_hi:[1,0]
    v_pk_mul_f32 v[68:69], v[68:69], v[36:37] op_sel:[0,0] op_sel_hi:[1,0]
    v_pk_mul_f32 v[70:71], v[70:71], v[36:37] op_sel:[0,0] op_sel_hi:[1,0]
    v_pk_mul_f32 v[72:73], v[72:73], v[36:37] op_sel:[0,0] op_sel_hi:[1,0]
    v_pk_mul_f32 v[74:75], v[74:75], v[36:37] op_sel:[0,0] op_sel_hi:[1,0]
    v_pk_mul_f32 v[76:77], v[76:77], v[36:37] op_sel:[0,0] op_sel_hi:[1,0]
    v_pk_mul_f32 v[78:79], v[78:79], v[36:37] op_sel:[0,0] op_sel_hi:[1,0]
    v_cvt_pk_bf16_f32 v96, v64, v65
    v_cvt_pk_bf16_f32 v97, v66, v67
    v_cvt_pk_bf16_f32 v98, v68, v69
    v_cvt_pk_bf16_f32 v99, v70, v71
    v_cvt_pk_bf16_f32 v100, v72, v73
    v_cvt_pk_bf16_f32 v101, v74, v75
    v_cvt_pk_bf16_f32 v102, v76, v77
    v_cvt_pk_bf16_f32 v103, v78, v79
    ds_write_b128 v40, v[96:99]
    ds_write_b128 v40, v[100:103] offset:16
    v_pk_fma_f32 v[80:81], v[112:113], v[58:59], v[14:15] op_sel:[0,0,1] op_sel_hi:[1,0,1] neg_lo:[1,0,0] neg_hi:[1,0,0]
    v_pk_fma_f32 v[82:83], v[114:115], v[58:59], v[14:15] op_sel:[0,0,1] op_sel_hi:[1,0,1] neg_lo:[1,0,0] neg_hi:[1,0,0]
    v_pk_fma_f32 v[84:85], v[116:117], v[58:59], v[14:15] op_sel:[0,0,1] op_sel_hi:[1,0,1] neg_lo:[1,0,0] neg_hi:[1,0,0]
    v_pk_fma_f32 v[86:87], v[118:119], v[58:59], v[14:15] op_sel:[0,0,1] op_sel_hi:[1,0,1] neg_lo:[1,0,0] neg_hi:[1,0,0]
    v_pk_fma_f32 v[88:89], v[120:121], v[58:59], v[14:15] op_sel:[0,0,1] op_sel_hi:[1,0,1] neg_lo:[1,0,0] neg_hi:[1,0,0]
    v_pk_fma_f32 v[90:91], v[122:123], v[58:59], v[14:15] op_sel:[0,0,1] op_sel_hi:[1,0,1] neg_lo:[1,0,0] neg_hi:[1,0,0]
    v_pk_fma_f32 v[92:93], v[124:125], v[58:59], v[14:15] op_sel:[0,0,1] op_sel_hi:[1,0,1] neg_lo:[1,0,0] neg_hi:[1,0,0]
    v_pk_fma_f32 v[94:95], v[126:127], v[58:59], v[14:15] op_sel:[0,0,1] op_sel_hi:[1,0,1] neg_lo:[1,0,0] neg_hi:[1,0,0]
    v_exp_f32 v80, v80
    v_exp_f32 v81, v81
    v_exp_f32 v82, v82
    v_exp_f32 v83, v83
    v_exp_f32 v84, v84
    v_exp_f32 v85, v85
    v_exp_f32 v86, v86
    v_exp_f32 v87, v87
    v_exp_f32 v88, v88
    v_exp_f32 v89, v89
    v_exp_f32 v90, v90
    v_exp_f32 v91, v91
    v_exp_f32 v92, v92
    v_exp_f32 v93, v93
    v_exp_f32 v94, v94
    v_exp_f32 v95, v95
    v_pk_add_f32 v[38:39], v[80:81], v[82:83] op_sel:[0,0] op_sel_hi:[1,1]
    v_pk_add_f32 v[38:39], v[38:39], v[84:85] op_sel:[0,0] op_sel_hi:[1,1]
    v_pk_add_f32 v[38:39], v[38:39], v[86:87] op_sel:[0,0] op_sel_hi:[1,1]
    v_pk_add_f32 v[38:39], v[38:39], v[88:89] op_sel:[0,0] op_sel_hi:[1,1]
    v_pk_add_f32 v[38:39], v[38:39], v[90:91] op_sel:[0,0] op_sel_hi:[1,1]
    v_pk_add_f32 v[38:39], v[38:39], v[92:93] op_sel:[0,0] op_sel_hi:[1,1]
    v_pk_add_f32 v[38:39], v[38:39], v[94:95] op_sel:[0,0] op_sel_hi:[1,1]
    v_add_f32 v38, v38, v39
    v_rcp_f32 v38, v38
    s_nop 0
    v_pk_mul_f32 v[80:81], v[80:81], v[38:39] op_sel:[0,0] op_sel_hi:[1,0]
    v_pk_mul_f32 v[82:83], v[82:83], v[38:39] op_sel:[0,0] op_sel_hi:[1,0]
    v_pk_mul_f32 v[84:85], v[84:85], v[38:39] op_sel:[0,0] op_sel_hi:[1,0]
    v_pk_mul_f32 v[86:87], v[86:87], v[38:39] op_sel:[0,0] op_sel_hi:[1,0]
    v_pk_mul_f32 v[88:89], v[88:89], v[38:39] op_sel:[0,0] op_sel_hi:[1,0]
    v_pk_mul_f32 v[90:91], v[90:91], v[38:39] op_sel:[0,0] op_sel_hi:[1,0]
    v_pk_mul_f32 v[92:93], v[92:93], v[38:39] op_sel:[0,0] op_sel_hi:[1,0]
    v_pk_mul_f32 v[94:95], v[94:95], v[38:39] op_sel:[0,0] op_sel_hi:[1,0]
    v_cvt_pk_bf16_f32 v104, v80, v81
    v_cvt_pk_bf16_f32 v105, v82, v83
    v_cvt_pk_bf16_f32 v106, v84, v85
    v_cvt_pk_bf16_f32 v107, v86, v87
    ds_write_b128 v40, v[104:107] offset:4096
    v_cvt_pk_bf16_f32 v108, v88, v89
    v_cvt_pk_bf16_f32 v109, v90, v91
    v_cvt_pk_bf16_f32 v110, v92, v93
    v_cvt_pk_bf16_f32 v111, v94, v95
    ds_write_b128 v40, v[108:111] offset:4112
    s_waitcnt lgkmcnt(0)
    s_barrier
    ds_read_b64_tr_b16 v[64:65], v42 offset:0
    ds_read_b64_tr_b16 v[80:81], v43 offset:0
    ds_read_b64_tr_b16 v[66:67], v42 offset:512
    ds_read_b64_tr_b16 v[82:83], v43 offset:512
    ds_read_b64_tr_b16 v[68:69], v42 offset:1024
    ds_read_b64_tr_b16 v[84:85], v43 offset:1024
    ds_read_b64_tr_b16 v[70:71], v42 offset:1536
    ds_read_b64_tr_b16 v[86:87], v43 offset:1536
    ds_read_b64_tr_b16 v[72:73], v42 offset:2048
    ds_read_b64_tr_b16 v[88:89], v43 offset:2048
    ds_read_b64_tr_b16 v[74:75], v42 offset:2560
    ds_read_b64_tr_b16 v[90:91], v43 offset:2560
    ds_read_b64_tr_b16 v[76:77], v42 offset:3072
    ds_read_b64_tr_b16 v[92:93], v43 offset:3072
    ds_read_b64_tr_b16 v[78:79], v42 offset:3584
    ds_read_b64_tr_b16 v[94:95], v43 offset:3584
    s_waitcnt lgkmcnt(13)
    v_mfma_f32_16x16x32_bf16 v[116:119], v[64:67], a[252:255], 0
    s_waitcnt lgkmcnt(12)
    v_mfma_f32_16x16x32_bf16 v[112:115], v[64:67], v[80:83], 0
    s_waitcnt lgkmcnt(9)
    v_mfma_f32_16x16x32_bf16 v[116:119], v[68:71], a[252:255], v[116:119]
    s_waitcnt lgkmcnt(8)
    v_mfma_f32_16x16x32_bf16 v[112:115], v[68:71], v[84:87], v[112:115]
    s_waitcnt lgkmcnt(5)
    v_mfma_f32_16x16x32_bf16 v[116:119], v[72:75], a[252:255], v[116:119]
    s_waitcnt lgkmcnt(4)
    v_mfma_f32_16x16x32_bf16 v[112:115], v[72:75], v[88:91], v[112:115]
    s_waitcnt lgkmcnt(1)
    v_mfma_f32_16x16x32_bf16 v[116:119], v[76:79], a[252:255], v[116:119]
    s_waitcnt lgkmcnt(0)
    v_mfma_f32_16x16x32_bf16 v[112:115], v[76:79], v[92:95], v[112:115]
    s_nop 5
    v_cvt_pk_bf16_f32 v122, v116, v117
    v_cvt_pk_bf16_f32 v123, v118, v119
    v_cvt_pk_bf16_f32 v120, v112, v113
    v_cvt_pk_bf16_f32 v121, v114, v115
    s_nop 0
    v_permlane32_swap_b32 v120, v122
    v_permlane32_swap_b32 v121, v123
    v_min_u32 v120, -2, v120
    v_min_u32 v123, -2, v123
    s_mov_b32 exec_hi, 0x00010001
    buffer_store_dwordx4 v[120:123], v44, s[8:11], s61 offen sc1
    s_mov_b64 exec, -1
    v_add_u32 v50, s88, v52
    s_mov_b32 s62, 0
    s_waitcnt vmcnt(4)
TG_1:
    v_and_b32 v14, 0xfffffff0, v63
    v_cmp_ne_u32 vcc, s34, v62
    v_cmp_ne_u32 s[58:59], s35, v14
    s_nop 0
    s_or_b64 s[58:59], vcc, s[58:59]
    s_cbranch_scc0 TGOK_2
    s_sleep 6
    buffer_load_dwordx2 v[62:63], v53, s[8:11], s60 offen sc1
    s_add_u32 s62, s62, 1
    s_cmp_gt_u32 s62, 0x80000
    s_cbranch_scc1 L_fail
    s_waitcnt vmcnt(0)
    s_branch TG_1
    TGOK_2:
    s_barrier
    buffer_load_dword v63, v59, s[8:11], s60 offen offset:4 sc1
    ds_read_b64_tr_b16 v[20:21], v50 offset:0
    ds_read_b64_tr_b16 v[22:23], v50 offset:256
    ds_read_b64_tr_b16 v[24:25], v50 offset:4096
    ds_read_b64_tr_b16 v[26:27], v50 offset:4352
    ds_read_b64_tr_b16 v[28:29], v50 offset:8192
    ds_read_b64_tr_b16 v[30:31], v50 offset:8448
    ds_read_b64_tr_b16 v[32:33], v50 offset:12288
    ds_read_b64_tr_b16 v[34:35], v50 offset:12544
    ds_read_b64_tr_b16 v[36:37], v50 offset:16384
    ds_read_b64_tr_b16 v[38:39], v50 offset:16640
    s_waitcnt lgkmcnt(8)
    v_mfma_f32_32x32x16_bf16 v[64:79], a[252:255], v[20:23], 0
    ds_read_b64_tr_b16 v[20:21], v50 offset:20480
    ds_read_b64_tr_b16 v[22:23], v50 offset:20736
    v_add_u32 v54, s52, v2
    s_add_u32 s60, s14, 0
    v_add_u32 v55, s60, v11
    ds_read_b128 a[128:131], v54 offset:0
    s_waitcnt lgkmcnt(9)
    v_mfma_f32_32x32x16_bf16 v[64:79], a[252:255], v[24:27], v[64:79]
    ds_read_b64_tr_b16 v[24:25], v50 offset:24576
    ds_read_b64_tr_b16 v[26:27], v50 offset:24832
    ds_read_b128 a[132:135], v54 offset:1024
    ds_read_b128 a[136:139], v54 offset:2048
    s_waitcnt lgkmcnt(9)
    v_mfma_f32_32x32x16_bf16 v[64:79], a[252:255], v[28:31], v[64:79]
    ds_read_b64_tr_b16 v[28:29], v50 offset:28672
    ds_read_b64_tr_b16 v[30:31], v50 offset:28928
    ds_read_b128 a[140:143], v54 offset:3072
    ds_read_b128 a[144:147], v54 offset:4096
    ds_read_b128 a[148:151], v54 offset:5120
    ds_read_b128 a[152:155], v54 offset:6144
    v_mfma_f32_32x32x16_bf16 v[64:79], a[252:255], v[32:35], v[64:79]
    ds_read_b64_tr_b16 v[32:33], v52 offset:0
    ds_read_b64_tr_b16 v[34:35], v52 offset:256
    s_waitcnt vmcnt(3)
    ds_read_b64_tr_b16 a[0:1], v57 offset:0
    ds_read_b64_tr_b16 a[2:3], v57 offset:512
    ds_read_b64_tr_b16 a[4:5], v57 offset:1024
    ds_read_b64_tr_b16 a[6:7], v57 offset:1536
    s_waitcnt lgkmcnt(14)
    v_mfma_f32_32x32x16_bf16 v[64:79], a[252:255], v[36:39], v[64:79]
    ds_read_b64_tr_b16 v[36:37], v52 offset:1024
    ds_read_b64_tr_b16 v[38:39], v52 offset:1280
    ds_read_b128 a[156:159], v54 offset:7168
    v_mfma_f32_32x32x16_bf16 v[64:79], a[252:255], v[20:23], v[64:79]
    ds_read_b64_tr_b16 v[20:21], v52 offset:2048
    ds_read_b64_tr_b16 v[22:23], v52 offset:2304
    ds_read_b32 a124, v55
    v_add_u32 v54, s52, v3
    s_waitcnt lgkmcnt(14)
    v_mfma_f32_32x32x16_bf16 v[64:79], a[252:255], v[24:27], v[64:79]
    ds_read_b64_tr_b16 v[24:25], v52 offset:3072
    ds_read_b64_tr_b16 v[26:27], v52 offset:3328
    s_add_u32 s60, s14, 33792
    v_add_u32 v55, s60, v11
    ds_read_b128 a[160:163], v54 offset:0
    ds_read_b128 a[164:167], v54 offset:1024
    ds_read_b128 a[168:171], v54 offset:2048
    v_mfma_f32_32x32x16_bf16 v[64:79], a[252:255], v[28:31], v[64:79]
    ds_read_b64_tr_b16 v[28:29], v52 offset:4096
    ds_read_b64_tr_b16 v[30:31], v52 offset:4352
    s_waitcnt lgkmcnt(14)
    buffer_store_dwordx4 a[0:3], v1, s[24:27], s3 offen offset:0 sc1
    s_waitcnt lgkmcnt(11)
    v_mfma_f32_32x32x16_bf16 v[96:111], v[32:35], v[128:131], 0
    ds_read_b64_tr_b16 v[32:33], v52 offset:5120
    ds_read_b64_tr_b16 v[34:35], v52 offset:5376
    buffer_store_dwordx4 a[4:7], v1, s[24:27], s3 offen offset:2048 sc1
    ds_read_b128 a[172:175], v54 offset:3072
    ds_read_b128 a[176:179], v54 offset:4096
    v_mfma_f32_32x32x16_bf16 v[96:111], v[36:39], v[132:135], v[96:111]
    ds_read_b64_tr_b16 v[36:37], v52 offset:6144
    ds_read_b64_tr_b16 v[38:39], v52 offset:6400
    s_add_u32 m0, s52, 101376
    s_add_u32 s63, s47, 0
    buffer_load_dwordx4 v1, s[8:11], s63 offen offset:0 lds
    s_waitcnt lgkmcnt(11)
    v_mfma_f32_32x32x16_bf16 v[96:111], v[20:23], v[136:139], v[96:111]
    ds_read_b64_tr_b16 v[20:21], v52 offset:7168
    ds_read_b64_tr_b16 v[22:23], v52 offset:7424
    ds_read_b128 a[180:183], v54 offset:5120
    ds_read_b128 a[184:187], v54 offset:6144
    v_mfma_f32_32x32x16_bf16 v[96:111], v[24:27], v[140:143], v[96:111]
    ds_read_b64_tr_b16 v[24:25], v52 offset:8192
    ds_read_b64_tr_b16 v[26:27], v52 offset:8448
    buffer_load_dwordx4 v1, s[8:11], s63 offen offset:1024 lds
    ds_read_b128 a[188:191], v54 offset:7168
    s_waitcnt lgkmcnt(11)
    v_mfma_f32_32x32x16_bf16 v[96:111], v[28:31], v[144:147], v[96:111]
    ds_read_b64_tr_b16 v[28:29], v52 offset:9216
    ds_read_b64_tr_b16 v[30:31], v52 offset:9472
    s_lshr_b32 s56, s28, 1
    s_lshl_b32 s56, s56, 9
    s_and_b32 s57, s28, 1
    s_lshl_b32 s57, s57, 3
    s_add_u32 s56, s56, s57
    v_mfma_f32_32x32x16_bf16 v[96:111], v[32:35], v[148:151], v[96:111]
    ds_read_b64_tr_b16 v[32:33], v52 offset:10240
    ds_read_b64_tr_b16 v[34:35], v52 offset:10496
    buffer_load_dwordx4 v1, s[8:11], s63 offen offset:2048 lds
    s_waitcnt lgkmcnt(9)
    v_mfma_f32_32x32x16_bf16 v[96:111], v[36:39], v[152:155], v[96:111]
    ds_read_b64_tr_b16 v[36:37], v52 offset:11264
    ds_read_b64_tr_b16 v[38:39], v52 offset:11520
    v_cvt_pk_bf16_f32 v68, v64, v64
    v_and_b32 v68, 0xffff0000, v68
    v_sub_f32 v66, v64, v68
    v_cvt_pk_bf16_f32 v66, v68, v66
    v_mfma_f32_32x32x16_bf16 v[96:111], v[20:23], v[156:159], v[96:111]
    ds_read_b64_tr_b16 v[20:21], v52 offset:12288
    ds_read_b64_tr_b16 v[22:23], v52 offset:12544
    buffer_load_dwordx4 v1, s[8:11], s63 offen offset:3072 lds
    s_waitcnt lgkmcnt(6)
    v_mfma_f32_32x32x16_bf16 v[96:111], v[24:27], v[160:163], v[96:111]
    ds_read_b64_tr_b16 v[24:25], v52 offset:13312
    ds_read_b64_tr_b16 v[26:27], v52 offset:13568
    v_mov_b32 v67, 0
    v_add_u32 v68, s56, v4
    s_mov_b32 exec_hi, 0
    ds_write_b64 v68, v[66:67] offset:32768
    s_mov_b64 exec, -1
    v_mfma_f32_32x32x16_bf16 v[96:111], v[28:31], v[164:167], v[96:111]
    ds_read_b64_tr_b16 v[28:29], v52 offset:14336
    ds_read_b64_tr_b16 v[30:31], v52 offset:14592
    s_add_u32 m0, s52, 105472
    s_add_u32 s63, s47, 4096
    buffer_load_dwordx4 v1, s[8:11], s63 offen offset:0 lds
    s_waitcnt lgkmcnt(7)
    v_mfma_f32_32x32x16_bf16 v[96:111], v[32:35], v[168:171], v[96:111]
    ds_read_b64_tr_b16 v[32:33], v52 offset:15360
    ds_read_b64_tr_b16 v[34:35], v52 offset:15616
    s_waitcnt lgkmcnt(0)
    s_barrier
    v_mfma_f32_32x32x16_bf16 v[96:111], v[36:39], v[172:175], v[96:111]
    ds_read_b64_tr_b16 v[36:37], v52 offset:16384
    ds_read_b64_tr_b16 v[38:39], v52 offset:16640
    buffer_load_dwordx4 v1, s[8:11], s63 offen offset:1024 lds
    v_mfma_f32_32x32x16_bf16 v[96:111], v[20:23], v[176:179], v[96:111]
    ds_read_b64_tr_b16 v[20:21], v52 offset:17408
    ds_read_b64_tr_b16 v[22:23], v52 offset:17664
    v_lshrrev_b32 v40, 9, v1
    v_mul_u32_u24 v40, 2176, v40
    v_and_b32 v41, 0x1f0, v1
    v_mfma_f32_32x32x16_bf16 v[96:111], v[24:27], v[180:183], v[96:111]
    ds_read_b64_tr_b16 v[24:25], v52 offset:18432
    ds_read_b64_tr_b16 v[26:27], v52 offset:18688
    buffer_load_dwordx4 v1, s[8:11], s63 offen offset:2048 lds
    v_add_u32 v40, v40, v41
    v_mfma_f32_32x32x16_bf16 v[96:111], v[28:31], v[184:187], v[96:111]
    ds_read_b64_tr_b16 v[28:29], v52 offset:19456
    ds_read_b64_tr_b16 v[30:31], v52 offset:19712
    s_lshl_b32 s56, s28, 9
    v_add_u32 v40, s56, v40
    s_add_u32 s57, s56, 159744
    v_mfma_f32_32x32x16_bf16 v[96:111], v[32:35], v[188:191], v[96:111]
    ds_read_b64_tr_b16 v[32:33], v52 offset:20480
    ds_read_b64_tr_b16 v[34:35], v52 offset:20736
    buffer_load_dwordx4 v1, s[8:11], s63 offen offset:3072 lds
    v_add_u32 v43, s57, v41
    s_waitcnt lgkmcnt(6)
    v_mfma_f32_32x32x16_bf16 v[96:111], v[36:39], v[192:195], v[96:111]
    ds_read_b64_tr_b16 v[36:37], v52 offset:21504
    ds_read_b64_tr_b16 v[38:39], v52 offset:21760
    v_bfe_u32 v41, v1, 4, 4
    v_mul_u32_u24 v41, 2176, v41
    v_bfe_u32 v14, v1, 8, 1
    v_mfma_f32_32x32x16_bf16 v[96:111], v[20:23], v[196:199], v[96:111]
    ds_read_b64_tr_b16 v[20:21], v52 offset:22528
    ds_read_b64_tr_b16 v[22:23], v52 offset:22784
    s_add_u32 m0, s14, 101376
    s_add_u32 s63, s46, 0
    buffer_load_dword v11, s[8:11], s63 offen lds
    s_waitcnt lgkmcnt(6)
    v_mfma_f32_32x32x16_bf16 v[96:111], v[24:27], v[200:203], v[96:111]
    ds_read_b64_tr_b16 v[24:25], v52 offset:23552
    ds_read_b64_tr_b16 v[26:27], v52 offset:23808
    v_lshl_add_u32 v41, v14, 4, v41
    v_mov_b32 v168, 0
    v_mov_b32 v169, 0
    v_mov_b32 v170, 0
    v_mov_b32 v171, 0
    v_mov_b32 v172, 0
    v_mfma_f32_32x32x16_bf16 v[96:111], v[28:31], v[204:207], v[96:111]
    ds_read_b64_tr_b16 v[28:29], v52 offset:24576
    ds_read_b64_tr_b16 v[30:31], v52 offset:24832
    s_lshl_b32 s56, s28, 5
    s_add_u32 s56, s56, 2048
    ds_read_b32 a125, v55
    v_mov_b32 v173, 0
    s_waitcnt lgkmcnt(7)
    v_mfma_f32_32x32x16_bf16 v[96:111], v[32:35], v[208:211], v[96:111]
    ds_read_b64_tr_b16 v[32:33], v52 offset:25600
    ds_read_b64_tr_b16 v[34:35], v52 offset:25856
    v_add_u32 v41, s56, v41
    v_and_b32 v42, 0x130, v1
    v_bfe_u32 v14, v1, 6, 1
    v_lshl_add_u32 v42, v14, 7, v42
    v_mov_b32 v174, 0
    v_mov_b32 v175, 0
    v_mfma_f32_32x32x16_bf16 v[96:111], v[36:39], v[212:215], v[96:111]
    ds_read_b64_tr_b16 v[36:37], v52 offset:26624
    ds_read_b64_tr_b16 v[38:39], v52 offset:26880
    v_bfe_u32 v14, v1, 7, 1
    v_lshl_add_u32 v42, v14, 6, v42
    v_mov_b32 v176, 0
    v_mov_b32 v177, 0
    v_mov_b32 v178, 0
    s_waitcnt lgkmcnt(7)
    v_mfma_f32_32x32x16_bf16 v[96:111], v[20:23], v[216:219], v[96:111]
    ds_read_b64_tr_b16 v[20:21], v52 offset:27648
    ds_read_b64_tr_b16 v[22:23], v52 offset:27904
    v_lshrrev_b32 v14, 9, v1
    v_lshl_add_u32 v42, v14, 3, v42
    v_add_u32 v42, s57, v42
    v_and_b32 v44, 0xf0, v1
    v_mov_b32 v179, 0
    v_mfma_f32_32x32x16_bf16 v[96:111], v[24:27], v[220:223], v[96:111]
    ds_read_b64_tr_b16 v[24:25], v52 offset:28672
    ds_read_b64_tr_b16 v[26:27], v52 offset:28928
    v_lshl_add_u32 v44, v14, 10, v44
    v_add_u32 v44, 159744, v44
    v_mov_b32 v180, 0
    v_mov_b32 v181, 0
    v_mov_b32 v182, 0
    s_waitcnt lgkmcnt(6)
    v_mfma_f32_32x32x16_bf16 v[96:111], v[28:31], v[224:227], v[96:111]
    ds_read_b64_tr_b16 v[28:29], v52 offset:29696
    ds_read_b64_tr_b16 v[30:31], v52 offset:29952
    s_add_u32 s64, s51, 0
    buffer_load_dwordx4 v[128:131], v41, s[8:11], s64 offen sc1
    v_mov_b32 v183, 0
    v_mov_b32 v184, 0
    v_mov_b32 v185, 0
    v_mfma_f32_32x32x16_bf16 v[96:111], v[32:35], v[228:231], v[96:111]
    ds_read_b64_tr_b16 v[32:33], v52 offset:30720
    ds_read_b64_tr_b16 v[34:35], v52 offset:30976
    buffer_load_dwordx4 v[132:135], v40, s[8:11], s64 offen sc1
    v_mov_b32 v186, 0
    v_mov_b32 v187, 0
    s_waitcnt lgkmcnt(6)
    v_mfma_f32_32x32x16_bf16 v[96:111], v[36:39], v[232:235], v[96:111]
    ds_read_b64_tr_b16 v[36:37], v52 offset:31744
    ds_read_b64_tr_b16 v[38:39], v52 offset:32000
    s_add_u32 s64, s51, 4352
    buffer_load_dwordx4 v[136:139], v40, s[8:11], s64 offen sc1
    v_mov_b32 v188, 0
    v_mov_b32 v189, 0
    v_mov_b32 v190, 0
    v_mfma_f32_32x32x16_bf16 v[96:111], v[20:23], v[236:239], v[96:111]
    ds_read_b128 v[20:23], v4 offset:32768
    s_add_u32 s64, s51, 8704
    buffer_load_dwordx4 v[140:143], v40, s[8:11], s64 offen sc1
    v_mov_b32 v191, 0
    v_mov_b32 v192, 0
    s_waitcnt lgkmcnt(5)
    v_mfma_f32_32x32x16_bf16 v[96:111], v[24:27], v[240:243], v[96:111]
    s_add_u32 s64, s51, 13056
    buffer_load_dwordx4 v[144:147], v40, s[8:11], s64 offen sc1
    v_mov_b32 v193, 0
    v_mov_b32 v194, 0
    v_mfma_f32_32x32x16_bf16 v[96:111], v[28:31], v[244:247], v[96:111]
    s_add_u32 s64, s51, 17408
    buffer_load_dwordx4 v[148:151], v40, s[8:11], s64 offen sc1
    v_mov_b32 v195, 0
    v_mov_b32 v196, 0
    s_waitcnt lgkmcnt(1)
    v_mfma_f32_32x32x16_bf16 v[96:111], v[32:35], v[248:251], v[96:111]
    s_add_u32 s64, s51, 21760
    buffer_load_dwordx4 v[152:155], v40, s[8:11], s64 offen sc1
    v_mov_b32 v197, 0
    v_mov_b32 v198, 0
    v_mov_b32 v199, 0
    v_mfma_f32_32x32x16_bf16 v[96:111], v[36:39], v[252:255], v[96:111]
    s_or_b32 s58, s35, s36
    s_waitcnt vmcnt(18)
    v_cmp_ne_u32 vcc, s58, v63
    s_nop 0
    s_cmp_eq_u64 vcc, 0
    s_cselect_b32 s12, 1, 0
    s_add_u32 s64, s51, 26112
    buffer_load_dwordx4 v[156:159], v40, s[8:11], s64 offen sc1
    s_waitcnt lgkmcnt(0)
    v_mfma_f32_32x32x16_bf16 v[96:111], v[20:23], v[16:19], v[96:111]
    s_add_u32 s64, s51, 30464
    buffer_load_dwordx4 v[160:163], v40, s[8:11], s64 offen sc1
    s_nop 9
    v_cvt_pk_bf16_f32 v20, v96, v97
    v_cvt_pk_bf16_f32 v21, v98, v99
    v_cvt_pk_bf16_f32 v22, v100, v101
    v_cvt_pk_bf16_f32 v23, v102, v103
    v_cvt_pk_bf16_f32 v24, v104, v105
    v_cvt_pk_bf16_f32 v25, v106, v107
    v_cvt_pk_bf16_f32 v26, v108, v109
    v_cvt_pk_bf16_f32 v27, v110, v111
    v_mfma_f32_32x32x16_bf16 v[112:127], a[240:243], v[20:23], 0
    s_nop 0
    v_mfma_f32_32x32x16_bf16 v[112:127], a[244:247], v[24:27], v[112:127]
    s_nop 11
    v_max3_f32 v14, v112, v113, v114
    v_min3_f32 v15, v112, v113, v114
    v_max3_f32 v14, v14, v115, v116
    v_min3_f32 v15, v15, v115, v116
    v_max3_f32 v14, v14, v117, v118
    v_min3_f32 v15, v15, v117, v118
    v_max3_f32 v14, v14, v119, v120
    v_min3_f32 v15, v15, v119, v120
    v_max3_f32 v14, v14, v121, v122
    v_min3_f32 v15, v15, v121, v122
    v_max3_f32 v14, v14, v123, v124
    v_min3_f32 v15, v15, v123, v124
    v_max3_f32 v14, v14, v125, v126
    v_min3_f32 v15, v15, v125, v126
    v_max_f32 v14, v14, v127
    v_min_f32 v15, v15, v127
    v_pk_mul_f32 v[14:15], v[14:15], v[58:59] op_sel:[0,0] op_sel_hi:[1,0]
    v_pk_fma_f32 v[64:65], v[112:113], v[58:59], v[14:15] op_sel:[0,0,0] op_sel_hi:[1,0,0] neg_lo:[0,0,1] neg_hi:[0,0,1]
    v_pk_fma_f32 v[66:67], v[114:115], v[58:59], v[14:15] op_sel:[0,0,0] op_sel_hi:[1,0,0] neg_lo:[0,0,1] neg_hi:[0,0,1]
    v_pk_fma_f32 v[68:69], v[116:117], v[58:59], v[14:15] op_sel:[0,0,0] op_sel_hi:[1,0,0] neg_lo:[0,0,1] neg_hi:[0,0,1]
    v_pk_fma_f32 v[70:71], v[118:119], v[58:59], v[14:15] op_sel:[0,0,0] op_sel_hi:[1,0,0] neg_lo:[0,0,1] neg_hi:[0,0,1]
    v_pk_fma_f32 v[72:73], v[120:121], v[58:59], v[14:15] op_sel:[0,0,0] op_sel_hi:[1,0,0] neg_lo:[0,0,1] neg_hi:[0,0,1]
    v_pk_fma_f32 v[74:75], v[122:123], v[58:59], v[14:15] op_sel:[0,0,0] op_sel_hi:[1,0,0] neg_lo:[0,0,1] neg_hi:[0,0,1]
    v_pk_fma_f32 v[76:77], v[124:125], v[58:59], v[14:15] op_sel:[0,0,0] op_sel_hi:[1,0,0] neg_lo:[0,0,1] neg_hi:[0,0,1]
    v_pk_fma_f32 v[78:79], v[126:127], v[58:59], v[14:15] op_sel:[0,0,0] op_sel_hi:[1,0,0] neg_lo:[0,0,1] neg_hi:[0,0,1]
    v_exp_f32 v64, v64
    v_exp_f32 v65, v65
    v_exp_f32 v66, v66
    v_exp_f32 v67, v67
    v_exp_f32 v68, v68
    v_exp_f32 v69, v69
    v_exp_f32 v70, v70
    v_exp_f32 v71, v71
    v_exp_f32 v72, v72
    v_exp_f32 v73, v73
    v_exp_f32 v74, v74
    v_exp_f32 v75, v75
    v_exp_f32 v76, v76
    v_exp_f32 v77, v77
    v_exp_f32 v78, v78
    v_exp_f32 v79, v79
    v_pk_add_f32 v[36:37], v[64:65], v[66:67] op_sel:[0,0] op_sel_hi:[1,1]
    v_pk_add_f32 v[36:37], v[36:37], v[68:69] op_sel:[0,0] op_sel_hi:[1,1]
    v_pk_add_f32 v[36:37], v[36:37], v[70:71] op_sel:[0,0] op_sel_hi:[1,1]
    v_pk_add_f32 v[36:37], v[36:37], v[72:73] op_sel:[0,0] op_sel_hi:[1,1]
    v_pk_add_f32 v[36:37], v[36:37], v[74:75] op_sel:[0,0] op_sel_hi:[1,1]
    v_pk_add_f32 v[36:37], v[36:37], v[76:77] op_sel:[0,0] op_sel_hi:[1,1]
    v_pk_add_f32 v[36:37], v[36:37], v[78:79] op_sel:[0,0] op_sel_hi:[1,1]
    v_add_f32 v36, v36, v37
    v_rcp_f32 v36, v36
    s_nop 0
    v_pk_mul_f32 v[64:65], v[64:65], v[36:37] op_sel:[0,0] op_sel_hi:[1,0]
    v_pk_mul_f32 v[66:67], v[66:67], v[36:37] op_sel:[0,0] op_sel_hi:[1,0]
    v_pk_mul_f32 v[68:69], v[68:69], v[36:37] op_sel:[0,0] op_sel_hi:[1,0]
    v_pk_mul_f32 v[70:71], v[70:71], v[36:37] op_sel:[0,0] op_sel_hi:[1,0]
    v_pk_mul_f32 v[72:73], v[72:73], v[36:37] op_sel:[0,0] op_sel_hi:[1,0]
    v_pk_mul_f32 v[74:75], v[74:75], v[36:37] op_sel:[0,0] op_sel_hi:[1,0]
    v_pk_mul_f32 v[76:77], v[76:77], v[36:37] op_sel:[0,0] op_sel_hi:[1,0]
    v_pk_mul_f32 v[78:79], v[78:79], v[36:37] op_sel:[0,0] op_sel_hi:[1,0]
    v_cvt_pk_bf16_f32 v96, v64, v65
    v_cvt_pk_bf16_f32 v97, v66, v67
    v_cvt_pk_bf16_f32 v100, v68, v69
    v_cvt_pk_bf16_f32 v101, v70, v71
    v_cvt_pk_bf16_f32 v98, v72, v73
    v_cvt_pk_bf16_f32 v99, v74, v75
    v_cvt_pk_bf16_f32 v102, v76, v77
    v_cvt_pk_bf16_f32 v103, v78, v79
    v_pk_fma_f32 v[80:81], v[112:113], v[58:59], v[14:15] op_sel:[0,0,1] op_sel_hi:[1,0,1] neg_lo:[1,0,0] neg_hi:[1,0,0]
    v_pk_fma_f32 v[82:83], v[114:115], v[58:59], v[14:15] op_sel:[0,0,1] op_sel_hi:[1,0,1] neg_lo:[1,0,0] neg_hi:[1,0,0]
    v_pk_fma_f32 v[84:85], v[116:117], v[58:59], v[14:15] op_sel:[0,0,1] op_sel_hi:[1,0,1] neg_lo:[1,0,0] neg_hi:[1,0,0]
    v_pk_fma_f32 v[86:87], v[118:119], v[58:59], v[14:15] op_sel:[0,0,1] op_sel_hi:[1,0,1] neg_lo:[1,0,0] neg_hi:[1,0,0]
    v_pk_fma_f32 v[88:89], v[120:121], v[58:59], v[14:15] op_sel:[0,0,1] op_sel_hi:[1,0,1] neg_lo:[1,0,0] neg_hi:[1,0,0]
    v_pk_fma_f32 v[90:91], v[122:123], v[58:59], v[14:15] op_sel:[0,0,1] op_sel_hi:[1,0,1] neg_lo:[1,0,0] neg_hi:[1,0,0]
    v_pk_fma_f32 v[92:93], v[124:125], v[58:59], v[14:15] op_sel:[0,0,1] op_sel_hi:[1,0,1] neg_lo:[1,0,0] neg_hi:[1,0,0]
    v_pk_fma_f32 v[94:95], v[126:127], v[58:59], v[14:15] op_sel:[0,0,1] op_sel_hi:[1,0,1] neg_lo:[1,0,0] neg_hi:[1,0,0]
    v_exp_f32 v80, v80
    v_exp_f32 v81, v81
    v_exp_f32 v82, v82
    v_exp_f32 v83, v83
    v_exp_f32 v84, v84
    v_exp_f32 v85, v85
    v_exp_f32 v86, v86
    v_exp_f32 v87, v87
    v_exp_f32 v88, v88
    v_exp_f32 v89, v89
    v_exp_f32 v90, v90
    v_exp_f32 v91, v91
    v_exp_f32 v92, v92
    v_exp_f32 v93, v93
    v_exp_f32 v94, v94
    v_exp_f32 v95, v95
    v_pk_add_f32 v[38:39], v[80:81], v[82:83] op_sel:[0,0] op_sel_hi:[1,1]
    v_pk_add_f32 v[38:39], v[38:39], v[84:85] op_sel:[0,0] op_sel_hi:[1,1]
    v_pk_add_f32 v[38:39], v[38:39], v[86:87] op_sel:[0,0] op_sel_hi:[1,1]
    v_pk_add_f32 v[38:39], v[38:39], v[88:89] op_sel:[0,0] op_sel_hi:[1,1]
    v_pk_add_f32 v[38:39], v[38:39], v[90:91] op_sel:[0,0] op_sel_hi:[1,1]
    v_pk_add_f32 v[38:39], v[38:39], v[92:93] op_sel:[0,0] op_sel_hi:[1,1]
    v_pk_add_f32 v[38:39], v[38:39], v[94:95] op_sel:[0,0] op_sel_hi:[1,1]
    v_add_f32 v38, v38, v39
    v_rcp_f32 v38, v38
    s_nop 0
    v_pk_mul_f32 v[80:81], v[80:81], v[38:39] op_sel:[0,0] op_sel_hi:[1,0]
    v_pk_mul_f32 v[82:83], v[82:83], v[38:39] op_sel:[0,0] op_sel_hi:[1,0]
    v_pk_mul_f32 v[84:85], v[84:85], v[38:39] op_sel:[0,0] op_sel_hi:[1,0]
    v_pk_mul_f32 v[86:87], v[86:87], v[38:39] op_sel:[0,0] op_sel_hi:[1,0]
    v_pk_mul_f32 v[88:89], v[88:89], v[38:39] op_sel:[0,0] op_sel_hi:[1,0]
    v_pk_mul_f32 v[90:91], v[90:91], v[38:39] op_sel:[0,0] op_sel_hi:[1,0]
    v_pk_mul_f32 v[92:93], v[92:93], v[38:39] op_sel:[0,0] op_sel_hi:[1,0]
    v_pk_mul_f32 v[94:95], v[94:95], v[38:39] op_sel:[0,0] op_sel_hi:[1,0]
    v_cvt_pk_bf16_f32 v104, v80, v81
    v_cvt_pk_bf16_f32 v105, v82, v83
    v_cvt_pk_bf16_f32 v108, v84, v85
    v_cvt_pk_bf16_f32 v109, v86, v87
    v_cvt_pk_bf16_f32 v106, v88, v89
    v_cvt_pk_bf16_f32 v107, v90, v91
    v_cvt_pk_bf16_f32 v110, v92, v93
    v_cvt_pk_bf16_f32 v111, v94, v95
    s_mov_b32 s62, 0
KV_3:
    s_waitcnt vmcnt(8)
    v_max_u32 v59, v128, v131
    s_mov_b32 exec_hi, 0
    ds_write_b128 v43, v[128:131] offset:2048
    s_mov_b64 exec, -1
    s_waitcnt vmcnt(7)
    v_mfma_f32_16x16x32_bf16 v[200:203], a[248:251], v[132:135], 0
    v_max3_u32 v59, v59, v132, v135
    s_waitcnt vmcnt(6)
    v_mfma_f32_16x16x32_bf16 v[200:203], a[248:251], v[136:139], v[200:203]
    v_max3_u32 v59, v59, v136, v139
    s_waitcnt vmcnt(5)
    v_mfma_f32_16x16x32_bf16 v[200:203], a[248:251], v[140:143], v[200:203]
    v_max3_u32 v59, v59, v140, v143
    s_waitcnt vmcnt(4)
    v_mfma_f32_16x16x32_bf16 v[200:203], a[248:251], v[144:147], v[200:203]
    v_max3_u32 v59, v59, v144, v147
    s_waitcnt vmcnt(3)
    v_mfma_f32_16x16x32_bf16 v[200:203], a[248:251], v[148:151], v[200:203]
    v_max3_u32 v59, v59, v148, v151
    s_waitcnt vmcnt(2)
    v_mfma_f32_16x16x32_bf16 v[200:203], a[248:251], v[152:155], v[200:203]
    v_max3_u32 v59, v59, v152, v155
    s_waitcnt vmcnt(1)
    v_mfma_f32_16x16x32_bf16 v[200:203], a[248:251], v[156:159], v[200:203]
    v_max3_u32 v59, v59, v156, v159
    s_waitcnt vmcnt(0)
    v_mfma_f32_16x16x32_bf16 v[200:203], a[248:251], v[160:163], v[200:203]
    v_max3_u32 v59, v59, v160, v163
    v_cmp_eq_u32 vcc, -1, v59
    s_cbranch_vccz KVOK_4
    v_max_u32 v59, v128, v131
    s_add_u32 s64, s51, 0
    v_cmp_eq_u32 vcc, -1, v59
    s_cbranch_vccz RS_5
    s_mov_b64 exec, vcc
    buffer_load_dwordx4 v[128:131], v41, s[8:11], s64 offen sc1
    s_mov_b64 exec, -1
    RS_5:
    v_max_u32 v59, v132, v135
    s_add_u32 s64, s51, 0
    v_cmp_eq_u32 vcc, -1, v59
    s_cbranch_vccz RS_6
    s_mov_b64 exec, vcc
    buffer_load_dwordx4 v[132:135], v40, s[8:11], s64 offen sc1
    s_mov_b64 exec, -1
    RS_6:
    v_max_u32 v59, v136, v139
    s_add_u32 s64, s51, 4352
    v_cmp_eq_u32 vcc, -1, v59
    s_cbranch_vccz RS_7
    s_mov_b64 exec, vcc
    buffer_load_dwordx4 v[136:139], v40, s[8:11], s64 offen sc1
    s_mov_b64 exec, -1
    RS_7:
    v_max_u32 v59, v140, v143
    s_add_u32 s64, s51, 8704
    v_cmp_eq_u32 vcc, -1, v59
    s_cbranch_vccz RS_8
    s_mov_b64 exec, vcc
    buffer_load_dwordx4 v[140:143], v40, s[8:11], s64 offen sc1
    s_mov_b64 exec, -1
    RS_8:
    v_max_u32 v59, v144, v147
    s_add_u32 s64, s51, 13056
    v_cmp_eq_u32 vcc, -1, v59
    s_cbranch_vccz RS_9
    s_mov_b64 exec, vcc
    buffer_load_dwordx4 v[144:147], v40, s[8:11], s64 offen sc1
    s_mov_b64 exec, -1
    RS_9:
    v_max_u32 v59, v148, v151
    s_add_u32 s64, s51, 17408
    v_cmp_eq_u32 vcc, -1, v59
    s_cbranch_vccz RS_10
    s_mov_b64 exec, vcc
    buffer_load_dwordx4 v[148:151], v40, s[8:11], s64 offen sc1
    s_mov_b64 exec, -1
    RS_10:
    v_max_u32 v59, v152, v155
    s_add_u32 s64, s51, 21760
    v_cmp_eq_u32 vcc, -1, v59
    s_cbranch_vccz RS_11
    s_mov_b64 exec, vcc
    buffer_load_dwordx4 v[152:155], v40, s[8:11], s64 offen sc1
    s_mov_b64 exec, -1
    RS_11:
    v_max_u32 v59, v156, v159
    s_add_u32 s64, s51, 26112
    v_cmp_eq_u32 vcc, -1, v59
    s_cbranch_vccz RS_12
    s_mov_b64 exec, vcc
    buffer_load_dwordx4 v[156:159], v40, s[8:11], s64 offen sc1
    s_mov_b64 exec, -1
    RS_12:
    v_max_u32 v59, v160, v163
    s_add_u32 s64, s51, 30464
    v_cmp_eq_u32 vcc, -1, v59
    s_cbranch_vccz RS_13
    s_mov_b64 exec, vcc
    buffer_load_dwordx4 v[160:163], v40, s[8:11], s64 offen sc1
    s_mov_b64 exec, -1
    RS_13:
    s_add_u32 s62, s62, 1
    s_cmp_gt_u32 s62, 0x80000
    s_cbranch_scc1 L_fail
    s_waitcnt vmcnt(0)
    s_branch KV_3
KVOK_4:
    s_nop 4
    v_cvt_pk_bf16_f32 v204, v200, v201
    v_cvt_pk_bf16_f32 v205, v202, v203
    ds_write_b64 v42, v[204:205]
    s_add_u32 s66, s49, 0
    buffer_load_dwordx4 a[60:63], v6, s[8:11], s66 offen
    buffer_load_dwordx4 a[64:67], v7, s[8:11], s66 offen
    buffer_load_dwordx4 a[68:71], v6, s[8:11], s66 offen offset:2048
    s_waitcnt lgkmcnt(0)
    s_barrier
    s_mov_b32 exec_lo, 0x0000ffff
    s_mov_b32 exec_hi, 0xffff0000
    ds_read_b128 v[184:187], v44 offset:2048
    ds_read_b128 v[188:191], v44 offset:2304
    ds_read_b128 v[192:195], v44 offset:2560
    ds_read_b128 v[196:199], v44 offset:2816
    ds_read_b128 v[168:171], v44 offset:0
    ds_read_b128 v[172:175], v44 offset:256
    ds_read_b128 v[176:179], v44 offset:512
    ds_read_b128 v[180:183], v44 offset:768
    s_mov_b64 exec, -1
    s_waitcnt lgkmcnt(7)
    v_mfma_f32_32x32x16_bf16 v[224:239], v[184:187], v[96:99], 0
    buffer_load_dwordx4 a[72:75], v7, s[8:11], s66 offen offset:2048
    s_waitcnt lgkmcnt(6)
    v_mfma_f32_32x32x16_bf16 v[224:239], v[188:191], v[100:103], v[224:239]
    s_add_u32 s66, s49, 4096
    buffer_load_dwordx4 a[76:79], v6, s[8:11], s66 offen
    s_waitcnt lgkmcnt(5)
    v_mfma_f32_32x32x16_bf16 v[224:239], v[192:195], v[104:107], v[224:239]
    buffer_load_dwordx4 a[80:83], v7, s[8:11], s66 offen
    s_waitcnt lgkmcnt(4)
    v_mfma_f32_32x32x16_bf16 v[224:239], v[196:199], v[108:111], v[224:239]
    buffer_load_dwordx4 a[84:87], v6, s[8:11], s66 offen offset:2048
    s_waitcnt lgkmcnt(3)
    v_mfma_f32_32x32x16_bf16 v[208:223], v[168:171], v[96:99], 0
    buffer_load_dwordx4 a[88:91], v7, s[8:11], s66 offen offset:2048
    s_waitcnt lgkmcnt(2)
    v_mfma_f32_32x32x16_bf16 v[208:223], v[172:175], v[100:103], v[208:223]
    s_add_u32 s66, s49, 8192
    buffer_load_dwordx4 a[92:95], v6, s[8:11], s66 offen
    s_waitcnt lgkmcnt(1)
    v_mfma_f32_32x32x16_bf16 v[208:223], v[176:179], v[104:107], v[208:223]
    buffer_load_dwordx4 a[96:99], v7, s[8:11], s66 offen
    s_waitcnt lgkmcnt(0)
    v_mfma_f32_32x32x16_bf16 v[208:223], v[180:183], v[108:111], v[208:223]
    v_pk_add_f32 v[224:225], v[224:225], v[226:227] op_sel:[0,0] op_sel_hi:[1,1]
    v_pk_add_f32 v[228:229], v[228:229], v[230:231] op_sel:[0,0] op_sel_hi:[1,1]
    v_pk_add_f32 v[232:233], v[232:233], v[234:235] op_sel:[0,0] op_sel_hi:[1,1]
    v_pk_add_f32 v[236:237], v[236:237], v[238:239] op_sel:[0,0] op_sel_hi:[1,1]
    v_pk_add_f32 v[224:225], v[224:225], v[228:229] op_sel:[0,0] op_sel_hi:[1,1]
    v_pk_add_f32 v[232:233], v[232:233], v[236:237] op_sel:[0,0] op_sel_hi:[1,1]
    v_add_f32 v224, v224, v225
    v_add_f32 v232, v232, v233
    s_nop 1
    v_permlane32_swap_b32 v224, v232
    v_add_f32 v224, v224, v232
    v_add_f32 v224, 0x358637bd, v224
    v_rcp_f32 v224, v224
    s_nop 0
    v_mov_b32 v232, v224
    s_nop 1
    v_permlane32_swap_b32 v224, v232
    v_pk_mul_f32 v[208:209], v[208:209], v[224:225] op_sel:[0,0] op_sel_hi:[1,0]
    v_pk_mul_f32 v[210:211], v[210:211], v[224:225] op_sel:[0,0] op_sel_hi:[1,0]
    v_pk_mul_f32 v[212:213], v[212:213], v[224:225] op_sel:[0,0] op_sel_hi:[1,0]
    v_pk_mul_f32 v[214:215], v[214:215], v[224:225] op_sel:[0,0] op_sel_hi:[1,0]
    v_cvt_pk_bf16_f32 v40, v208, v209
    v_cvt_pk_bf16_f32 v41, v210, v211
    v_cvt_pk_bf16_f32 v42, v212, v213
    v_cvt_pk_bf16_f32 v43, v214, v215
    s_cmp_eq_u32 s12, 0
    s_cbranch_scc1 WT_14
    buffer_store_dwordx4 v[40:43], v1, s[8:11], s42 offen
RT_15:
    v_pk_mul_f32 v[216:217], v[216:217], v[232:233] op_sel:[0,0] op_sel_hi:[1,0]
    v_pk_mul_f32 v[218:219], v[218:219], v[232:233] op_sel:[0,0] op_sel_hi:[1,0]
    v_pk_mul_f32 v[220:221], v[220:221], v[232:233] op_sel:[0,0] op_sel_hi:[1,0]
    v_pk_mul_f32 v[222:223], v[222:223], v[232:233] op_sel:[0,0] op_sel_hi:[1,0]
    v_cvt_pk_bf16_f32 v44, v216, v217
    v_cvt_pk_bf16_f32 v45, v218, v219
    v_cvt_pk_bf16_f32 v46, v220, v221
    v_cvt_pk_bf16_f32 v47, v222, v223
    s_cmp_eq_u32 s12, 0
    s_cbranch_scc1 WT_16
    buffer_store_dwordx4 v[44:47], v1, s[8:11], s42 offen offset:1024
RT_17:
    buffer_load_dwordx4 a[100:103], v6, s[8:11], s66 offen offset:2048
    buffer_load_dwordx4 a[104:107], v7, s[8:11], s66 offen offset:2048
    s_add_u32 s66, s49, 12288
    buffer_load_dwordx4 a[108:111], v6, s[8:11], s66 offen
    buffer_load_dwordx4 a[112:115], v7, s[8:11], s66 offen
    buffer_load_dwordx4 a[116:119], v6, s[8:11], s66 offen offset:2048
    buffer_load_dwordx4 a[120:123], v7, s[8:11], s66 offen offset:2048
    v_accvgpr_read_b32 v64, a224
    v_accvgpr_read_b32 v65, a225
    v_accvgpr_read_b32 v66, a226
    v_accvgpr_read_b32 v67, a227
    v_accvgpr_read_b32 v68, a228
    v_accvgpr_read_b32 v69, a229
    v_accvgpr_read_b32 v70, a230
    v_accvgpr_read_b32 v71, a231
    v_pk_mul_f32 v[72:73], v[10:11], v[10:11] op_sel:[0,0] op_sel_hi:[0,0]
    v_pk_mul_f32 v[74:75], v[10:11], v[10:11] op_sel:[0,0] op_sel_hi:[0,0]
    v_pk_mul_f32 v[76:77], v[10:11], v[10:11] op_sel:[0,0] op_sel_hi:[0,0]
    v_pk_mul_f32 v[78:79], v[10:11], v[10:11] op_sel:[0,0] op_sel_hi:[0,0]
    v_accvgpr_read_b32 v96, a232
    v_accvgpr_read_b32 v97, a233
    v_accvgpr_read_b32 v98, a234
    v_accvgpr_read_b32 v99, a235
    v_accvgpr_read_b32 v100, a236
    v_accvgpr_read_b32 v101, a237
    v_accvgpr_read_b32 v102, a238
    v_accvgpr_read_b32 v103, a239
    v_pk_mul_f32 v[104:105], v[10:11], v[10:11] op_sel:[0,0] op_sel_hi:[0,0]
    v_pk_mul_f32 v[106:107], v[10:11], v[10:11] op_sel:[0,0] op_sel_hi:[0,0]
    v_pk_mul_f32 v[108:109], v[10:11], v[10:11] op_sel:[0,0] op_sel_hi:[0,0]
    v_pk_mul_f32 v[110:111], v[10:11], v[10:11] op_sel:[0,0] op_sel_hi:[0,0]
    v_mov_b32 v62, 1
    s_waitcnt vmcnt(6)
    s_mov_b64 exec, 1
    s_cmp_eq_u32 s12, 0
    s_cbranch_scc1 WT_18
    buffer_store_dword v62, v10, s[8:11], s38 offen
RT_19:
    s_mov_b64 exec, -1
    s_mov_b32 s62, 0
POLL_20:
    buffer_load_dword v63, v9, s[8:11], s37 offen sc1
    s_add_u32 s62, s62, 1
    s_cmp_gt_u32 s62, 0x200000
    s_cbranch_scc1 L_fail
    s_waitcnt vmcnt(0)
    v_cmp_gt_u32 vcc, 1, v63
    s_cbranch_vccnz POLL_20
    s_add_u32 s64, s43, 0
    buffer_load_dwordx4 v[192:195], v1, s[8:11], s64 offen sc1
    buffer_load_dwordx4 v[196:199], v1, s[8:11], s64 offen offset:1024 sc1
    buffer_load_dwordx4 v[200:203], v1, s[8:11], s64 offen offset:2048 sc1
    buffer_load_dwordx4 v[204:207], v1, s[8:11], s64 offen offset:3072 sc1
    s_add_u32 s64, s43, 4096
    buffer_load_dwordx4 v[208:211], v1, s[8:11], s64 offen sc1
    buffer_load_dwordx4 v[212:215], v1, s[8:11], s64 offen offset:1024 sc1
    buffer_load_dwordx4 v[216:219], v1, s[8:11], s64 offen offset:2048 sc1
    s_xor_b32 s56, s28, 1
    s_mul_i32 s56, s56, 6144
    s_add_u32 s56, s56, 135168
    v_add_u32 v16, s56, v1
    s_xor_b32 s56, s28, 2
    s_mul_i32 s56, s56, 6144
    s_add_u32 s56, s56, 137216
    v_add_u32 v17, s56, v1
    s_xor_b32 s56, s28, 3
    s_mul_i32 s56, s56, 6144
    s_add_u32 s56, s56, 139264
    v_add_u32 v18, s56, v1
    s_mul_i32 s56, s28, 6144
    s_add_u32 s56, s56, 135168
    v_add_u32 v19, s56, v1
    s_lshl_b32 s56, s28, 8
    s_add_u32 s56, s56, 159744
    v_add_u32 v14, s56, v11
    v_add_u32 v15, 159744, v11
    s_waitcnt vmcnt(6)
    v_mfma_f32_32x32x16_bf16 v[80:95], a[64:67], v[192:195], 0
    v_mfma_f32_32x32x16_bf16 v[64:79], a[60:63], v[192:195], v[64:79]
    v_add_u32 v56, s52, v4
    s_add_u32 s60, s14, 67584
    v_add_u32 v57, s60, v11
    buffer_load_dwordx4 v[220:223], v1, s[8:11], s64 offen offset:3072 sc1
    s_waitcnt vmcnt(6)
    v_mfma_f32_32x32x16_bf16 v[80:95], a[72:75], v[196:199], v[80:95]
    v_mfma_f32_32x32x16_bf16 v[64:79], a[68:71], v[196:199], v[64:79]
    ds_read_b128 a[192:195], v56 offset:0
    ds_read_b128 a[196:199], v56 offset:1024
    s_add_u32 s64, s43, 114688
    buffer_load_dwordx4 v[224:227], v1, s[8:11], s64 offen sc1
    s_waitcnt vmcnt(6)
    v_mfma_f32_32x32x16_bf16 v[80:95], a[80:83], v[200:203], v[80:95]
    v_mfma_f32_32x32x16_bf16 v[64:79], a[76:79], v[200:203], v[64:79]
    ds_read_b128 a[200:203], v56 offset:2048
    ds_read_b128 a[204:207], v56 offset:3072
    buffer_load_dwordx4 v[228:231], v1, s[8:11], s64 offen offset:1024 sc1
    s_waitcnt vmcnt(6)
    v_mfma_f32_32x32x16_bf16 v[80:95], a[88:91], v[204:207], v[80:95]
    v_mfma_f32_32x32x16_bf16 v[64:79], a[84:87], v[204:207], v[64:79]
    ds_read_b128 a[208:211], v56 offset:4096
    ds_read_b128 a[212:215], v56 offset:5120
    buffer_load_dwordx4 v[232:235], v1, s[8:11], s64 offen offset:2048 sc1
    s_waitcnt vmcnt(6)
    v_mfma_f32_32x32x16_bf16 v[80:95], a[96:99], v[208:211], v[80:95]
    v_mfma_f32_32x32x16_bf16 v[64:79], a[92:95], v[208:211], v[64:79]
    ds_read_b128 a[216:219], v56 offset:6144
    ds_read_b128 a[220:223], v56 offset:7168
    buffer_load_dwordx4 v[236:239], v1, s[8:11], s64 offen offset:3072 sc1
    s_waitcnt vmcnt(6)
    v_mfma_f32_32x32x16_bf16 v[80:95], a[104:107], v[212:215], v[80:95]
    v_mfma_f32_32x32x16_bf16 v[64:79], a[100:103], v[212:215], v[64:79]
    ds_read_b32 a126, v57
    s_add_u32 s64, s43, 118784
    buffer_load_dwordx4 v[240:243], v1, s[8:11], s64 offen sc1
    s_waitcnt vmcnt(6)
    v_mfma_f32_32x32x16_bf16 v[80:95], a[112:115], v[216:219], v[80:95]
    v_mfma_f32_32x32x16_bf16 v[64:79], a[108:111], v[216:219], v[64:79]
    buffer_load_dwordx4 v[244:247], v1, s[8:11], s64 offen offset:1024 sc1
    s_waitcnt vmcnt(6)
    v_mfma_f32_32x32x16_bf16 v[80:95], a[120:123], v[220:223], v[80:95]
    v_mfma_f32_32x32x16_bf16 v[64:79], a[116:119], v[220:223], v[64:79]
    buffer_load_dwordx4 v[248:251], v1, s[8:11], s64 offen offset:2048 sc1
    s_waitcnt vmcnt(6)
    v_mfma_f32_32x32x16_bf16 v[112:127], a[64:67], v[224:227], 0
    v_mfma_f32_32x32x16_bf16 v[96:111], a[60:63], v[224:227], v[96:111]
    s_nop 6
    ds_write_b128 v17, v[80:83] offset:0
    buffer_load_dwordx4 v[252:255], v1, s[8:11], s64 offen offset:3072 sc1
    s_waitcnt vmcnt(6)
    v_mfma_f32_32x32x16_bf16 v[112:127], a[72:75], v[228:231], v[112:127]
    ds_write_b128 v17, v[84:87] offset:1024
    v_mfma_f32_32x32x16_bf16 v[96:111], a[68:71], v[228:231], v[96:111]
    ds_write_b128 v18, v[88:91] offset:0
    s_or_b32 s66, s35, s36
    v_mov_b32 v60, s34
    v_mov_b32 v61, s66
    s_add_u32 s66, s89, 98304
    s_mov_b64 exec, 1
    buffer_store_dwordx2 v[60:61], v10, s[8:11], s66 offen sc1
    s_mov_b64 exec, -1
    s_waitcnt vmcnt(6)
    v_mfma_f32_32x32x16_bf16 v[112:127], a[80:83], v[232:235], v[112:127]
    ds_write_b128 v18, v[92:95] offset:1024
    v_mfma_f32_32x32x16_bf16 v[96:111], a[76:79], v[232:235], v[96:111]
    ds_write_b128 v16, v[72:75] offset:0
    s_add_u32 m0, s52, 0
    s_add_u32 s63, s47, 33792
    buffer_load_dwordx4 v1, s[8:11], s63 offen offset:0 lds
    buffer_load_dwordx4 v1, s[8:11], s63 offen offset:1024 lds
    s_waitcnt vmcnt(7)
    v_mfma_f32_32x32x16_bf16 v[112:127], a[88:91], v[236:239], v[112:127]
    ds_write_b128 v16, v[76:79] offset:1024
    v_mfma_f32_32x32x16_bf16 v[96:111], a[84:87], v[236:239], v[96:111]
    buffer_load_dwordx4 v1, s[8:11], s63 offen offset:2048 lds
    s_waitcnt vmcnt(7)
    v_mfma_f32_32x32x16_bf16 v[112:127], a[96:99], v[240:243], v[112:127]
    v_mfma_f32_32x32x16_bf16 v[96:111], a[92:95], v[240:243], v[96:111]
    buffer_load_dwordx4 v1, s[8:11], s63 offen offset:3072 lds
    s_add_u32 m0, s52, 4096
    s_add_u32 s63, s47, 37888
    buffer_load_dwordx4 v1, s[8:11], s63 offen offset:0 lds
    s_waitcnt vmcnt(8)
    v_mfma_f32_32x32x16_bf16 v[112:127], a[104:107], v[244:247], v[112:127]
    s_waitcnt lgkmcnt(0)
    s_barrier
    v_mfma_f32_32x32x16_bf16 v[96:111], a[100:103], v[244:247], v[96:111]
    ds_read_b128 v[20:23], v19 offset:0
    ds_read_b128 v[24:27], v19 offset:1024
    buffer_load_dwordx4 v1, s[8:11], s63 offen offset:1024 lds
    s_waitcnt vmcnt(8)
    v_mfma_f32_32x32x16_bf16 v[112:127], a[112:115], v[248:251], v[112:127]
    ds_read_b128 v[28:31], v19 offset:2048
    ds_read_b128 v[32:35], v19 offset:3072
    v_mfma_f32_32x32x16_bf16 v[96:111], a[108:111], v[248:251], v[96:111]
    ds_read_b128 v[36:39], v19 offset:4096
    ds_read_b128 v[40:43], v19 offset:5120
    buffer_load_dwordx4 v1, s[8:11], s63 offen offset:2048 lds
    buffer_load_dwordx4 v1, s[8:11], s63 offen offset:3072 lds
    s_waitcnt vmcnt(9)
    v_mfma_f32_32x32x16_bf16 v[112:127], a[120:123], v[252:255], v[112:127]
    v_mfma_f32_32x32x16_bf16 v[96:111], a[116:119], v[252:255], v[96:111]
    s_waitcnt lgkmcnt(0)
    s_barrier
    s_lshr_b32 s66, s2, 3
    s_lshl_b32 s66, s66, 2
    s_add_u32 s66, s66, s28
    s_lshl_b32 s66, s66, 9
    s_add_u32 s66, s66, L_p3_0-L_pc
    v_lshl_add_u32 v58, v1, 3, s66
    v_min_u32 v58, L_end-L_pc-4, v58
    s_mov_b64 exec, 15
    global_load_dword v58, v58, s[4:5]
    s_mov_b64 exec, -1
    s_add_u32 m0, s14, 0
    s_add_u32 s63, s46, 33792
    buffer_load_dword v11, s[8:11], s63 offen lds
    v_pk_add_f32 v[64:65], v[64:65], v[20:21] op_sel:[0,0] op_sel_hi:[1,1]
    v_pk_add_f32 v[66:67], v[66:67], v[22:23] op_sel:[0,0] op_sel_hi:[1,1]
    v_pk_add_f32 v[68:69], v[68:69], v[24:25] op_sel:[0,0] op_sel_hi:[1,1]
    v_pk_add_f32 v[70:71], v[70:71], v[26:27] op_sel:[0,0] op_sel_hi:[1,1]
    v_pk_add_f32 v[64:65], v[64:65], v[28:29] op_sel:[0,0] op_sel_hi:[1,1]
    v_pk_add_f32 v[66:67], v[66:67], v[30:31] op_sel:[0,0] op_sel_hi:[1,1]
    v_pk_add_f32 v[68:69], v[68:69], v[32:33] op_sel:[0,0] op_sel_hi:[1,1]
    v_pk_add_f32 v[70:71], v[70:71], v[34:35] op_sel:[0,0] op_sel_hi:[1,1]
    ds_write_b128 v17, v[112:115] offset:0
    v_pk_add_f32 v[64:65], v[64:65], v[36:37] op_sel:[0,0] op_sel_hi:[1,1]
    v_pk_add_f32 v[66:67], v[66:67], v[38:39] op_sel:[0,0] op_sel_hi:[1,1]
    v_pk_add_f32 v[68:69], v[68:69], v[40:41] op_sel:[0,0] op_sel_hi:[1,1]
    v_pk_add_f32 v[70:71], v[70:71], v[42:43] op_sel:[0,0] op_sel_hi:[1,1]
    v_cvt_pk_bf16_f32 v44, v64, v65
    v_cvt_pk_bf16_f32 v45, v66, v67
    v_cvt_pk_bf16_f32 v46, v68, v69
    ds_write_b128 v17, v[116:119] offset:1024
    v_cvt_pk_bf16_f32 v47, v70, v71
    s_add_u32 s65, s40, 0
    s_cmp_eq_u32 s12, 0
    s_cbranch_scc1 WT_21
    buffer_store_dwordx4 v[44:47], v1, s[8:11], s65 offen
RT_22:
    v_pk_add_f32 v[72:73], v[64:65], v[66:67] op_sel:[0,0] op_sel_hi:[1,1]
    v_pk_mul_f32 v[74:75], v[64:65], v[64:65] op_sel:[0,0] op_sel_hi:[1,1]
    v_pk_add_f32 v[72:73], v[72:73], v[68:69] op_sel:[0,0] op_sel_hi:[1,1]
    v_pk_fma_f32 v[74:75], v[66:67], v[66:67], v[74:75] op_sel:[0,0,0] op_sel_hi:[1,1,1]
    ds_write_b128 v18, v[120:123] offset:0
    v_pk_add_f32 v[72:73], v[72:73], v[70:71] op_sel:[0,0] op_sel_hi:[1,1]
    v_pk_fma_f32 v[74:75], v[68:69], v[68:69], v[74:75] op_sel:[0,0,0] op_sel_hi:[1,1,1]
    v_add_f32 v72, v72, v73
    v_pk_fma_f32 v[74:75], v[70:71], v[70:71], v[74:75] op_sel:[0,0,0] op_sel_hi:[1,1,1]
    v_add_f32 v74, v74, v75
    s_nop 1
    v_permlane32_swap_b32 v72, v74
    ds_write_b128 v18, v[124:127] offset:1024
    v_add_f32 v72, v72, v74
    ds_write_b32 v14, v72 offset:0
    v_lshlrev_b32 v80, 16, v44
    v_and_b32 v81, 0xffff0000, v44
    v_lshlrev_b32 v82, 16, v45
    v_and_b32 v83, 0xffff0000, v45
    ds_write_b128 v16, v[104:107] offset:0
    v_lshlrev_b32 v84, 16, v46
    v_and_b32 v85, 0xffff0000, v46
    v_lshlrev_b32 v86, 16, v47
    v_and_b32 v87, 0xffff0000, v47
    v_accvgpr_write_b32 a224, v80
    v_accvgpr_write_b32 a225, v81
    ds_write_b128 v16, v[108:111] offset:1024
    v_accvgpr_write_b32 a226, v82
    v_accvgpr_write_b32 a227, v83
    v_accvgpr_write_b32 a228, v84
    v_accvgpr_write_b32 a229, v85
    v_accvgpr_write_b32 a230, v86
    v_accvgpr_write_b32 a231, v87
    s_waitcnt lgkmcnt(0)
    s_barrier
    ds_read_b128 v[20:23], v19 offset:0
    ds_read_b128 v[24:27], v19 offset:1024
    ds_read_b128 v[28:31], v19 offset:2048
    ds_read_b128 v[32:35], v19 offset:3072
    ds_read_b128 v[36:39], v19 offset:4096
    ds_read_b128 v[40:43], v19 offset:5120
    s_waitcnt lgkmcnt(5)
    v_pk_add_f32 v[96:97], v[96:97], v[20:21] op_sel:[0,0] op_sel_hi:[1,1]
    v_pk_add_f32 v[98:99], v[98:99], v[22:23] op_sel:[0,0] op_sel_hi:[1,1]
    s_waitcnt lgkmcnt(4)
    v_pk_add_f32 v[100:101], v[100:101], v[24:25] op_sel:[0,0] op_sel_hi:[1,1]
    v_pk_add_f32 v[102:103], v[102:103], v[26:27] op_sel:[0,0] op_sel_hi:[1,1]
    s_waitcnt lgkmcnt(3)
    v_pk_add_f32 v[96:97], v[96:97], v[28:29] op_sel:[0,0] op_sel_hi:[1,1]
    v_pk_add_f32 v[98:99], v[98:99], v[30:31] op_sel:[0,0] op_sel_hi:[1,1]
    s_waitcnt lgkmcnt(2)
    v_pk_add_f32 v[100:101], v[100:101], v[32:33] op_sel:[0,0] op_sel_hi:[1,1]
    v_pk_add_f32 v[102:103], v[102:103], v[34:35] op_sel:[0,0] op_sel_hi:[1,1]
    s_waitcnt lgkmcnt(1)
    v_pk_add_f32 v[96:97], v[96:97], v[36:37] op_sel:[0,0] op_sel_hi:[1,1]
    v_pk_add_f32 v[98:99], v[98:99], v[38:39] op_sel:[0,0] op_sel_hi:[1,1]
    s_waitcnt lgkmcnt(0)
    v_pk_add_f32 v[100:101], v[100:101], v[40:41] op_sel:[0,0] op_sel_hi:[1,1]
    v_pk_add_f32 v[102:103], v[102:103], v[42:43] op_sel:[0,0] op_sel_hi:[1,1]
    v_cvt_pk_bf16_f32 v44, v96, v97
    v_cvt_pk_bf16_f32 v45, v98, v99
    v_cvt_pk_bf16_f32 v46, v100, v101
    v_cvt_pk_bf16_f32 v47, v102, v103
    s_add_u32 s65, s40, 32768
    s_cmp_eq_u32 s12, 0
    s_cbranch_scc1 WT_23
    buffer_store_dwordx4 v[44:47], v1, s[8:11], s65 offen
RT_24:
    v_pk_add_f32 v[104:105], v[96:97], v[98:99] op_sel:[0,0] op_sel_hi:[1,1]
    v_pk_mul_f32 v[106:107], v[96:97], v[96:97] op_sel:[0,0] op_sel_hi:[1,1]
    v_pk_add_f32 v[104:105], v[104:105], v[100:101] op_sel:[0,0] op_sel_hi:[1,1]
    v_pk_fma_f32 v[106:107], v[98:99], v[98:99], v[106:107] op_sel:[0,0,0] op_sel_hi:[1,1,1]
    v_pk_add_f32 v[104:105], v[104:105], v[102:103] op_sel:[0,0] op_sel_hi:[1,1]
    v_pk_fma_f32 v[106:107], v[100:101], v[100:101], v[106:107] op_sel:[0,0,0] op_sel_hi:[1,1,1]
    v_add_f32 v104, v104, v105
    v_pk_fma_f32 v[106:107], v[102:103], v[102:103], v[106:107] op_sel:[0,0,0] op_sel_hi:[1,1,1]
    v_add_f32 v106, v106, v107
    s_nop 1
    v_permlane32_swap_b32 v104, v106
    v_add_f32 v104, v104, v106
    ds_write_b32 v14, v104 offset:1024
    v_lshlrev_b32 v112, 16, v44
    v_and_b32 v113, 0xffff0000, v44
    v_lshlrev_b32 v114, 16, v45
    v_and_b32 v115, 0xffff0000, v45
    v_lshlrev_b32 v116, 16, v46
    v_and_b32 v117, 0xffff0000, v46
    v_lshlrev_b32 v118, 16, v47
    v_and_b32 v119, 0xffff0000, v47
    s_waitcnt lgkmcnt(0)
    s_barrier
    ds_read2st64_b32 v[48:49], v15 offset0:0 offset1:1
    ds_read2st64_b32 v[50:51], v15 offset0:2 offset1:3
    ds_read2st64_b32 v[52:53], v15 offset0:4 offset1:5
    ds_read2st64_b32 v[54:55], v15 offset0:6 offset1:7
    v_accvgpr_write_b32 a232, v112
    v_accvgpr_write_b32 a233, v113
    v_accvgpr_write_b32 a234, v114
    v_accvgpr_write_b32 a235, v115
    v_accvgpr_write_b32 a236, v116
    v_accvgpr_write_b32 a237, v117
    v_accvgpr_write_b32 a238, v118
    v_accvgpr_write_b32 a239, v119
    v_mov_b32 v62, 2
    s_waitcnt vmcnt(0)
    s_mov_b64 exec, 1
    s_cmp_eq_u32 s12, 0
    s_cbranch_scc1 WT_25
    buffer_store_dword v62, v10, s[8:11], s38 offen
RT_26:
    s_mov_b64 exec, -1
    s_waitcnt lgkmcnt(2)
    v_pk_add_f32 v[48:49], v[48:49], v[50:51] op_sel:[0,0] op_sel_hi:[1,1]
    v_add_f32 v48, v48, v49
    s_add_u32 s65, s41, 0
    s_mov_b64 exec, s[54:55]
    s_cmp_eq_u32 s12, 0
    s_cbranch_scc1 WT_27
    buffer_store_dword v48, v1, s[8:11], s65 offen
RT_28:
    s_mov_b64 exec, -1
    s_waitcnt lgkmcnt(0)
    v_pk_add_f32 v[52:53], v[52:53], v[54:55] op_sel:[0,0] op_sel_hi:[1,1]
    v_add_f32 v52, v52, v53
    s_add_u32 s65, s41, 2048
    s_mov_b64 exec, s[54:55]
    s_cmp_eq_u32 s12, 0
    s_cbranch_scc1 WT_29
    buffer_store_dword v52, v1, s[8:11], s65 offen
RT_30:
    s_mov_b64 exec, -1
L_p3_0:
    s_barrier
    ds_read_b128 v[20:23], v5 offset:0
    ds_read_b128 v[24:27], v2 offset:0
    ds_read_b128 v[28:31], v5 offset:1024
    ds_read_b128 v[32:35], v2 offset:1024
    ds_read_b128 v[36:39], v5 offset:2048
    s_mov_b32 s62, 0
POLL_35:
    buffer_load_dword v63, v8, s[8:11], s37 offen sc1
    s_add_u32 s62, s62, 1
    s_cmp_gt_u32 s62, 0x200000
    s_cbranch_scc1 L_fail
    s_waitcnt vmcnt(0)
    v_cmp_gt_u32 vcc, 2, v63
    s_cbranch_vccnz POLL_35
    s_add_u32 s64, s39, 0
    buffer_load_dwordx4 v[128:131], v1, s[8:11], s64 offen sc1
    buffer_load_dwordx4 v[132:135], v1, s[8:11], s64 offen offset:1024 sc1
    buffer_load_dwordx4 v[136:139], v1, s[8:11], s64 offen offset:2048 sc1
    buffer_load_dwordx4 v[140:143], v1, s[8:11], s64 offen offset:3072 sc1
    s_add_u32 s64, s39, 4096
    buffer_load_dwordx4 v[144:147], v1, s[8:11], s64 offen sc1
    buffer_load_dwordx4 v[148:151], v1, s[8:11], s64 offen offset:1024 sc1
    buffer_load_dwordx4 v[152:155], v1, s[8:11], s64 offen offset:2048 sc1
    v_mov_b32 v62, 3
    s_mov_b64 exec, 1
    s_cmp_eq_u32 s12, 0
    s_cbranch_scc1 WT_31
    buffer_store_dword v62, v10, s[8:11], s38 offen
RT_32:
    s_mov_b64 exec, -1
    s_waitcnt vmcnt(7) lgkmcnt(4)
    v_mfma_f32_32x32x16_bf16 v[64:79], v[20:23], v[128:131], 0
    ds_read_b128 v[20:23], v2 offset:2048
    buffer_load_dwordx4 v[156:159], v1, s[8:11], s64 offen offset:3072 sc1
    s_waitcnt lgkmcnt(4)
    v_mfma_f32_32x32x16_bf16 v[80:95], v[24:27], v[128:131], 0
    ds_read_b128 v[24:27], v5 offset:3072
    s_waitcnt vmcnt(7) lgkmcnt(3)
    v_mfma_f32_32x32x16_bf16 v[64:79], v[28:31], v[132:135], v[64:79]
    ds_read_b128 v[28:31], v2 offset:3072
    s_add_u32 s64, s39, 8192
    buffer_load_dwordx4 v[160:163], v1, s[8:11], s64 offen sc1
    v_mfma_f32_32x32x16_bf16 v[80:95], v[32:35], v[132:135], v[80:95]
    ds_read_b128 v[32:35], v5 offset:4096
    s_waitcnt vmcnt(7) lgkmcnt(3)
    v_mfma_f32_32x32x16_bf16 v[64:79], v[36:39], v[136:139], v[64:79]
    ds_read_b128 v[36:39], v2 offset:4096
    buffer_load_dwordx4 v[164:167], v1, s[8:11], s64 offen offset:1024 sc1
    v_mfma_f32_32x32x16_bf16 v[80:95], v[20:23], v[136:139], v[80:95]
    ds_read_b128 v[20:23], v5 offset:5120
    s_waitcnt vmcnt(7) lgkmcnt(3)
    v_mfma_f32_32x32x16_bf16 v[64:79], v[24:27], v[140:143], v[64:79]
    ds_read_b128 v[24:27], v2 offset:5120
    buffer_load_dwordx4 v[168:171], v1, s[8:11], s64 offen offset:2048 sc1
    v_mfma_f32_32x32x16_bf16 v[80:95], v[28:31], v[140:143], v[80:95]
    ds_read_b128 v[28:31], v5 offset:6144
    s_waitcnt vmcnt(7) lgkmcnt(3)
    v_mfma_f32_32x32x16_bf16 v[64:79], v[32:35], v[144:147], v[64:79]
    ds_read_b128 v[32:35], v2 offset:6144
    buffer_load_dwordx4 v[172:175], v1, s[8:11], s64 offen offset:3072 sc1
    v_mfma_f32_32x32x16_bf16 v[80:95], v[36:39], v[144:147], v[80:95]
    ds_read_b128 v[36:39], v5 offset:7168
    s_waitcnt vmcnt(7) lgkmcnt(3)
    v_mfma_f32_32x32x16_bf16 v[64:79], v[20:23], v[148:151], v[64:79]
    ds_read_b128 v[20:23], v2 offset:7168
    s_add_u32 s64, s39, 12288
    buffer_load_dwordx4 v[176:179], v1, s[8:11], s64 offen sc1
    v_mfma_f32_32x32x16_bf16 v[80:95], v[24:27], v[148:151], v[80:95]
    ds_read_b128 v[24:27], v5 offset:8192
    s_waitcnt vmcnt(7) lgkmcnt(3)
    v_mfma_f32_32x32x16_bf16 v[64:79], v[28:31], v[152:155], v[64:79]
    ds_read_b128 v[28:31], v2 offset:8192
    buffer_load_dwordx4 v[180:183], v1, s[8:11], s64 offen offset:1024 sc1
    v_mfma_f32_32x32x16_bf16 v[80:95], v[32:35], v[152:155], v[80:95]
    ds_read_b128 v[32:35], v5 offset:9216
    s_waitcnt vmcnt(6) lgkmcnt(3)
    v_mfma_f32_32x32x16_bf16 v[64:79], v[36:39], v[156:159], v[64:79]
    ds_read_b128 v[36:39], v2 offset:9216
    buffer_load_dwordx4 v[184:187], v1, s[8:11], s64 offen offset:2048 sc1
    buffer_load_dword v63, v8, s[8:11], s37 offen sc1
    v_mfma_f32_32x32x16_bf16 v[80:95], v[20:23], v[156:159], v[80:95]
    ds_read_b128 v[20:23], v5 offset:10240
    s_waitcnt vmcnt(7) lgkmcnt(3)
    v_mfma_f32_32x32x16_bf16 v[64:79], v[24:27], v[160:163], v[64:79]
    ds_read_b128 v[24:27], v2 offset:10240
    buffer_load_dwordx4 v[188:191], v1, s[8:11], s64 offen offset:3072 sc1
    v_mfma_f32_32x32x16_bf16 v[80:95], v[28:31], v[160:163], v[80:95]
    ds_read_b128 v[28:31], v5 offset:11264
    s_waitcnt vmcnt(7) lgkmcnt(3)
    v_mfma_f32_32x32x16_bf16 v[64:79], v[32:35], v[164:167], v[64:79]
    ds_read_b128 v[32:35], v2 offset:11264
    s_add_u32 s64, s39, 16384
    buffer_load_dwordx4 v[192:195], v1, s[8:11], s64 offen sc1
    v_mfma_f32_32x32x16_bf16 v[80:95], v[36:39], v[164:167], v[80:95]
    ds_read_b128 v[36:39], v5 offset:12288
    s_waitcnt vmcnt(7) lgkmcnt(3)
    v_mfma_f32_32x32x16_bf16 v[64:79], v[20:23], v[168:171], v[64:79]
    ds_read_b128 v[20:23], v2 offset:12288
    buffer_load_dwordx4 v[196:199], v1, s[8:11], s64 offen offset:1024 sc1
    s_add_u32 m0, s52, 33792
    s_add_u32 s63, s47, 67584
    buffer_load_dwordx4 v1, s[8:11], s63 offen offset:0 lds
    v_mfma_f32_32x32x16_bf16 v[80:95], v[24:27], v[168:171], v[80:95]
    ds_read_b128 v[24:27], v5 offset:13312
    s_waitcnt vmcnt(8) lgkmcnt(3)
    v_mfma_f32_32x32x16_bf16 v[64:79], v[28:31], v[172:175], v[64:79]
    ds_read_b128 v[28:31], v2 offset:13312
    buffer_load_dwordx4 v[200:203], v1, s[8:11], s64 offen offset:2048 sc1
    v_mfma_f32_32x32x16_bf16 v[80:95], v[32:35], v[172:175], v[80:95]
    ds_read_b128 v[32:35], v5 offset:14336
    buffer_load_dwordx4 v1, s[8:11], s63 offen offset:1024 lds
    s_waitcnt vmcnt(9) lgkmcnt(3)
    v_mfma_f32_32x32x16_bf16 v[64:79], v[36:39], v[176:179], v[64:79]
    ds_read_b128 v[36:39], v2 offset:14336
    buffer_load_dwordx4 v[204:207], v1, s[8:11], s64 offen offset:3072 sc1
    v_mfma_f32_32x32x16_bf16 v[80:95], v[20:23], v[176:179], v[80:95]
    ds_read_b128 v[20:23], v5 offset:15360
    s_waitcnt vmcnt(9) lgkmcnt(3)
    v_mfma_f32_32x32x16_bf16 v[64:79], v[24:27], v[180:183], v[64:79]
    ds_read_b128 v[24:27], v2 offset:15360
    s_add_u32 s64, s39, 20480
    buffer_load_dwordx4 v[208:211], v1, s[8:11], s64 offen sc1
    buffer_load_dwordx4 v1, s[8:11], s63 offen offset:2048 lds
    v_mfma_f32_32x32x16_bf16 v[80:95], v[28:31], v[180:183], v[80:95]
    ds_read_b128 v[28:31], v5 offset:16384
    s_waitcnt vmcnt(10) lgkmcnt(3)
    v_mfma_f32_32x32x16_bf16 v[64:79], v[32:35], v[184:187], v[64:79]
    ds_read_b128 v[32:35], v2 offset:16384
    buffer_load_dwordx4 v[212:215], v1, s[8:11], s64 offen offset:1024 sc1
    s_waitcnt vmcnt(10)
    v_cmp_gt_u32 vcc, 3, v63
    s_cbranch_vccz OK_36
    s_mov_b32 s62, 0
    SP_37:
    buffer_load_dword v63, v8, s[8:11], s37 offen sc1
    s_add_u32 s62, s62, 1
    s_cmp_gt_u32 s62, 0x200000
    s_cbranch_scc1 L_fail
    s_waitcnt vmcnt(0)
    v_cmp_gt_u32 vcc, 3, v63
    s_cbranch_vccnz SP_37
    OK_36:
    v_mfma_f32_32x32x16_bf16 v[80:95], v[36:39], v[184:187], v[80:95]
    ds_read_b128 v[36:39], v5 offset:17408
    s_lshr_b32 s65, s39, 4
    s_add_u32 s65, s65, 6918144
    buffer_load_dwordx4 v[52:55], v1, s[8:11], s65 offen sc1
    s_waitcnt vmcnt(10) lgkmcnt(3)
    v_mfma_f32_32x32x16_bf16 v[64:79], v[20:23], v[188:191], v[64:79]
    ds_read_b128 v[20:23], v2 offset:17408
    buffer_load_dwordx4 v[216:219], v1, s[8:11], s64 offen offset:2048 sc1
    buffer_load_dwordx4 v1, s[8:11], s63 offen offset:3072 lds
    v_bfe_u32 v42, v1, 4, 4
    v_mfma_f32_32x32x16_bf16 v[80:95], v[24:27], v[188:191], v[80:95]
    ds_read_b128 v[24:27], v5 offset:18432
    buffer_load_dwordx4 v[56:59], v1, s[8:11], s65 offen offset:1024 sc1
    v_min_u32 v42, 13, v42
    s_waitcnt vmcnt(12) lgkmcnt(3)
    v_mfma_f32_32x32x16_bf16 v[64:79], v[28:31], v[192:195], v[64:79]
    ds_read_b128 v[28:31], v2 offset:18432
    buffer_load_dwordx4 v[220:223], v1, s[8:11], s64 offen offset:3072 sc1
    s_mul_i32 s60, s28, 56
    v_mfma_f32_32x32x16_bf16 v[80:95], v[32:35], v[192:195], v[80:95]
    ds_read_b128 v[32:35], v5 offset:19456
    s_add_u32 m0, s52, 37888
    s_add_u32 s63, s47, 71680
    buffer_load_dwordx4 v1, s[8:11], s63 offen offset:0 lds
    s_lshr_b32 s56, s32, 1
    s_waitcnt vmcnt(13) lgkmcnt(3)
    v_mfma_f32_32x32x16_bf16 v[64:79], v[36:39], v[196:199], v[64:79]
    ds_read_b128 v[36:39], v2 offset:19456
    s_add_u32 s64, s39, 24576
    buffer_load_dwordx4 v[224:227], v1, s[8:11], s64 offen sc1
    s_add_u32 s60, s60, s56
    v_mfma_f32_32x32x16_bf16 v[80:95], v[20:23], v[196:199], v[80:95]
    ds_read_b128 v[20:23], v5 offset:20480
    s_lshl_b32 s60, s60, 7
    s_waitcnt vmcnt(12) lgkmcnt(3)
    v_mfma_f32_32x32x16_bf16 v[64:79], v[24:27], v[200:203], v[64:79]
    ds_read_b128 v[24:27], v2 offset:20480
    buffer_load_dwordx4 v[228:231], v1, s[8:11], s64 offen offset:1024 sc1
    s_add_u32 s60, s60, 98304
    v_mfma_f32_32x32x16_bf16 v[80:95], v[28:31], v[200:203], v[80:95]
    ds_read_b128 v[28:31], v5 offset:21504
    buffer_load_dwordx4 v1, s[8:11], s63 offen offset:1024 lds
    v_lshlrev_b32 v42, 9, v42
    s_waitcnt vmcnt(12) lgkmcnt(3)
    v_mfma_f32_32x32x16_bf16 v[64:79], v[32:35], v[204:207], v[64:79]
    ds_read_b128 v[32:35], v2 offset:21504
    buffer_load_dwordx4 v[232:235], v1, s[8:11], s64 offen offset:2048 sc1
    buffer_load_dwordx2 v[40:41], v42, s[8:11], s60 offen sc1
    v_mfma_f32_32x32x16_bf16 v[80:95], v[36:39], v[204:207], v[80:95]
    ds_read_b128 v[36:39], v5 offset:22528
    s_waitcnt vmcnt(13) lgkmcnt(3)
    v_mfma_f32_32x32x16_bf16 v[64:79], v[20:23], v[208:211], v[64:79]
    ds_read_b128 v[20:23], v2 offset:22528
    buffer_load_dwordx4 v[236:239], v1, s[8:11], s64 offen offset:3072 sc1
    buffer_load_dwordx4 v1, s[8:11], s63 offen offset:2048 lds
    v_mfma_f32_32x32x16_bf16 v[80:95], v[24:27], v[208:211], v[80:95]
    ds_read_b128 v[24:27], v5 offset:23552
    s_waitcnt vmcnt(13) lgkmcnt(3)
    v_mfma_f32_32x32x16_bf16 v[64:79], v[28:31], v[212:215], v[64:79]
    ds_read_b128 v[28:31], v2 offset:23552
    s_add_u32 s64, s39, 28672
    buffer_load_dwordx4 v[240:243], v1, s[8:11], s64 offen sc1
    v_mfma_f32_32x32x16_bf16 v[80:95], v[32:35], v[212:215], v[80:95]
    ds_read_b128 v[32:35], v5 offset:24576
    s_waitcnt vmcnt(12) lgkmcnt(3)
    v_mfma_f32_32x32x16_bf16 v[64:79], v[36:39], v[216:219], v[64:79]
    ds_read_b128 v[36:39], v2 offset:24576
    buffer_load_dwordx4 v[244:247], v1, s[8:11], s64 offen offset:1024 sc1
    buffer_load_dwordx4 v1, s[8:11], s63 offen offset:3072 lds
    v_mfma_f32_32x32x16_bf16 v[80:95], v[20:23], v[216:219], v[80:95]
    ds_read_b128 v[20:23], v5 offset:25600
    s_waitcnt vmcnt(11) lgkmcnt(3)
    v_mfma_f32_32x32x16_bf16 v[64:79], v[24:27], v[220:223], v[64:79]
    ds_read_b128 v[24:27], v2 offset:25600
    buffer_load_dwordx4 v[248:251], v1, s[8:11], s64 offen offset:2048 sc1
    v_mfma_f32_32x32x16_bf16 v[80:95], v[28:31], v[220:223], v[80:95]
    ds_read_b128 v[28:31], v5 offset:26624
    s_add_u32 m0, s14, 33792
    s_add_u32 s63, s46, 67584
    buffer_load_dword v11, s[8:11], s63 offen lds
    s_waitcnt vmcnt(11) lgkmcnt(3)
    v_mfma_f32_32x32x16_bf16 v[64:79], v[32:35], v[224:227], v[64:79]
    ds_read_b128 v[32:35], v2 offset:26624
    buffer_load_dwordx4 v[252:255], v1, s[8:11], s64 offen offset:3072 sc1
    v_mfma_f32_32x32x16_bf16 v[80:95], v[36:39], v[224:227], v[80:95]
    ds_read_b128 v[36:39], v5 offset:27648
    v_pk_add_f32 v[52:53], v[52:53], v[54:55] op_sel:[0,0] op_sel_hi:[1,1]
    s_waitcnt vmcnt(11) lgkmcnt(3)
    v_mfma_f32_32x32x16_bf16 v[64:79], v[20:23], v[228:231], v[64:79]
    ds_read_b128 v[20:23], v2 offset:27648
    v_pk_add_f32 v[56:57], v[56:57], v[58:59] op_sel:[0,0] op_sel_hi:[1,1]
    v_pk_add_f32 v[52:53], v[52:53], v[56:57] op_sel:[0,0] op_sel_hi:[1,1]
    v_add_f32 v52, v52, v53
    v_mfma_f32_32x32x16_bf16 v[80:95], v[24:27], v[228:231], v[80:95]
    ds_read_b128 v[24:27], v5 offset:28672
    v_mov_b32 v53, v52
    s_add_u32 m0, s52, 67584
    s_add_u32 s63, s47, 101376
    buffer_load_dwordx4 v1, s[8:11], s63 offen offset:0 lds
    s_waitcnt vmcnt(10) lgkmcnt(3)
    v_mfma_f32_32x32x16_bf16 v[64:79], v[28:31], v[232:235], v[64:79]
    ds_read_b128 v[28:31], v2 offset:28672
    v_permlane32_swap_b32 v52, v53
    buffer_load_dwordx4 v1, s[8:11], s63 offen offset:1024 lds
    v_mfma_f32_32x32x16_bf16 v[80:95], v[32:35], v[232:235], v[80:95]
    ds_read_b128 v[32:35], v5 offset:29696
    v_mul_f32 v52, 0xbb000000, v52
    v_mul_f32 v53, 0x3b000000, v53
    s_waitcnt vmcnt(9) lgkmcnt(3)
    v_mfma_f32_32x32x16_bf16 v[64:79], v[36:39], v[236:239], v[64:79]
    ds_read_b128 v[36:39], v2 offset:29696
    v_fma_f32 v53, -v52, v52, v53
    v_cvt_pk_bf16_f32 v16, v52, v52
    buffer_load_dwordx4 v1, s[8:11], s63 offen offset:2048 lds
    v_mfma_f32_32x32x16_bf16 v[80:95], v[20:23], v[236:239], v[80:95]
    ds_read_b128 v[20:23], v5 offset:30720
    v_max_f32 v53, 0, v53
    v_cvt_pk_bf16_f32 v17, v52, v52
    s_waitcnt vmcnt(8) lgkmcnt(3)
    v_mfma_f32_32x32x16_bf16 v[64:79], v[24:27], v[240:243], v[64:79]
    ds_read_b128 v[24:27], v2 offset:30720
    v_add_f32 v53, 0x3727c5ac, v53
    v_cvt_pk_bf16_f32 v18, v52, v52
    buffer_load_dwordx4 v1, s[8:11], s63 offen offset:3072 lds
    v_mfma_f32_32x32x16_bf16 v[80:95], v[28:31], v[240:243], v[80:95]
    ds_read_b128 v[28:31], v5 offset:32768
    v_rsq_f32 v12, v53
    s_add_u32 m0, s52, 71680
    s_add_u32 s63, s47, 105472
    buffer_load_dwordx4 v1, s[8:11], s63 offen offset:0 lds
    s_waitcnt vmcnt(9) lgkmcnt(3)
    v_mfma_f32_32x32x16_bf16 v[64:79], v[32:35], v[244:247], v[64:79]
    ds_read_b128 v[32:35], v2 offset:32768
    v_cvt_pk_bf16_f32 v19, v52, v52
    v_mul_f32 v13, v53, v12
    v_mfma_f32_32x32x16_bf16 v[80:95], v[36:39], v[244:247], v[80:95]
    ds_read_b128 v[36:39], v5 offset:31744
    v_mul_f32 v12, 0xbfb8aa3b, v12
    buffer_load_dwordx4 v1, s[8:11], s63 offen offset:1024 lds
    s_waitcnt vmcnt(8) lgkmcnt(3)
    v_mfma_f32_32x32x16_bf16 v[64:79], v[20:23], v[248:251], v[64:79]
    ds_read_b128 v[20:23], v2 offset:31744
    s_mov_b32 s62, 0
TG_38:
    v_and_b32 v14, 0xfffffff0, v41
    v_cmp_ne_u32 vcc, s34, v40
    v_cmp_ne_u32 s[58:59], s35, v14
    s_nop 0
    s_or_b64 s[58:59], vcc, s[58:59]
    s_cbranch_scc0 TGOK_39
    s_sleep 6
    buffer_load_dwordx2 v[40:41], v42, s[8:11], s60 offen sc1
    s_add_u32 s62, s62, 1
    s_cmp_gt_u32 s62, 0x80000
    s_cbranch_scc1 L_fail
    s_waitcnt vmcnt(0)
    s_branch TG_38
    TGOK_39:
    s_waitcnt vmcnt(7)
    s_barrier
    v_mfma_f32_32x32x16_bf16 v[80:95], v[24:27], v[248:251], v[80:95]
    ds_read_b128 v[24:27], v3 offset:0
    buffer_load_dwordx4 v1, s[8:11], s63 offen offset:2048 lds
    s_waitcnt lgkmcnt(3)
    v_mfma_f32_32x32x16_bf16 v[64:79], v[28:31], v[16:19], v[64:79]
    ds_read_b128 v[28:31], v3 offset:1024
    buffer_load_dwordx4 v1, s[8:11], s63 offen offset:3072 lds
    v_mfma_f32_32x32x16_bf16 v[80:95], v[32:35], v[16:19], v[80:95]
    ds_read_b128 v[32:35], v3 offset:2048
    s_waitcnt vmcnt(8) lgkmcnt(3)
    v_mfma_f32_32x32x16_bf16 v[64:79], v[36:39], v[252:255], v[64:79]
    ds_read_b128 v[36:39], v3 offset:3072
    s_add_u32 m0, s14, 67584
    s_add_u32 s63, s46, 101376
    buffer_load_dword v11, s[8:11], s63 offen lds
    v_mfma_f32_32x32x16_bf16 v[80:95], v[20:23], v[252:255], v[80:95]
    ds_read_b128 v[20:23], v3 offset:4096
    s_waitcnt lgkmcnt(3)
    v_mfma_f32_32x32x16_bf16 v[96:111], v[24:27], v[128:131], 0
    ds_read_b128 v[24:27], v3 offset:5120
    s_barrier
    v_mfma_f32_32x32x16_bf16 v[96:111], v[28:31], v[132:135], v[96:111]
    ds_read_b128 v[28:31], v3 offset:6144
    s_add_u32 s66, s48, 0
    buffer_load_dwordx4 a[0:3], v6, s[8:11], s66 offen
    s_waitcnt lgkmcnt(3)
    v_mfma_f32_32x32x16_bf16 v[96:111], v[32:35], v[136:139], v[96:111]
    ds_read_b128 v[32:35], v3 offset:7168
    v_mfma_f32_32x32x16_bf16 v[96:111], v[36:39], v[140:143], v[96:111]
    ds_read_b128 v[36:39], v3 offset:8192
    s_add_u32 m0, s52, 101376
    s_add_u32 s63, s47, 135168
    buffer_load_dwordx4 v1, s[8:11], s63 offen offset:0 lds
    v_mul_f32 v44, v64, v12
    s_waitcnt lgkmcnt(3)
    v_mfma_f32_32x32x16_bf16 v[96:111], v[20:23], v[144:147], v[96:111]
    ds_read_b128 v[20:23], v3 offset:9216
    v_mul_f32 v45, v65, v12
    v_exp_f32 v44, v44
    v_mul_f32 v46, v66, v12
    v_exp_f32 v45, v45
    v_mfma_f32_32x32x16_bf16 v[96:111], v[24:27], v[148:151], v[96:111]
    ds_read_b128 v[24:27], v3 offset:10240
    buffer_load_dwordx4 v1, s[8:11], s63 offen offset:1024 lds
    v_fma_f32 v44, v44, v13, v13
    v_mul_f32 v47, v67, v12
    v_exp_f32 v46, v46
    s_waitcnt lgkmcnt(3)
    v_mfma_f32_32x32x16_bf16 v[96:111], v[28:31], v[152:155], v[96:111]
    ds_read_b128 v[28:31], v3 offset:11264
    v_fma_f32 v45, v45, v13, v13
    v_rcp_f32 v44, v44
    v_mul_f32 v48, v68, v12
    v_exp_f32 v47, v47
    v_mfma_f32_32x32x16_bf16 v[96:111], v[32:35], v[156:159], v[96:111]
    ds_read_b128 v[32:35], v3 offset:12288
    buffer_load_dwordx4 a[4:7], v7, s[8:11], s66 offen
    v_fma_f32 v46, v46, v13, v13
    v_rcp_f32 v45, v45
    s_waitcnt lgkmcnt(3)
    v_mfma_f32_32x32x16_bf16 v[96:111], v[36:39], v[160:163], v[96:111]
    ds_read_b128 v[36:39], v3 offset:13312
    v_mul_f32 v44, v44, v72
    v_mul_f32 v49, v69, v12
    v_exp_f32 v48, v48
    v_fma_f32 v47, v47, v13, v13
    v_rcp_f32 v46, v46
    v_mfma_f32_32x32x16_bf16 v[96:111], v[20:23], v[164:167], v[96:111]
    ds_read_b128 v[20:23], v3 offset:14336
    buffer_load_dwordx4 v1, s[8:11], s63 offen offset:2048 lds
    v_mul_f32 v45, v45, v73
    v_mul_f32 v50, v70, v12
    s_waitcnt lgkmcnt(3)
    v_mfma_f32_32x32x16_bf16 v[96:111], v[24:27], v[168:171], v[96:111]
    ds_read_b128 v[24:27], v3 offset:15360
    v_exp_f32 v49, v49
    v_fma_f32 v48, v48, v13, v13
    v_rcp_f32 v47, v47
    v_mul_f32 v46, v46, v74
    v_cvt_pk_bf16_f32 v40, v44, v45
    v_mfma_f32_32x32x16_bf16 v[96:111], v[28:31], v[172:175], v[96:111]
    ds_read_b128 v[28:31], v3 offset:16384
    buffer_load_dwordx4 a[8:11], v6, s[8:11], s66 offen offset:2048
    v_mul_f32 v51, v71, v12
    v_exp_f32 v50, v50
    s_waitcnt lgkmcnt(3)
    v_mfma_f32_32x32x16_bf16 v[96:111], v[32:35], v[176:179], v[96:111]
    ds_read_b128 v[32:35], v3 offset:17408
    v_fma_f32 v49, v49, v13, v13
    v_rcp_f32 v48, v48
    v_mul_f32 v47, v47, v75
    v_exp_f32 v51, v51
    v_mfma_f32_32x32x16_bf16 v[96:111], v[36:39], v[180:183], v[96:111]
    ds_read_b128 v[36:39], v3 offset:18432
    buffer_load_dwordx4 v1, s[8:11], s63 offen offset:3072 lds
    v_fma_f32 v50, v50, v13, v13
    v_rcp_f32 v49, v49
    v_mul_f32 v48, v48, v76
    s_waitcnt lgkmcnt(3)
    v_mfma_f32_32x32x16_bf16 v[96:111], v[20:23], v[184:187], v[96:111]
    ds_read_b128 v[20:23], v3 offset:19456
    v_cvt_pk_bf16_f32 v41, v46, v47
    v_fma_f32 v51, v51, v13, v13
    v_rcp_f32 v50, v50
    v_mul_f32 v49, v49, v77
    v_mfma_f32_32x32x16_bf16 v[96:111], v[24:27], v[188:191], v[96:111]
    ds_read_b128 v[24:27], v3 offset:20480
    s_add_u32 m0, s52, 105472
    s_add_u32 s63, s47, 139264
    buffer_load_dwordx4 v1, s[8:11], s63 offen offset:0 lds
    v_rcp_f32 v51, v51
    s_waitcnt lgkmcnt(3)
    v_mfma_f32_32x32x16_bf16 v[96:111], v[28:31], v[192:195], v[96:111]
    ds_read_b128 v[28:31], v3 offset:21504
    v_mul_f32 v50, v50, v78
    v_cvt_pk_bf16_f32 v42, v48, v49
    v_mul_f32 v51, v51, v79
    v_cvt_pk_bf16_f32 v43, v50, v51
    s_add_u32 s65, s44, 0
    buffer_store_dwordx4 v[40:43], v1, s[8:11], s65 offen sc1
    v_mfma_f32_32x32x16_bf16 v[96:111], v[32:35], v[196:199], v[96:111]
    ds_read_b128 v[32:35], v3 offset:22528
    buffer_load_dwordx4 a[12:15], v7, s[8:11], s66 offen offset:2048
    v_mul_f32 v44, v80, v12
    v_mul_f32 v45, v81, v12
    s_waitcnt lgkmcnt(3)
    v_mfma_f32_32x32x16_bf16 v[96:111], v[36:39], v[200:203], v[96:111]
    ds_read_b128 v[36:39], v3 offset:23552
    v_exp_f32 v44, v44
    v_mul_f32 v46, v82, v12
    v_exp_f32 v45, v45
    v_fma_f32 v44, v44, v13, v13
    v_mfma_f32_32x32x16_bf16 v[96:111], v[20:23], v[204:207], v[96:111]
    ds_read_b128 v[20:23], v3 offset:24576
    buffer_load_dwordx4 v1, s[8:11], s63 offen offset:1024 lds
    v_mul_f32 v47, v83, v12
    v_exp_f32 v46, v46
    s_waitcnt lgkmcnt(3)
    v_mfma_f32_32x32x16_bf16 v[96:111], v[24:27], v[208:211], v[96:111]
    ds_read_b128 v[24:27], v3 offset:25600
    v_fma_f32 v45, v45, v13, v13
    v_rcp_f32 v44, v44
    v_mul_f32 v48, v84, v12
    v_exp_f32 v47, v47
    v_mfma_f32_32x32x16_bf16 v[96:111], v[28:31], v[212:215], v[96:111]
    ds_read_b128 v[28:31], v3 offset:26624
    s_add_u32 s66, s48, 4096
    buffer_load_dwordx4 a[16:19], v6, s[8:11], s66 offen
    v_fma_f32 v46, v46, v13, v13
    v_rcp_f32 v45, v45
    s_waitcnt lgkmcnt(3)
    v_mfma_f32_32x32x16_bf16 v[96:111], v[32:35], v[216:219], v[96:111]
    ds_read_b128 v[32:35], v3 offset:27648
    v_mul_f32 v44, v44, v88
    v_mul_f32 v49, v85, v12
    v_exp_f32 v48, v48
    v_fma_f32 v47, v47, v13, v13
    v_mfma_f32_32x32x16_bf16 v[96:111], v[36:39], v[220:223], v[96:111]
    ds_read_b128 v[36:39], v3 offset:28672
    buffer_load_dwordx4 v1, s[8:11], s63 offen offset:2048 lds
    v_rcp_f32 v46, v46
    v_mul_f32 v45, v45, v89
    v_mul_f32 v50, v86, v12
    s_waitcnt lgkmcnt(3)
    v_mfma_f32_32x32x16_bf16 v[96:111], v[20:23], v[224:227], v[96:111]
    ds_read_b128 v[20:23], v3 offset:29696
    v_exp_f32 v49, v49
    v_fma_f32 v48, v48, v13, v13
    v_rcp_f32 v47, v47
    v_mul_f32 v46, v46, v90
    v_mfma_f32_32x32x16_bf16 v[96:111], v[24:27], v[228:231], v[96:111]
    ds_read_b128 v[24:27], v3 offset:30720
    buffer_load_dwordx4 v1, s[8:11], s63 offen offset:3072 lds
    v_cvt_pk_bf16_f32 v40, v44, v45
    v_mul_f32 v51, v87, v12
    v_exp_f32 v50, v50
    s_waitcnt lgkmcnt(3)
    v_mfma_f32_32x32x16_bf16 v[96:111], v[28:31], v[232:235], v[96:111]
    ds_read_b128 v[28:31], v3 offset:31744
    v_fma_f32 v49, v49, v13, v13
    v_rcp_f32 v48, v48
    v_mul_f32 v47, v47, v91
    v_exp_f32 v51, v51
    v_mfma_f32_32x32x16_bf16 v[96:111], v[32:35], v[236:239], v[96:111]
    ds_read_b128 v[32:35], v3 offset:32768
    buffer_load_dwordx4 a[20:23], v7, s[8:11], s66 offen
    s_waitcnt vmcnt(15)
    s_barrier
    v_fma_f32 v50, v50, v13, v13
    s_waitcnt lgkmcnt(3)
    v_mfma_f32_32x32x16_bf16 v[96:111], v[36:39], v[240:243], v[96:111]
    ds_read_b128 v[36:39], v4 offset:0
    v_rcp_f32 v49, v49
    v_mul_f32 v48, v48, v92
    v_cvt_pk_bf16_f32 v41, v46, v47
    v_fma_f32 v51, v51, v13, v13
    v_rcp_f32 v50, v50
    v_mfma_f32_32x32x16_bf16 v[96:111], v[20:23], v[244:247], v[96:111]
    ds_read_b128 v[20:23], v4 offset:1024
    s_add_u32 m0, s14, 101376
    s_add_u32 s63, s46, 135168
    buffer_load_dword v11, s[8:11], s63 offen lds
    s_waitcnt lgkmcnt(3)
    v_mfma_f32_32x32x16_bf16 v[96:111], v[24:27], v[248:251], v[96:111]
    ds_read_b128 v[24:27], v4 offset:2048
    v_mul_f32 v49, v49, v93
    v_rcp_f32 v51, v51
    v_mul_f32 v50, v50, v94
    v_cvt_pk_bf16_f32 v42, v48, v49
    v_mul_f32 v51, v51, v95
    v_mfma_f32_32x32x16_bf16 v[96:111], v[28:31], v[252:255], v[96:111]
    ds_read_b128 v[28:31], v4 offset:3072
    v_cvt_pk_bf16_f32 v43, v50, v51
    s_add_u32 s65, s44, 1024
    buffer_store_dwordx4 v[40:43], v1, s[8:11], s65 offen sc1
    s_waitcnt lgkmcnt(3)
    v_mfma_f32_32x32x16_bf16 v[96:111], v[32:35], v[16:19], v[96:111]
    ds_read_b128 v[32:35], v4 offset:4096
    v_mfma_f32_32x32x16_bf16 v[112:127], v[36:39], v[128:131], 0
    ds_read_b128 v[36:39], v4 offset:5120
    s_waitcnt lgkmcnt(3)
    v_mfma_f32_32x32x16_bf16 v[112:127], v[20:23], v[132:135], v[112:127]
    ds_read_b128 v[20:23], v4 offset:6144
    buffer_load_dwordx4 a[24:27], v6, s[8:11], s66 offen offset:2048
    v_mfma_f32_32x32x16_bf16 v[112:127], v[24:27], v[136:139], v[112:127]
    ds_read_b128 v[24:27], v4 offset:7168
    s_waitcnt lgkmcnt(3)
    v_mfma_f32_32x32x16_bf16 v[112:127], v[28:31], v[140:143], v[112:127]
    ds_read_b128 v[28:31], v4 offset:8192
    s_add_u32 m0, s52, 0
    s_add_u32 s63, s47, 168960
    buffer_load_dwordx4 v1, s[8:11], s63 offen offset:0 lds
    v_mfma_f32_32x32x16_bf16 v[112:127], v[32:35], v[144:147], v[112:127]
    ds_read_b128 v[32:35], v4 offset:9216
    v_mul_f32 v44, v96, v12
    v_mul_f32 v45, v97, v12
    v_exp_f32 v44, v44
    s_waitcnt lgkmcnt(3)
    v_mfma_f32_32x32x16_bf16 v[112:127], v[36:39], v[148:151], v[112:127]
    ds_read_b128 v[36:39], v4 offset:10240
    buffer_load_dwordx4 v1, s[8:11], s63 offen offset:1024 lds
    v_mul_f32 v46, v98, v12
    v_mfma_f32_32x32x16_bf16 v[112:127], v[20:23], v[152:155], v[112:127]
    ds_read_b128 v[20:23], v4 offset:11264
    v_exp_f32 v45, v45
    v_fma_f32 v44, v44, v13, v13
    s_waitcnt lgkmcnt(3)
    v_mfma_f32_32x32x16_bf16 v[112:127], v[24:27], v[156:159], v[112:127]
    ds_read_b128 v[24:27], v4 offset:12288
    buffer_load_dwordx4 a[28:31], v7, s[8:11], s66 offen offset:2048
    v_mul_f32 v47, v99, v12
    v_exp_f32 v46, v46
    v_mfma_f32_32x32x16_bf16 v[112:127], v[28:31], v[160:163], v[112:127]
    ds_read_b128 v[28:31], v4 offset:13312
    v_fma_f32 v45, v45, v13, v13
    v_rcp_f32 v44, v44
    s_waitcnt lgkmcnt(3)
    v_mfma_f32_32x32x16_bf16 v[112:127], v[32:35], v[164:167], v[112:127]
    ds_read_b128 v[32:35], v4 offset:14336
    buffer_load_dwordx4 v1, s[8:11], s63 offen offset:2048 lds
    v_mul_f32 v48, v100, v12
    v_mfma_f32_32x32x16_bf16 v[112:127], v[36:39], v[168:171], v[112:127]
    ds_read_b128 v[36:39], v4 offset:15360
    v_exp_f32 v47, v47
    v_fma_f32 v46, v46, v13, v13
    s_waitcnt lgkmcnt(3)
    v_mfma_f32_32x32x16_bf16 v[112:127], v[20:23], v[172:175], v[112:127]
    ds_read_b128 v[20:23], v4 offset:16384
    s_add_u32 s66, s48, 14336
    buffer_load_dwordx4 a[32:35], v6, s[8:11], s66 offen
    v_rcp_f32 v45, v45
    v_mfma_f32_32x32x16_bf16 v[112:127], v[24:27], v[176:179], v[112:127]
    ds_read_b128 v[24:27], v4 offset:17408
    v_mul_f32 v44, v44, v104
    v_mul_f32 v49, v101, v12
    s_waitcnt lgkmcnt(3)
    v_mfma_f32_32x32x16_bf16 v[112:127], v[28:31], v[180:183], v[112:127]
    ds_read_b128 v[28:31], v4 offset:18432
    buffer_load_dwordx4 v1, s[8:11], s63 offen offset:3072 lds
    v_exp_f32 v48, v48
    v_mfma_f32_32x32x16_bf16 v[112:127], v[32:35], v[184:187], v[112:127]
    ds_read_b128 v[32:35], v4 offset:19456
    v_fma_f32 v47, v47, v13, v13
    v_rcp_f32 v46, v46
    s_waitcnt lgkmcnt(3)
    v_mfma_f32_32x32x16_bf16 v[112:127], v[36:39], v[188:191], v[112:127]
    ds_read_b128 v[36:39], v4 offset:20480
    s_add_u32 m0, s52, 4096
    s_add_u32 s63, s47, 173056
    buffer_load_dwordx4 v1, s[8:11], s63 offen offset:0 lds
    v_mfma_f32_32x32x16_bf16 v[112:127], v[20:23], v[192:195], v[112:127]
    ds_read_b128 v[20:23], v4 offset:21504
    v_mul_f32 v45, v45, v105
    v_mul_f32 v50, v102, v12
    v_exp_f32 v49, v49
    s_waitcnt lgkmcnt(3)
    v_mfma_f32_32x32x16_bf16 v[112:127], v[24:27], v[196:199], v[112:127]
    ds_read_b128 v[24:27], v4 offset:22528
    buffer_load_dwordx4 a[36:39], v7, s[8:11], s66 offen
    v_fma_f32 v48, v48, v13, v13
    v_mfma_f32_32x32x16_bf16 v[112:127], v[28:31], v[200:203], v[112:127]
    ds_read_b128 v[28:31], v4 offset:23552
    v_rcp_f32 v47, v47
    v_mul_f32 v46, v46, v106
    s_waitcnt lgkmcnt(3)
    v_mfma_f32_32x32x16_bf16 v[112:127], v[32:35], v[204:207], v[112:127]
    ds_read_b128 v[32:35], v4 offset:24576
    buffer_load_dwordx4 v1, s[8:11], s63 offen offset:1024 lds
    v_cvt_pk_bf16_f32 v40, v44, v45
    v_mul_f32 v51, v103, v12
    v_mfma_f32_32x32x16_bf16 v[112:127], v[36:39], v[208:211], v[112:127]
    ds_read_b128 v[36:39], v4 offset:25600
    v_exp_f32 v50, v50
    v_fma_f32 v49, v49, v13, v13
    s_waitcnt lgkmcnt(3)
    v_mfma_f32_32x32x16_bf16 v[112:127], v[20:23], v[212:215], v[112:127]
    ds_read_b128 v[20:23], v4 offset:26624
    buffer_load_dwordx4 a[40:43], v6, s[8:11], s66 offen offset:2048
    v_rcp_f32 v48, v48
    v_mfma_f32_32x32x16_bf16 v[112:127], v[24:27], v[216:219], v[112:127]
    ds_read_b128 v[24:27], v4 offset:27648
    v_mul_f32 v47, v47, v107
    v_exp_f32 v51, v51
    s_waitcnt lgkmcnt(3)
    v_mfma_f32_32x32x16_bf16 v[112:127], v[28:31], v[220:223], v[112:127]
    ds_read_b128 v[28:31], v4 offset:28672
    buffer_load_dwordx4 v1, s[8:11], s63 offen offset:2048 lds
    v_fma_f32 v50, v50, v13, v13
    v_rcp_f32 v49, v49
    v_mfma_f32_32x32x16_bf16 v[112:127], v[32:35], v[224:227], v[112:127]
    ds_read_b128 v[32:35], v4 offset:29696
    v_mul_f32 v48, v48, v108
    v_cvt_pk_bf16_f32 v41, v46, v47
    s_waitcnt lgkmcnt(3)
    v_mfma_f32_32x32x16_bf16 v[112:127], v[36:39], v[228:231], v[112:127]
    ds_read_b128 v[36:39], v4 offset:30720
    buffer_load_dwordx4 v1, s[8:11], s63 offen offset:3072 lds
    v_fma_f32 v51, v51, v13, v13
    v_rcp_f32 v50, v50
    v_mfma_f32_32x32x16_bf16 v[112:127], v[20:23], v[232:235], v[112:127]
    ds_read_b128 v[20:23], v4 offset:31744
    v_mul_f32 v49, v49, v109
    v_rcp_f32 v51, v51
    s_waitcnt lgkmcnt(3)
    v_mfma_f32_32x32x16_bf16 v[112:127], v[24:27], v[236:239], v[112:127]
    ds_read_b128 v[24:27], v4 offset:32768
    buffer_load_dwordx4 a[44:47], v7, s[8:11], s66 offen offset:2048
    s_waitcnt vmcnt(15)
    s_barrier
    v_mfma_f32_32x32x16_bf16 v[112:127], v[28:31], v[240:243], v[112:127]
    ds_read_b128 v[28:31], v5 offset:0
    v_mul_f32 v50, v50, v110
    v_cvt_pk_bf16_f32 v42, v48, v49
    s_waitcnt lgkmcnt(3)
    v_mfma_f32_32x32x16_bf16 v[112:127], v[32:35], v[244:247], v[112:127]
    ds_read_b128 v[32:35], v5 offset:1024
    s_add_u32 m0, s14, 0
    s_add_u32 s63, s46, 168960
    buffer_load_dword v11, s[8:11], s63 offen lds
    v_mfma_f32_32x32x16_bf16 v[112:127], v[36:39], v[248:251], v[112:127]
    ds_read_b128 v[36:39], v5 offset:2048
    v_mul_f32 v51, v51, v111
    v_cvt_pk_bf16_f32 v43, v50, v51
    s_waitcnt lgkmcnt(3)
    v_mfma_f32_32x32x16_bf16 v[112:127], v[20:23], v[252:255], v[112:127]
    ds_read_b128 v[20:23], v5 offset:3072
    s_add_u32 s65, s44, 2048
    buffer_store_dwordx4 v[40:43], v1, s[8:11], s65 offen sc1
    v_mfma_f32_32x32x16_bf16 v[112:127], v[24:27], v[16:19], v[112:127]
    ds_read_b128 v[24:27], v5 offset:4096
    s_waitcnt lgkmcnt(3)
    v_mfma_f32_32x32x16_bf16 v[64:79], v[28:31], v[128:131], 0
    ds_read_b128 v[28:31], v5 offset:5120
    s_barrier
    v_mfma_f32_32x32x16_bf16 v[64:79], v[32:35], v[132:135], v[64:79]
    ds_read_b128 v[32:35], v5 offset:6144
    s_add_u32 s66, s48, 18432
    buffer_load_dwordx4 a[48:51], v6, s[8:11], s66 offen
    v_add_u32 v52, s52, v4
    s_waitcnt lgkmcnt(3)
    v_mfma_f32_32x32x16_bf16 v[64:79], v[36:39], v[136:139], v[64:79]
    ds_read_b128 v[36:39], v5 offset:7168
    v_mfma_f32_32x32x16_bf16 v[64:79], v[20:23], v[140:143], v[64:79]
    ds_read_b128 v[20:23], v5 offset:8192
    s_add_u32 m0, s52, 33792
    s_add_u32 s63, s47, 202752
    buffer_load_dwordx4 v1, s[8:11], s63 offen offset:0 lds
    s_add_u32 s60, s14, 67584
    v_add_u32 v53, s60, v11
    s_waitcnt lgkmcnt(3)
    v_mfma_f32_32x32x16_bf16 v[64:79], v[24:27], v[144:147], v[64:79]
    ds_read_b128 v[24:27], v5 offset:9216
    v_mul_f32 v44, v112, v12
    v_mul_f32 v45, v113, v12
    v_exp_f32 v44, v44
    v_mfma_f32_32x32x16_bf16 v[64:79], v[28:31], v[148:151], v[64:79]
    ds_read_b128 v[28:31], v5 offset:10240
    ds_write_b128 v52, a[128:131] offset:0
    v_mul_f32 v46, v114, v12
    v_exp_f32 v45, v45
    s_waitcnt lgkmcnt(4)
    v_mfma_f32_32x32x16_bf16 v[64:79], v[32:35], v[152:155], v[64:79]
    ds_read_b128 v[32:35], v5 offset:11264
    buffer_load_dwordx4 v1, s[8:11], s63 offen offset:1024 lds
    v_fma_f32 v44, v44, v13, v13
    v_mul_f32 v47, v115, v12
    v_mfma_f32_32x32x16_bf16 v[64:79], v[36:39], v[156:159], v[64:79]
    ds_read_b128 v[36:39], v5 offset:12288
    ds_write_b128 v52, a[132:135] offset:1024
    v_exp_f32 v46, v46
    v_fma_f32 v45, v45, v13, v13
    s_waitcnt lgkmcnt(5)
    v_mfma_f32_32x32x16_bf16 v[64:79], v[20:23], v[160:163], v[64:79]
    ds_read_b128 v[20:23], v5 offset:13312
    buffer_load_dwordx4 v1, s[8:11], s63 offen offset:2048 lds
    v_rcp_f32 v44, v44
    v_mul_f32 v48, v116, v12
    v_mfma_f32_32x32x16_bf16 v[64:79], v[24:27], v[164:167], v[64:79]
    ds_read_b128 v[24:27], v5 offset:14336
    ds_write_b128 v52, a[136:139] offset:2048
    v_exp_f32 v47, v47
    v_fma_f32 v46, v46, v13, v13
    s_waitcnt lgkmcnt(5)
    v_mfma_f32_32x32x16_bf16 v[64:79], v[28:31], v[168:171], v[64:79]
    ds_read_b128 v[28:31], v5 offset:15360
    v_rcp_f32 v45, v45
    v_mul_f32 v44, v44, v120
    v_mul_f32 v49, v117, v12
    v_exp_f32 v48, v48
    v_mfma_f32_32x32x16_bf16 v[64:79], v[32:35], v[172:175], v[64:79]
    ds_read_b128 v[32:35], v5 offset:16384
    buffer_load_dwordx4 a[52:55], v7, s[8:11], s66 offen
    ds_write_b128 v52, a[140:143] offset:3072
    v_fma_f32 v47, v47, v13, v13
    s_waitcnt lgkmcnt(5)
    v_mfma_f32_32x32x16_bf16 v[64:79], v[36:39], v[176:179], v[64:79]
    ds_read_b128 v[36:39], v5 offset:17408
    v_rcp_f32 v46, v46
    v_mul_f32 v45, v45, v121
    v_mul_f32 v50, v118, v12
    v_mfma_f32_32x32x16_bf16 v[64:79], v[20:23], v[180:183], v[64:79]
    ds_read_b128 v[20:23], v5 offset:18432
    buffer_load_dwordx4 v1, s[8:11], s63 offen offset:3072 lds
    v_exp_f32 v49, v49
    v_fma_f32 v48, v48, v13, v13
    s_waitcnt lgkmcnt(4)
    v_mfma_f32_32x32x16_bf16 v[64:79], v[24:27], v[184:187], v[64:79]
    ds_read_b128 v[24:27], v5 offset:19456
    ds_write_b128 v52, a[144:147] offset:4096
    v_rcp_f32 v47, v47
    v_mul_f32 v46, v46, v122
    v_cvt_pk_bf16_f32 v40, v44, v45
    v_mfma_f32_32x32x16_bf16 v[64:79], v[28:31], v[188:191], v[64:79]
    ds_read_b128 v[28:31], v5 offset:20480
    v_mul_f32 v51, v119, v12
    v_exp_f32 v50, v50
    v_fma_f32 v49, v49, v13, v13
    s_waitcnt lgkmcnt(4)
    v_mfma_f32_32x32x16_bf16 v[64:79], v[32:35], v[192:195], v[64:79]
    ds_read_b128 v[32:35], v5 offset:21504
    s_add_u32 m0, s52, 37888
    s_add_u32 s63, s47, 206848
    buffer_load_dwordx4 v1, s[8:11], s63 offen offset:0 lds
    ds_write_b128 v52, a[148:151] offset:5120
    v_mfma_f32_32x32x16_bf16 v[64:79], v[36:39], v[196:199], v[64:79]
    ds_read_b128 v[36:39], v5 offset:22528
    v_rcp_f32 v48, v48
    v_mul_f32 v47, v47, v123
    v_exp_f32 v51, v51
    s_waitcnt lgkmcnt(5)
    v_mfma_f32_32x32x16_bf16 v[64:79], v[20:23], v[200:203], v[64:79]
    ds_read_b128 v[20:23], v5 offset:23552
    ds_write_b128 v52, a[152:155] offset:6144
    v_fma_f32 v50, v50, v13, v13
    v_rcp_f32 v49, v49
    v_mul_f32 v48, v48, v124
    v_mfma_f32_32x32x16_bf16 v[64:79], v[24:27], v[204:207], v[64:79]
    ds_read_b128 v[24:27], v5 offset:24576
    buffer_load_dwordx4 v1, s[8:11], s63 offen offset:1024 lds
    v_cvt_pk_bf16_f32 v41, v46, v47
    v_fma_f32 v51, v51, v13, v13
    s_waitcnt lgkmcnt(5)
    v_mfma_f32_32x32x16_bf16 v[64:79], v[28:31], v[208:211], v[64:79]
    ds_read_b128 v[28:31], v5 offset:25600
    ds_write_b128 v52, a[156:159] offset:7168
    v_rcp_f32 v50, v50
    v_mul_f32 v49, v49, v125
    v_mfma_f32_32x32x16_bf16 v[64:79], v[32:35], v[212:215], v[64:79]
    ds_read_b128 v[32:35], v5 offset:26624
    buffer_load_dwordx4 a[56:59], v6, s[8:11], s66 offen offset:2048
    v_rcp_f32 v51, v51
    v_mul_f32 v50, v50, v126
    s_waitcnt lgkmcnt(5)
    v_mfma_f32_32x32x16_bf16 v[64:79], v[36:39], v[216:219], v[64:79]
    ds_read_b128 v[36:39], v5 offset:27648
    ds_write_b32 v53, a124
    v_cvt_pk_bf16_f32 v42, v48, v49
    v_mul_f32 v51, v51, v127
    v_cvt_pk_bf16_f32 v43, v50, v51
    v_mfma_f32_32x32x16_bf16 v[64:79], v[20:23], v[220:223], v[64:79]
    ds_read_b128 v[20:23], v5 offset:28672
    s_add_u32 s65, s44, 3072
    buffer_store_dwordx4 v[40:43], v1, s[8:11], s65 offen sc1
    s_waitcnt lgkmcnt(5)
    v_mfma_f32_32x32x16_bf16 v[64:79], v[24:27], v[224:227], v[64:79]
    ds_read_b128 v[24:27], v5 offset:29696
    buffer_load_dwordx4 v1, s[8:11], s63 offen offset:2048 lds
    v_mfma_f32_32x32x16_bf16 v[64:79], v[28:31], v[228:231], v[64:79]
    ds_read_b128 v[28:31], v5 offset:30720
    s_waitcnt lgkmcnt(4)
    v_mfma_f32_32x32x16_bf16 v[64:79], v[32:35], v[232:235], v[64:79]
    ds_read_b128 v[32:35], v5 offset:31744
    buffer_load_dwordx4 v1, s[8:11], s63 offen offset:3072 lds
    v_mfma_f32_32x32x16_bf16 v[64:79], v[36:39], v[236:239], v[64:79]
    ds_read_b128 v[36:39], v5 offset:32768
    s_waitcnt vmcnt(13)
    s_barrier
    s_waitcnt lgkmcnt(3)
    v_mfma_f32_32x32x16_bf16 v[64:79], v[20:23], v[240:243], v[64:79]
    ds_read_b128 v[20:23], v2 offset:0
    v_mfma_f32_32x32x16_bf16 v[64:79], v[24:27], v[244:247], v[64:79]
    ds_read_b128 v[24:27], v2 offset:1024
    s_add_u32 m0, s14, 33792
    s_add_u32 s63, s46, 202752
    buffer_load_dword v11, s[8:11], s63 offen lds
    s_waitcnt lgkmcnt(3)
    v_mfma_f32_32x32x16_bf16 v[64:79], v[28:31], v[248:251], v[64:79]
    ds_read_b128 v[28:31], v2 offset:2048
    v_mfma_f32_32x32x16_bf16 v[64:79], v[32:35], v[252:255], v[64:79]
    ds_read_b128 v[32:35], v2 offset:3072
    s_waitcnt lgkmcnt(3)
    v_mfma_f32_32x32x16_bf16 v[64:79], v[36:39], v[16:19], v[64:79]
    ds_read_b128 v[36:39], v2 offset:4096
    v_mfma_f32_32x32x16_bf16 v[96:111], v[20:23], v[128:131], 0
    ds_read_b128 v[20:23], v2 offset:5120
    s_barrier
    buffer_load_dwordx4 a[128:131], v7, s[8:11], s66 offen offset:2048
    s_waitcnt lgkmcnt(3)
    v_mfma_f32_32x32x16_bf16 v[96:111], v[24:27], v[132:135], v[96:111]
    ds_read_b128 v[24:27], v2 offset:6144
    v_add_u32 v52, s52, v5
    v_mfma_f32_32x32x16_bf16 v[96:111], v[28:31], v[136:139], v[96:111]
    ds_read_b128 v[28:31], v2 offset:7168
    s_waitcnt lgkmcnt(3)
    v_mfma_f32_32x32x16_bf16 v[96:111], v[32:35], v[140:143], v[96:111]
    ds_read_b128 v[32:35], v2 offset:8192
    s_add_u32 s60, s14, 101376
    v_add_u32 v53, s60, v11
    v_mul_f32 v44, v64, v12
    v_mul_f32 v45, v65, v12
    v_mfma_f32_32x32x16_bf16 v[96:111], v[36:39], v[144:147], v[96:111]
    ds_read_b128 v[36:39], v2 offset:9216
    s_add_u32 s66, s48, 28672
    buffer_load_dwordx4 a[132:135], v6, s[8:11], s66 offen
    s_waitcnt lgkmcnt(3)
    v_mfma_f32_32x32x16_bf16 v[96:111], v[20:23], v[148:151], v[96:111]
    ds_read_b128 v[20:23], v2 offset:10240
    ds_write_b128 v52, a[160:163] offset:0
    v_exp_f32 v44, v44
    v_mul_f32 v46, v66, v12
    v_mfma_f32_32x32x16_bf16 v[96:111], v[24:27], v[152:155], v[96:111]
    ds_read_b128 v[24:27], v2 offset:11264
    v_exp_f32 v45, v45
    v_fma_f32 v44, v44, v13, v13
    s_waitcnt lgkmcnt(4)
    v_mfma_f32_32x32x16_bf16 v[96:111], v[28:31], v[156:159], v[96:111]
    ds_read_b128 v[28:31], v2 offset:12288
    ds_write_b128 v52, a[164:167] offset:1024
    v_mul_f32 v47, v67, v12
    v_exp_f32 v46, v46
    v_mfma_f32_32x32x16_bf16 v[96:111], v[32:35], v[160:163], v[96:111]
    ds_read_b128 v[32:35], v2 offset:13312
    buffer_load_dwordx4 a[136:139], v7, s[8:11], s66 offen
    v_fma_f32 v45, v45, v13, v13
    s_waitcnt lgkmcnt(5)
    v_mfma_f32_32x32x16_bf16 v[96:111], v[36:39], v[164:167], v[96:111]
    ds_read_b128 v[36:39], v2 offset:14336
    ds_write_b128 v52, a[168:171] offset:2048
    v_rcp_f32 v44, v44
    v_mul_f32 v48, v68, v12
    v_mfma_f32_32x32x16_bf16 v[96:111], v[20:23], v[168:171], v[96:111]
    ds_read_b128 v[20:23], v2 offset:15360
    v_exp_f32 v47, v47
    v_fma_f32 v46, v46, v13, v13
    s_waitcnt lgkmcnt(5)
    v_mfma_f32_32x32x16_bf16 v[96:111], v[24:27], v[172:175], v[96:111]
    ds_read_b128 v[24:27], v2 offset:16384
    ds_write_b128 v52, a[172:175] offset:3072
    v_rcp_f32 v45, v45
    v_mul_f32 v44, v44, v72
    v_mfma_f32_32x32x16_bf16 v[96:111], v[28:31], v[176:179], v[96:111]
    ds_read_b128 v[28:31], v2 offset:17408
    buffer_load_dwordx4 a[140:143], v6, s[8:11], s66 offen offset:2048
    v_mul_f32 v49, v69, v12
    s_waitcnt lgkmcnt(5)
    v_mfma_f32_32x32x16_bf16 v[96:111], v[32:35], v[180:183], v[96:111]
    ds_read_b128 v[32:35], v2 offset:18432
    v_exp_f32 v48, v48
    v_fma_f32 v47, v47, v13, v13
    v_rcp_f32 v46, v46
    v_mfma_f32_32x32x16_bf16 v[96:111], v[36:39], v[184:187], v[96:111]
    ds_read_b128 v[36:39], v2 offset:19456
    ds_write_b128 v52, a[176:179] offset:4096
    v_mul_f32 v45, v45, v73
    s_waitcnt lgkmcnt(5)
    v_mfma_f32_32x32x16_bf16 v[96:111], v[20:23], v[188:191], v[96:111]
    ds_read_b128 v[20:23], v2 offset:20480
    v_mul_f32 v50, v70, v12
    v_exp_f32 v49, v49
    v_fma_f32 v48, v48, v13, v13
    v_mfma_f32_32x32x16_bf16 v[96:111], v[24:27], v[192:195], v[96:111]
    ds_read_b128 v[24:27], v2 offset:21504
    buffer_load_dwordx4 a[144:147], v7, s[8:11], s66 offen offset:2048
    ds_write_b128 v52, a[180:183] offset:5120
    s_waitcnt lgkmcnt(5)
    v_mfma_f32_32x32x16_bf16 v[96:111], v[28:31], v[196:199], v[96:111]
    ds_read_b128 v[28:31], v2 offset:22528
    v_rcp_f32 v47, v47
    v_mul_f32 v46, v46, v74
    v_cvt_pk_bf16_f32 v40, v44, v45
    v_mul_f32 v51, v71, v12
    v_mfma_f32_32x32x16_bf16 v[96:111], v[32:35], v[200:203], v[96:111]
    ds_read_b128 v[32:35], v2 offset:23552
    ds_write_b128 v52, a[184:187] offset:6144
    v_mov_b32 v62, 4
    s_waitcnt vmcnt(8)
    s_mov_b64 exec, 1
    s_cmp_eq_u32 s12, 0
    s_cbranch_scc1 WT_33
    buffer_store_dword v62, v10, s[8:11], s38 offen
RT_34:
    s_mov_b64 exec, -1
    s_waitcnt lgkmcnt(5)
    v_mfma_f32_32x32x16_bf16 v[96:111], v[36:39], v[204:207], v[96:111]
    ds_read_b128 v[36:39], v2 offset:24576
    v_mfma_f32_32x32x16_bf16 v[96:111], v[20:23], v[208:211], v[96:111]
    ds_read_b128 v[20:23], v2 offset:25600
    s_add_u32 s66, s48, 32768
    buffer_load_dwordx4 a[148:151], v6, s[8:11], s66 offen
    ds_write_b128 v52, a[188:191] offset:7168
    s_waitcnt lgkmcnt(5)
    v_mfma_f32_32x32x16_bf16 v[96:111], v[24:27], v[212:215], v[96:111]
    ds_read_b128 v[24:27], v2 offset:26624
    v_mfma_f32_32x32x16_bf16 v[96:111], v[28:31], v[216:219], v[96:111]
    ds_read_b128 v[28:31], v2 offset:27648
    ds_write_b32 v53, a125
    s_waitcnt lgkmcnt(5)
    v_mfma_f32_32x32x16_bf16 v[96:111], v[32:35], v[220:223], v[96:111]
    ds_read_b128 v[32:35], v2 offset:28672
    v_exp_f32 v50, v50
    v_fma_f32 v49, v49, v13, v13
    v_rcp_f32 v48, v48
    v_mfma_f32_32x32x16_bf16 v[96:111], v[36:39], v[224:227], v[96:111]
    ds_read_b128 v[36:39], v2 offset:29696
    buffer_load_dwordx4 a[152:155], v7, s[8:11], s66 offen
    v_mul_f32 v47, v47, v75
    s_waitcnt lgkmcnt(4)
    v_mfma_f32_32x32x16_bf16 v[96:111], v[20:23], v[228:231], v[96:111]
    ds_read_b128 v[20:23], v2 offset:30720
    v_exp_f32 v51, v51
    v_fma_f32 v50, v50, v13, v13
    v_mfma_f32_32x32x16_bf16 v[96:111], v[24:27], v[232:235], v[96:111]
    ds_read_b128 v[24:27], v2 offset:31744
    v_rcp_f32 v49, v49
    v_mul_f32 v48, v48, v76
    v_cvt_pk_bf16_f32 v41, v46, v47
    s_waitcnt lgkmcnt(3)
    v_mfma_f32_32x32x16_bf16 v[96:111], v[28:31], v[236:239], v[96:111]
    ds_read_b128 v[28:31], v2 offset:32768
    s_waitcnt vmcnt(8)
    s_barrier
    v_fma_f32 v51, v51, v13, v13
    v_mfma_f32_32x32x16_bf16 v[96:111], v[32:35], v[240:243], v[96:111]
    ds_read_b128 v[32:35], v3 offset:0
    buffer_load_dwordx4 a[156:159], v6, s[8:11], s66 offen offset:2048
    v_rcp_f32 v50, v50
    s_waitcnt lgkmcnt(3)
    v_mfma_f32_32x32x16_bf16 v[96:111], v[36:39], v[244:247], v[96:111]
    ds_read_b128 v[36:39], v3 offset:1024
    v_mul_f32 v49, v49, v77
    v_rcp_f32 v51, v51
    v_mul_f32 v50, v50, v78
    v_mfma_f32_32x32x16_bf16 v[96:111], v[20:23], v[248:251], v[96:111]
    ds_read_b128 v[20:23], v3 offset:2048
    v_cvt_pk_bf16_f32 v42, v48, v49
    v_mul_f32 v51, v51, v79
    v_cvt_pk_bf16_f32 v43, v50, v51
    s_waitcnt lgkmcnt(3)
    v_mfma_f32_32x32x16_bf16 v[96:111], v[24:27], v[252:255], v[96:111]
    ds_read_b128 v[24:27], v3 offset:3072
    s_add_u32 s65, s44, 4096
    buffer_store_dwordx4 v[40:43], v1, s[8:11], s65 offen sc1
    v_mfma_f32_32x32x16_bf16 v[96:111], v[28:31], v[16:19], v[96:111]
    ds_read_b128 v[28:31], v3 offset:4096
    s_waitcnt lgkmcnt(3)
    v_mfma_f32_32x32x16_bf16 v[112:127], v[32:35], v[128:131], 0
    ds_read_b128 v[32:35], v3 offset:5120
    s_barrier
    buffer_load_dwordx4 a[160:163], v7, s[8:11], s66 offen offset:2048
    v_mfma_f32_32x32x16_bf16 v[112:127], v[36:39], v[132:135], v[112:127]
    ds_read_b128 v[36:39], v3 offset:6144
    s_add_u32 s66, s48, 43008
    buffer_load_dwordx4 a[164:167], v6, s[8:11], s66 offen
    v_add_u32 v52, s52, v2
    buffer_load_dword v63, v9, s[8:11], s37 offen sc1
    s_waitcnt lgkmcnt(3)
    v_mfma_f32_32x32x16_bf16 v[112:127], v[20:23], v[136:139], v[112:127]
    ds_read_b128 v[20:23], v3 offset:7168
    v_accvgpr_read_b32 v64, a224
    v_accvgpr_read_b32 v65, a225
    v_mfma_f32_32x32x16_bf16 v[112:127], v[24:27], v[140:143], v[112:127]
    ds_read_b128 v[24:27], v3 offset:8192
    buffer_load_dwordx4 a[168:171], v7, s[8:11], s66 offen
    s_add_u32 s60, s14, 0
    v_add_u32 v53, s60, v11
    s_waitcnt lgkmcnt(3)
    v_mfma_f32_32x32x16_bf16 v[112:127], v[28:31], v[144:147], v[112:127]
    ds_read_b128 v[28:31], v3 offset:9216
    v_mul_f32 v44, v96, v12
    v_mul_f32 v45, v97, v12
    v_exp_f32 v44, v44
    v_mfma_f32_32x32x16_bf16 v[112:127], v[32:35], v[148:151], v[112:127]
    ds_read_b128 v[32:35], v3 offset:10240
    buffer_load_dwordx4 a[172:175], v6, s[8:11], s66 offen offset:2048
    ds_write_b128 v52, a[192:195] offset:0
    v_mul_f32 v46, v98, v12
    s_waitcnt lgkmcnt(4)
    v_mfma_f32_32x32x16_bf16 v[112:127], v[36:39], v[152:155], v[112:127]
    ds_read_b128 v[36:39], v3 offset:11264
    v_accvgpr_read_b32 v66, a226
    v_exp_f32 v45, v45
    v_fma_f32 v44, v44, v13, v13
    v_mul_f32 v47, v99, v12
    v_mfma_f32_32x32x16_bf16 v[112:127], v[20:23], v[156:159], v[112:127]
    ds_read_b128 v[20:23], v3 offset:12288
    buffer_load_dwordx4 a[176:179], v7, s[8:11], s66 offen offset:2048
    ds_write_b128 v52, a[196:199] offset:1024
    s_waitcnt lgkmcnt(5)
    v_mfma_f32_32x32x16_bf16 v[112:127], v[24:27], v[160:163], v[112:127]
    ds_read_b128 v[24:27], v3 offset:13312
    v_accvgpr_read_b32 v67, a227
    v_exp_f32 v46, v46
    v_fma_f32 v45, v45, v13, v13
    v_mfma_f32_32x32x16_bf16 v[112:127], v[28:31], v[164:167], v[112:127]
    ds_read_b128 v[28:31], v3 offset:14336
    s_add_u32 s66, s48, 47104
    buffer_load_dwordx4 a[180:183], v6, s[8:11], s66 offen
    ds_write_b128 v52, a[200:203] offset:2048
    s_waitcnt lgkmcnt(5)
    v_mfma_f32_32x32x16_bf16 v[112:127], v[32:35], v[168:171], v[112:127]
    ds_read_b128 v[32:35], v3 offset:15360
    v_rcp_f32 v44, v44
    v_mul_f32 v48, v100, v12
    v_exp_f32 v47, v47
    v_mfma_f32_32x32x16_bf16 v[112:127], v[36:39], v[172:175], v[112:127]
    ds_read_b128 v[36:39], v3 offset:16384
    buffer_load_dwordx4 a[184:187], v7, s[8:11], s66 offen
    ds_write_b128 v52, a[204:207] offset:3072
    v_fma_f32 v46, v46, v13, v13
    s_waitcnt lgkmcnt(5)
    v_mfma_f32_32x32x16_bf16 v[112:127], v[20:23], v[176:179], v[112:127]
    ds_read_b128 v[20:23], v3 offset:17408
    v_accvgpr_read_b32 v68, a228
    v_rcp_f32 v45, v45
    v_mul_f32 v44, v44, v104
    v_mul_f32 v49, v101, v12
    v_mfma_f32_32x32x16_bf16 v[112:127], v[24:27], v[180:183], v[112:127]
    ds_read_b128 v[24:27], v3 offset:18432
    buffer_load_dwordx4 a[188:191], v6, s[8:11], s66 offen offset:2048
    v_exp_f32 v48, v48
    s_waitcnt lgkmcnt(4)
    v_mfma_f32_32x32x16_bf16 v[112:127], v[28:31], v[184:187], v[112:127]
    ds_read_b128 v[28:31], v3 offset:19456
    ds_write_b128 v52, a[208:211] offset:4096
    v_fma_f32 v47, v47, v13, v13
    v_rcp_f32 v46, v46
    v_mfma_f32_32x32x16_bf16 v[112:127], v[32:35], v[188:191], v[112:127]
    ds_read_b128 v[32:35], v3 offset:20480
    s_waitcnt vmcnt(6)
    v_cmp_gt_u32 vcc, 4, v63
    s_cbranch_vccz OK_40
    s_mov_b32 s62, 0
    SP_41:
    buffer_load_dword v63, v9, s[8:11], s37 offen sc1
    s_add_u32 s62, s62, 1
    s_cmp_gt_u32 s62, 0x200000
    s_cbranch_scc1 L_fail
    s_waitcnt vmcnt(0)
    v_cmp_gt_u32 vcc, 4, v63
    s_cbranch_vccnz SP_41
    OK_40:
    v_accvgpr_read_b32 v69, a229
    v_mul_f32 v45, v45, v105
    v_mul_f32 v50, v102, v12
    s_waitcnt lgkmcnt(4)
    v_mfma_f32_32x32x16_bf16 v[112:127], v[36:39], v[192:195], v[112:127]
    ds_read_b128 v[36:39], v3 offset:21504
    ds_write_b128 v52, a[212:215] offset:5120
    s_add_u32 s64, s45, 0
    buffer_load_dwordx4 v[128:131], v1, s[8:11], s64 offen sc1
    v_mfma_f32_32x32x16_bf16 v[112:127], v[20:23], v[196:199], v[112:127]
    ds_read_b128 v[20:23], v3 offset:22528
    buffer_load_dwordx4 v[132:135], v1, s[8:11], s64 offen offset:1024 sc1
    v_exp_f32 v49, v49
    s_waitcnt lgkmcnt(5)
    v_mfma_f32_32x32x16_bf16 v[112:127], v[24:27], v[200:203], v[112:127]
    ds_read_b128 v[24:27], v3 offset:23552
    ds_write_b128 v52, a[216:219] offset:6144
    buffer_load_dwordx4 v[136:139], v1, s[8:11], s64 offen offset:2048 sc1
    v_fma_f32 v48, v48, v13, v13
    v_mfma_f32_32x32x16_bf16 v[112:127], v[28:31], v[204:207], v[112:127]
    ds_read_b128 v[28:31], v3 offset:24576
    buffer_load_dwordx4 v[140:143], v1, s[8:11], s64 offen offset:3072 sc1
    v_rcp_f32 v47, v47
    s_waitcnt lgkmcnt(5)
    v_mfma_f32_32x32x16_bf16 v[112:127], v[32:35], v[208:211], v[112:127]
    ds_read_b128 v[32:35], v3 offset:25600
    ds_write_b128 v52, a[220:223] offset:7168
    s_add_u32 s64, s45, 7168
    buffer_load_dwordx4 v[144:147], v1, s[8:11], s64 offen sc1
    v_mul_f32 v46, v46, v106
    v_mfma_f32_32x32x16_bf16 v[112:127], v[36:39], v[212:215], v[112:127]
    ds_read_b128 v[36:39], v3 offset:26624
    buffer_load_dwordx4 v[148:151], v1, s[8:11], s64 offen offset:1024 sc1
    v_cvt_pk_bf16_f32 v40, v44, v45
    s_waitcnt lgkmcnt(5)
    v_mfma_f32_32x32x16_bf16 v[112:127], v[20:23], v[216:219], v[112:127]
    ds_read_b128 v[20:23], v3 offset:27648
    ds_write_b32 v53, a126
    buffer_load_dwordx4 v[152:155], v1, s[8:11], s64 offen offset:2048 sc1
    v_mul_f32 v51, v103, v12
    v_exp_f32 v50, v50
    v_mfma_f32_32x32x16_bf16 v[112:127], v[24:27], v[220:223], v[112:127]
    ds_read_b128 v[24:27], v3 offset:28672
    buffer_load_dwordx4 v[156:159], v1, s[8:11], s64 offen offset:3072 sc1
    v_fma_f32 v49, v49, v13, v13
    s_waitcnt lgkmcnt(5)
    v_mfma_f32_32x32x16_bf16 v[112:127], v[28:31], v[224:227], v[112:127]
    ds_read_b128 v[28:31], v3 offset:29696
    s_add_u32 s64, s45, 14336
    buffer_load_dwordx4 v[160:163], v1, s[8:11], s64 offen sc1
    v_rcp_f32 v48, v48
    v_mfma_f32_32x32x16_bf16 v[112:127], v[32:35], v[228:231], v[112:127]
    ds_read_b128 v[32:35], v3 offset:30720
    buffer_load_dwordx4 v[164:167], v1, s[8:11], s64 offen offset:1024 sc1
    v_mul_f32 v47, v47, v107
    s_waitcnt lgkmcnt(4)
    v_mfma_f32_32x32x16_bf16 v[112:127], v[36:39], v[232:235], v[112:127]
    ds_read_b128 v[36:39], v3 offset:31744
    v_exp_f32 v51, v51
    v_fma_f32 v50, v50, v13, v13
    v_rcp_f32 v49, v49
    v_mfma_f32_32x32x16_bf16 v[112:127], v[20:23], v[236:239], v[112:127]
    ds_read_b128 v[20:23], v3 offset:32768
    v_mul_f32 v48, v48, v108
    v_cvt_pk_bf16_f32 v41, v46, v47
    v_fma_f32 v51, v51, v13, v13
    s_waitcnt lgkmcnt(3)
    v_mfma_f32_32x32x16_bf16 v[112:127], v[24:27], v[240:243], v[112:127]
    v_rcp_f32 v50, v50
    v_mul_f32 v49, v49, v109
    v_rcp_f32 v51, v51
    v_mfma_f32_32x32x16_bf16 v[112:127], v[28:31], v[244:247], v[112:127]
    v_mul_f32 v50, v50, v110
    v_cvt_pk_bf16_f32 v42, v48, v49
    v_mul_f32 v51, v51, v111
    v_cvt_pk_bf16_f32 v43, v50, v51
    s_waitcnt lgkmcnt(1)
    v_mfma_f32_32x32x16_bf16 v[112:127], v[32:35], v[248:251], v[112:127]
    v_accvgpr_read_b32 v70, a230
    v_accvgpr_read_b32 v71, a231
    s_add_u32 s65, s44, 5120
    buffer_store_dwordx4 v[40:43], v1, s[8:11], s65 offen sc1
    v_mfma_f32_32x32x16_bf16 v[112:127], v[36:39], v[252:255], v[112:127]
    v_pk_mul_f32 v[72:73], v[10:11], v[10:11] op_sel:[0,0] op_sel_hi:[0,0]
    v_pk_mul_f32 v[74:75], v[10:11], v[10:11] op_sel:[0,0] op_sel_hi:[0,0]
    s_waitcnt lgkmcnt(0)
    v_mfma_f32_32x32x16_bf16 v[112:127], v[20:23], v[16:19], v[112:127]
    v_pk_mul_f32 v[76:77], v[10:11], v[10:11] op_sel:[0,0] op_sel_hi:[0,0]
    v_pk_mul_f32 v[78:79], v[10:11], v[10:11] op_sel:[0,0] op_sel_hi:[0,0]
    s_nop 9
    v_pk_mul_f32 v[44:45], v[112:113], v[12:13] op_sel:[0,0] op_sel_hi:[1,0]
    v_pk_mul_f32 v[46:47], v[114:115], v[12:13] op_sel:[0,0] op_sel_hi:[1,0]
    v_pk_mul_f32 v[48:49], v[116:117], v[12:13] op_sel:[0,0] op_sel_hi:[1,0]
    v_pk_mul_f32 v[50:51], v[118:119], v[12:13] op_sel:[0,0] op_sel_hi:[1,0]
    v_exp_f32 v44, v44
    v_exp_f32 v45, v45
    v_exp_f32 v46, v46
    v_exp_f32 v47, v47
    v_exp_f32 v48, v48
    v_exp_f32 v49, v49
    v_exp_f32 v50, v50
    v_exp_f32 v51, v51
    v_pk_fma_f32 v[44:45], v[44:45], v[12:13], v[12:13] op_sel:[0,1,1] op_sel_hi:[1,1,1]
    v_pk_fma_f32 v[46:47], v[46:47], v[12:13], v[12:13] op_sel:[0,1,1] op_sel_hi:[1,1,1]
    v_pk_fma_f32 v[48:49], v[48:49], v[12:13], v[12:13] op_sel:[0,1,1] op_sel_hi:[1,1,1]
    v_pk_fma_f32 v[50:51], v[50:51], v[12:13], v[12:13] op_sel:[0,1,1] op_sel_hi:[1,1,1]
    v_rcp_f32 v44, v44
    v_rcp_f32 v45, v45
    v_rcp_f32 v46, v46
    v_rcp_f32 v47, v47
    v_rcp_f32 v48, v48
    v_rcp_f32 v49, v49
    v_rcp_f32 v50, v50
    v_rcp_f32 v51, v51
    v_pk_mul_f32 v[44:45], v[44:45], v[120:121] op_sel:[0,0] op_sel_hi:[1,1]
    v_pk_mul_f32 v[46:47], v[46:47], v[122:123] op_sel:[0,0] op_sel_hi:[1,1]
    v_pk_mul_f32 v[48:49], v[48:49], v[124:125] op_sel:[0,0] op_sel_hi:[1,1]
    v_pk_mul_f32 v[50:51], v[50:51], v[126:127] op_sel:[0,0] op_sel_hi:[1,1]
    v_cvt_pk_bf16_f32 v40, v44, v45
    v_cvt_pk_bf16_f32 v41, v46, v47
    v_cvt_pk_bf16_f32 v42, v48, v49
    v_cvt_pk_bf16_f32 v43, v50, v51
    s_add_u32 s65, s44, 6144
    buffer_store_dwordx4 v[40:43], v1, s[8:11], s65 offen sc1
    buffer_load_dwordx4 v[168:171], v1, s[8:11], s64 offen offset:2048 sc1
    buffer_load_dwordx4 v[192:195], v7, s[8:11], s66 offen offset:2048
    s_waitcnt vmcnt(13)
    v_mfma_f32_32x32x16_bf16 v[80:95], a[4:7], v[128:131], 0
    v_mfma_f32_32x32x16_bf16 v[64:79], a[0:3], v[128:131], v[64:79]
    v_accvgpr_read_b32 v96, a232
    buffer_load_dwordx4 v[172:175], v1, s[8:11], s64 offen offset:3072 sc1
    s_add_u32 s66, s48, 8192
    buffer_load_dwordx4 v[196:199], v6, s[8:11], s66 offen
    s_waitcnt vmcnt(14)
    v_mfma_f32_32x32x16_bf16 v[80:95], a[12:15], v[132:135], v[80:95]
    v_mfma_f32_32x32x16_bf16 v[64:79], a[8:11], v[132:135], v[64:79]
    v_accvgpr_read_b32 v97, a233
    s_add_u32 s64, s45, 21504
    buffer_load_dwordx4 v[176:179], v1, s[8:11], s64 offen sc1
    buffer_load_dwordx4 v[200:203], v7, s[8:11], s66 offen
    s_waitcnt vmcnt(15)
    v_mfma_f32_32x32x16_bf16 v[80:95], a[20:23], v[136:139], v[80:95]
    v_mfma_f32_32x32x16_bf16 v[64:79], a[16:19], v[136:139], v[64:79]
    v_accvgpr_read_b32 v98, a234
    buffer_load_dwordx4 v[180:183], v1, s[8:11], s64 offen offset:1024 sc1
    buffer_load_dwordx4 v[204:207], v6, s[8:11], s66 offen offset:2048
    s_waitcnt vmcnt(16)
    v_mfma_f32_32x32x16_bf16 v[80:95], a[28:31], v[140:143], v[80:95]
    v_mfma_f32_32x32x16_bf16 v[64:79], a[24:27], v[140:143], v[64:79]
    v_accvgpr_read_b32 v99, a235
    buffer_load_dwordx4 v[184:187], v1, s[8:11], s64 offen offset:2048 sc1
    buffer_load_dwordx4 v[208:211], v7, s[8:11], s66 offen offset:2048
    s_waitcnt vmcnt(17)
    v_mfma_f32_32x32x16_bf16 v[80:95], a[36:39], v[144:147], v[80:95]
    v_mfma_f32_32x32x16_bf16 v[64:79], a[32:35], v[144:147], v[64:79]
    v_accvgpr_read_b32 v100, a236
    buffer_load_dwordx4 v[188:191], v1, s[8:11], s64 offen offset:3072 sc1
    s_add_u32 s66, s48, 12288
    buffer_load_dwordx4 v[212:215], v6, s[8:11], s66 offen
    s_waitcnt vmcnt(18)
    v_mfma_f32_32x32x16_bf16 v[80:95], a[44:47], v[148:151], v[80:95]
    v_mfma_f32_32x32x16_bf16 v[64:79], a[40:43], v[148:151], v[64:79]
    v_accvgpr_read_b32 v101, a237
    s_add_u32 s64, s45, 114688
    buffer_load_dwordx4 v[128:131], v1, s[8:11], s64 offen sc1
    buffer_load_dwordx4 v[216:219], v7, s[8:11], s66 offen
    s_waitcnt vmcnt(19)
    v_mfma_f32_32x32x16_bf16 v[80:95], a[52:55], v[152:155], v[80:95]
    v_mfma_f32_32x32x16_bf16 v[64:79], a[48:51], v[152:155], v[64:79]
    v_accvgpr_read_b32 v102, a238
    buffer_load_dwordx4 v[132:135], v1, s[8:11], s64 offen offset:1024 sc1
    s_add_u32 s66, s48, 22528
    buffer_load_dwordx4 v[220:223], v6, s[8:11], s66 offen
    s_waitcnt vmcnt(20)
    v_mfma_f32_32x32x16_bf16 v[80:95], a[128:131], v[156:159], v[80:95]
    v_mfma_f32_32x32x16_bf16 v[64:79], a[56:59], v[156:159], v[64:79]
    v_accvgpr_read_b32 v103, a239
    v_mov_b32 v62, 5
    s_waitcnt vmcnt(16)
    s_mov_b64 exec, 1
    s_cmp_eq_u32 s12, 0
    s_cbranch_scc1 WT_42
    buffer_store_dword v62, v10, s[8:11], s38 offen
RT_43:
    s_mov_b64 exec, -1
    buffer_load_dwordx4 v[136:139], v1, s[8:11], s64 offen offset:2048 sc1
    buffer_load_dwordx4 v[224:227], v7, s[8:11], s66 offen
    v_mfma_f32_32x32x16_bf16 v[80:95], a[136:139], v[160:163], v[80:95]
    v_mfma_f32_32x32x16_bf16 v[64:79], a[132:135], v[160:163], v[64:79]
    v_pk_mul_f32 v[104:105], v[10:11], v[10:11] op_sel:[0,0] op_sel_hi:[0,0]
    buffer_load_dwordx4 v[140:143], v1, s[8:11], s64 offen offset:3072 sc1
    buffer_load_dwordx4 v[228:231], v6, s[8:11], s66 offen offset:2048
    v_mfma_f32_32x32x16_bf16 v[80:95], a[144:147], v[164:167], v[80:95]
    v_mfma_f32_32x32x16_bf16 v[64:79], a[140:143], v[164:167], v[64:79]
    v_pk_mul_f32 v[106:107], v[10:11], v[10:11] op_sel:[0,0] op_sel_hi:[0,0]
    s_add_u32 s64, s45, 121856
    buffer_load_dwordx4 v[144:147], v1, s[8:11], s64 offen sc1
    buffer_load_dwordx4 v[232:235], v7, s[8:11], s66 offen offset:2048
    s_waitcnt vmcnt(22)
    v_mfma_f32_32x32x16_bf16 v[80:95], a[152:155], v[168:171], v[80:95]
    v_mfma_f32_32x32x16_bf16 v[64:79], a[148:151], v[168:171], v[64:79]
    v_pk_mul_f32 v[108:109], v[10:11], v[10:11] op_sel:[0,0] op_sel_hi:[0,0]
    buffer_load_dwordx4 v[148:151], v1, s[8:11], s64 offen offset:1024 sc1
    s_add_u32 s66, s48, 26624
    buffer_load_dwordx4 v[236:239], v6, s[8:11], s66 offen
    s_waitcnt vmcnt(22)
    v_mfma_f32_32x32x16_bf16 v[80:95], a[160:163], v[172:175], v[80:95]
    v_mfma_f32_32x32x16_bf16 v[64:79], a[156:159], v[172:175], v[64:79]
    v_pk_mul_f32 v[110:111], v[10:11], v[10:11] op_sel:[0,0] op_sel_hi:[0,0]
    buffer_load_dwordx4 v[152:155], v1, s[8:11], s64 offen offset:2048 sc1
    buffer_load_dwordx4 v[240:243], v7, s[8:11], s66 offen
    s_waitcnt vmcnt(22)
    v_mfma_f32_32x32x16_bf16 v[80:95], a[168:171], v[176:179], v[80:95]
    v_mfma_f32_32x32x16_bf16 v[64:79], a[164:167], v[176:179], v[64:79]
    buffer_load_dword v63, v9, s[8:11], s37 offen sc1
    buffer_load_dwordx4 v[156:159], v1, s[8:11], s64 offen offset:3072 sc1
    s_add_u32 s66, s48, 36864
    buffer_load_dwordx4 v[244:247], v6, s[8:11], s66 offen
    s_waitcnt vmcnt(23)
    v_mfma_f32_32x32x16_bf16 v[80:95], a[176:179], v[180:183], v[80:95]
    v_mfma_f32_32x32x16_bf16 v[64:79], a[172:175], v[180:183], v[64:79]
    s_add_u32 s64, s45, 129024
    buffer_load_dwordx4 v[160:163], v1, s[8:11], s64 offen sc1
    buffer_load_dwordx4 v[248:251], v7, s[8:11], s66 offen
    s_waitcnt vmcnt(23)
    v_mfma_f32_32x32x16_bf16 v[80:95], a[184:187], v[184:187], v[80:95]
    v_mfma_f32_32x32x16_bf16 v[64:79], a[180:183], v[184:187], v[64:79]
    buffer_load_dwordx4 v[164:167], v1, s[8:11], s64 offen offset:1024 sc1
    buffer_load_dwordx4 v[252:255], v6, s[8:11], s66 offen offset:2048
    s_waitcnt vmcnt(23)
    v_mfma_f32_32x32x16_bf16 v[80:95], v[192:195], v[188:191], v[80:95]
    v_mfma_f32_32x32x16_bf16 v[64:79], a[188:191], v[188:191], v[64:79]
    buffer_load_dwordx4 v[168:171], v1, s[8:11], s64 offen offset:2048 sc1
    buffer_load_dwordx4 a[192:195], v7, s[8:11], s66 offen offset:2048
    s_waitcnt vmcnt(23)
    v_mfma_f32_32x32x16_bf16 v[112:127], a[4:7], v[128:131], 0
    v_mfma_f32_32x32x16_bf16 v[96:111], a[0:3], v[128:131], v[96:111]
    buffer_load_dwordx4 v[172:175], v1, s[8:11], s64 offen offset:3072 sc1
    s_add_u32 s66, s48, 40960
    buffer_load_dwordx4 a[196:199], v6, s[8:11], s66 offen
    s_waitcnt vmcnt(23)
    v_mfma_f32_32x32x16_bf16 v[112:127], a[12:15], v[132:135], v[112:127]
    v_mfma_f32_32x32x16_bf16 v[96:111], a[8:11], v[132:135], v[96:111]
    s_add_u32 s64, s45, 136192
    buffer_load_dwordx4 v[176:179], v1, s[8:11], s64 offen sc1
    buffer_load_dwordx4 a[200:203], v7, s[8:11], s66 offen
    s_waitcnt vmcnt(22)
    v_mfma_f32_32x32x16_bf16 v[112:127], a[20:23], v[136:139], v[112:127]
    v_mfma_f32_32x32x16_bf16 v[96:111], a[16:19], v[136:139], v[96:111]
    buffer_load_dwordx4 v[180:183], v1, s[8:11], s64 offen offset:1024 sc1
    s_add_u32 s66, s48, 51200
    buffer_load_dwordx4 a[204:207], v6, s[8:11], s66 offen
    s_waitcnt vmcnt(22)
    v_mfma_f32_32x32x16_bf16 v[112:127], a[28:31], v[140:143], v[112:127]
    v_mfma_f32_32x32x16_bf16 v[96:111], a[24:27], v[140:143], v[96:111]
    s_waitcnt vmcnt(14)
    v_cmp_gt_u32 vcc, 5, v63
    s_cbranch_vccz OK_46
    s_mov_b32 s62, 0
    SP_47:
    buffer_load_dword v63, v9, s[8:11], s37 offen sc1
    s_add_u32 s62, s62, 1
    s_cmp_gt_u32 s62, 0x200000
    s_cbranch_scc1 L_fail
    s_waitcnt vmcnt(0)
    v_cmp_gt_u32 vcc, 5, v63
    s_cbranch_vccnz SP_47
    OK_46:
    s_add_u32 s64, s45, 4096
    buffer_load_dwordx4 v[184:187], v1, s[8:11], s64 offen sc1
    buffer_load_dwordx4 a[208:211], v7, s[8:11], s66 offen
    v_mfma_f32_32x32x16_bf16 v[112:127], a[36:39], v[144:147], v[112:127]
    v_mfma_f32_32x32x16_bf16 v[96:111], a[32:35], v[144:147], v[96:111]
    buffer_load_dwordx4 v[188:191], v1, s[8:11], s64 offen offset:1024 sc1
    buffer_load_dwordx4 a[212:215], v6, s[8:11], s66 offen offset:2048
    v_mfma_f32_32x32x16_bf16 v[112:127], a[44:47], v[148:151], v[112:127]
    v_mfma_f32_32x32x16_bf16 v[96:111], a[40:43], v[148:151], v[96:111]
    buffer_load_dwordx4 v[128:131], v1, s[8:11], s64 offen offset:2048 sc1
    buffer_load_dwordx4 a[216:219], v7, s[8:11], s66 offen offset:2048
    v_mfma_f32_32x32x16_bf16 v[112:127], a[52:55], v[152:155], v[112:127]
    v_mfma_f32_32x32x16_bf16 v[96:111], a[48:51], v[152:155], v[96:111]
    s_xor_b32 s56, s28, 1
    s_mul_i32 s56, s56, 6144
    s_add_u32 s56, s56, 135168
    v_add_u32 v16, s56, v1
    s_add_u32 s64, s45, 11264
    buffer_load_dwordx4 v[132:135], v1, s[8:11], s64 offen sc1
    s_add_u32 s66, s48, 55296
    buffer_load_dwordx4 a[220:223], v6, s[8:11], s66 offen
    s_waitcnt vmcnt(21)
    v_mfma_f32_32x32x16_bf16 v[112:127], a[128:131], v[156:159], v[112:127]
    v_mfma_f32_32x32x16_bf16 v[96:111], a[56:59], v[156:159], v[96:111]
    s_xor_b32 s56, s28, 2
    s_mul_i32 s56, s56, 6144
    s_add_u32 s56, s56, 137216
    v_add_u32 v17, s56, v1
    buffer_load_dwordx4 v[136:139], v1, s[8:11], s64 offen offset:1024 sc1
    buffer_load_dwordx4 a[124:127], v7, s[8:11], s66 offen
    s_waitcnt vmcnt(21)
    v_mfma_f32_32x32x16_bf16 v[112:127], a[136:139], v[160:163], v[112:127]
    v_mfma_f32_32x32x16_bf16 v[96:111], a[132:135], v[160:163], v[96:111]
    s_xor_b32 s56, s28, 3
    s_mul_i32 s56, s56, 6144
    s_add_u32 s56, s56, 139264
    v_add_u32 v18, s56, v1
    buffer_load_dwordx4 v[140:143], v1, s[8:11], s64 offen offset:2048 sc1
    s_waitcnt vmcnt(20)
    v_mfma_f32_32x32x16_bf16 v[112:127], a[144:147], v[164:167], v[112:127]
    v_mfma_f32_32x32x16_bf16 v[96:111], a[140:143], v[164:167], v[96:111]
    s_mul_i32 s56, s28, 6144
    s_add_u32 s56, s56, 135168
    v_add_u32 v19, s56, v1
    v_lshlrev_b32 v56, 3, v1
    s_add_u32 s66, s40, 0
    s_mov_b64 exec, 255
    buffer_load_dword v56, v56, s[8:11], s66 offen sc1
    s_mov_b64 exec, -1
    s_add_u32 s64, s45, 18432
    buffer_load_dwordx4 v[144:147], v1, s[8:11], s64 offen sc1
    s_waitcnt vmcnt(20)
    v_mfma_f32_32x32x16_bf16 v[112:127], a[152:155], v[168:171], v[112:127]
    v_mfma_f32_32x32x16_bf16 v[96:111], a[148:151], v[168:171], v[96:111]
    s_lshl_b32 s56, s28, 8
    s_add_u32 s56, s56, 159744
    v_add_u32 v14, s56, v11
    v_add_u32 v15, 159744, v11
    buffer_load_dwordx4 v[148:151], v1, s[8:11], s64 offen offset:1024 sc1
    s_waitcnt vmcnt(19)
    v_mfma_f32_32x32x16_bf16 v[112:127], a[160:163], v[172:175], v[112:127]
    v_mfma_f32_32x32x16_bf16 v[96:111], a[156:159], v[172:175], v[96:111]
    v_lshlrev_b32 v57, 3, v1
    s_add_u32 s66, s40, 32768
    s_mov_b64 exec, 255
    buffer_load_dword v57, v57, s[8:11], s66 offen sc1
    s_mov_b64 exec, -1
    buffer_load_dwordx4 v[152:155], v1, s[8:11], s64 offen offset:2048 sc1
    s_waitcnt vmcnt(19)
    v_mfma_f32_32x32x16_bf16 v[112:127], a[168:171], v[176:179], v[112:127]
    v_mfma_f32_32x32x16_bf16 v[96:111], a[164:167], v[176:179], v[96:111]
    s_add_u32 s64, s45, 25600
    buffer_load_dwordx4 v[156:159], v1, s[8:11], s64 offen sc1
    s_waitcnt vmcnt(18)
    v_mfma_f32_32x32x16_bf16 v[112:127], a[176:179], v[180:183], v[112:127]
    v_mfma_f32_32x32x16_bf16 v[96:111], a[172:175], v[180:183], v[96:111]
    v_lshlrev_b32 v58, 3, v1
    s_add_u32 s66, s41, 0
    s_mov_b64 exec, 255
    buffer_load_dword v58, v58, s[8:11], s66 offen sc1
    s_mov_b64 exec, -1
    buffer_load_dwordx4 v[160:163], v1, s[8:11], s64 offen offset:1024 sc1
    s_waitcnt vmcnt(18)
    v_mfma_f32_32x32x16_bf16 v[80:95], v[200:203], v[184:187], v[80:95]
    v_mfma_f32_32x32x16_bf16 v[64:79], v[196:199], v[184:187], v[64:79]
    buffer_load_dwordx4 v[164:167], v1, s[8:11], s64 offen offset:2048 sc1
    s_waitcnt vmcnt(17)
    v_mfma_f32_32x32x16_bf16 v[80:95], v[208:211], v[188:191], v[80:95]
    v_mfma_f32_32x32x16_bf16 v[64:79], v[204:207], v[188:191], v[64:79]
    v_lshlrev_b32 v59, 3, v1
    s_add_u32 s66, s41, 2048
    s_mov_b64 exec, 255
    buffer_load_dword v59, v59, s[8:11], s66 offen sc1
    s_mov_b64 exec, -1
    s_add_u32 s64, s45, 138240
    buffer_load_dwordx4 v[168:171], v1, s[8:11], s64 offen sc1
    s_waitcnt vmcnt(17)
    v_mfma_f32_32x32x16_bf16 v[80:95], v[216:219], v[128:131], v[80:95]
    v_mfma_f32_32x32x16_bf16 v[64:79], v[212:215], v[128:131], v[64:79]
    buffer_load_dwordx4 v[172:175], v1, s[8:11], s64 offen offset:1024 sc1
    s_waitcnt vmcnt(16)
    v_mfma_f32_32x32x16_bf16 v[80:95], v[224:227], v[132:135], v[80:95]
    v_mfma_f32_32x32x16_bf16 v[64:79], v[220:223], v[132:135], v[64:79]
    s_lshr_b32 s66, s2, 3
    s_lshl_b32 s66, s66, 2
    s_add_u32 s66, s66, s28
    s_lshl_b32 s66, s66, 9
    s_add_u32 s66, s66, L_layer1-L_pc
    v_lshl_add_u32 v60, v1, 3, s66
    v_min_u32 v60, L_end-L_pc-4, v60
    s_mov_b64 exec, 15
    global_load_dword v60, v60, s[4:5]
    s_mov_b64 exec, -1
    s_add_u32 s64, s45, 118784
    buffer_load_dwordx4 v[176:179], v1, s[8:11], s64 offen sc1
    s_waitcnt vmcnt(16)
    v_mfma_f32_32x32x16_bf16 v[80:95], v[232:235], v[136:139], v[80:95]
    v_mfma_f32_32x32x16_bf16 v[64:79], v[228:231], v[136:139], v[64:79]
    buffer_load_dwordx4 v[180:183], v1, s[8:11], s64 offen offset:1024 sc1
    s_waitcnt vmcnt(15)
    v_mfma_f32_32x32x16_bf16 v[80:95], v[240:243], v[140:143], v[80:95]
    v_mfma_f32_32x32x16_bf16 v[64:79], v[236:239], v[140:143], v[64:79]
    buffer_load_dwordx4 v[184:187], v1, s[8:11], s64 offen offset:2048 sc1
    s_waitcnt vmcnt(14)
    v_mfma_f32_32x32x16_bf16 v[80:95], v[248:251], v[144:147], v[80:95]
    v_mfma_f32_32x32x16_bf16 v[64:79], v[244:247], v[144:147], v[64:79]
    s_add_u32 s64, s45, 125952
    buffer_load_dwordx4 v[188:191], v1, s[8:11], s64 offen sc1
    s_waitcnt vmcnt(14)
    v_mfma_f32_32x32x16_bf16 v[80:95], a[192:195], v[148:151], v[80:95]
    v_mfma_f32_32x32x16_bf16 v[64:79], v[252:255], v[148:151], v[64:79]
    buffer_load_dwordx4 v[128:131], v1, s[8:11], s64 offen offset:1024 sc1
    s_waitcnt vmcnt(13)
    v_mfma_f32_32x32x16_bf16 v[80:95], a[200:203], v[152:155], v[80:95]
    v_mfma_f32_32x32x16_bf16 v[64:79], a[196:199], v[152:155], v[64:79]
    buffer_load_dwordx4 v[132:135], v1, s[8:11], s64 offen offset:2048 sc1
    s_waitcnt vmcnt(13)
    v_mfma_f32_32x32x16_bf16 v[80:95], a[208:211], v[156:159], v[80:95]
    v_mfma_f32_32x32x16_bf16 v[64:79], a[204:207], v[156:159], v[64:79]
    s_add_u32 s64, s45, 133120
    buffer_load_dwordx4 v[136:139], v1, s[8:11], s64 offen sc1
    s_waitcnt vmcnt(12)
    v_mfma_f32_32x32x16_bf16 v[80:95], a[216:219], v[160:163], v[80:95]
    v_mfma_f32_32x32x16_bf16 v[64:79], a[212:215], v[160:163], v[64:79]
    buffer_load_dwordx4 v[140:143], v1, s[8:11], s64 offen offset:1024 sc1
    s_waitcnt vmcnt(12)
    v_mfma_f32_32x32x16_bf16 v[80:95], a[124:127], v[164:167], v[80:95]
    v_mfma_f32_32x32x16_bf16 v[64:79], a[220:223], v[164:167], v[64:79]
    buffer_load_dwordx4 v[144:147], v1, s[8:11], s64 offen offset:2048 sc1
    s_waitcnt vmcnt(11)
    v_mfma_f32_32x32x16_bf16 v[112:127], a[184:187], v[168:171], v[112:127]
    v_mfma_f32_32x32x16_bf16 v[96:111], a[180:183], v[168:171], v[96:111]
    s_add_u32 s64, s45, 140288
    buffer_load_dwordx4 v[148:151], v1, s[8:11], s64 offen sc1
    s_waitcnt vmcnt(11)
    v_mfma_f32_32x32x16_bf16 v[112:127], v[192:195], v[172:175], v[112:127]
    s_nop 2
    ds_write_b128 v17, v[80:83] offset:0
    v_mfma_f32_32x32x16_bf16 v[96:111], a[188:191], v[172:175], v[96:111]
    buffer_load_dwordx4 v[152:155], v1, s[8:11], s64 offen offset:1024 sc1
    s_waitcnt vmcnt(10)
    v_mfma_f32_32x32x16_bf16 v[112:127], v[200:203], v[176:179], v[112:127]
    ds_write_b128 v17, v[84:87] offset:1024
    v_mfma_f32_32x32x16_bf16 v[96:111], v[196:199], v[176:179], v[96:111]
    buffer_load_dwordx4 v[156:159], v1, s[8:11], s64 offen offset:2048 sc1
    s_waitcnt vmcnt(10)
    v_mfma_f32_32x32x16_bf16 v[112:127], v[208:211], v[180:183], v[112:127]
    ds_write_b128 v18, v[88:91] offset:0
    v_mfma_f32_32x32x16_bf16 v[96:111], v[204:207], v[180:183], v[96:111]
    s_waitcnt vmcnt(9)
    v_mfma_f32_32x32x16_bf16 v[112:127], v[216:219], v[184:187], v[112:127]
    ds_write_b128 v18, v[92:95] offset:1024
    v_mfma_f32_32x32x16_bf16 v[96:111], v[212:215], v[184:187], v[96:111]
    s_waitcnt vmcnt(8)
    v_mfma_f32_32x32x16_bf16 v[112:127], v[224:227], v[188:191], v[112:127]
    ds_write_b128 v16, v[72:75] offset:0
    v_mfma_f32_32x32x16_bf16 v[96:111], v[220:223], v[188:191], v[96:111]
    s_waitcnt vmcnt(7)
    v_mfma_f32_32x32x16_bf16 v[112:127], v[232:235], v[128:131], v[112:127]
    ds_write_b128 v16, v[76:79] offset:1024
    v_mfma_f32_32x32x16_bf16 v[96:111], v[228:231], v[128:131], v[96:111]
    s_waitcnt vmcnt(6)
    v_mfma_f32_32x32x16_bf16 v[112:127], v[240:243], v[132:135], v[112:127]
    v_mfma_f32_32x32x16_bf16 v[96:111], v[236:239], v[132:135], v[96:111]
    s_waitcnt vmcnt(5)
    v_mfma_f32_32x32x16_bf16 v[112:127], v[248:251], v[136:139], v[112:127]
    s_waitcnt lgkmcnt(0)
    s_barrier
    v_mfma_f32_32x32x16_bf16 v[96:111], v[244:247], v[136:139], v[96:111]
    ds_read_b128 v[20:23], v19 offset:0
    ds_read_b128 v[24:27], v19 offset:1024
    s_waitcnt vmcnt(4)
    v_mfma_f32_32x32x16_bf16 v[112:127], a[192:195], v[140:143], v[112:127]
    ds_read_b128 v[28:31], v19 offset:2048
    ds_read_b128 v[32:35], v19 offset:3072
    v_mfma_f32_32x32x16_bf16 v[96:111], v[252:255], v[140:143], v[96:111]
    ds_read_b128 v[36:39], v19 offset:4096
    ds_read_b128 v[40:43], v19 offset:5120
    s_waitcnt vmcnt(3)
    v_mfma_f32_32x32x16_bf16 v[112:127], a[200:203], v[144:147], v[112:127]
    v_mfma_f32_32x32x16_bf16 v[96:111], a[196:199], v[144:147], v[96:111]
    s_waitcnt vmcnt(2)
    v_mfma_f32_32x32x16_bf16 v[112:127], a[208:211], v[148:151], v[112:127]
    s_waitcnt lgkmcnt(0)
    s_barrier
    v_mfma_f32_32x32x16_bf16 v[96:111], a[204:207], v[148:151], v[96:111]
    v_pk_add_f32 v[64:65], v[64:65], v[20:21] op_sel:[0,0] op_sel_hi:[1,1]
    v_pk_add_f32 v[66:67], v[66:67], v[22:23] op_sel:[0,0] op_sel_hi:[1,1]
    v_pk_add_f32 v[68:69], v[68:69], v[24:25] op_sel:[0,0] op_sel_hi:[1,1]
    v_pk_add_f32 v[70:71], v[70:71], v[26:27] op_sel:[0,0] op_sel_hi:[1,1]
    s_waitcnt vmcnt(1)
    v_mfma_f32_32x32x16_bf16 v[112:127], a[216:219], v[152:155], v[112:127]
    v_pk_add_f32 v[64:65], v[64:65], v[28:29] op_sel:[0,0] op_sel_hi:[1,1]
    v_pk_add_f32 v[66:67], v[66:67], v[30:31] op_sel:[0,0] op_sel_hi:[1,1]
    v_pk_add_f32 v[68:69], v[68:69], v[32:33] op_sel:[0,0] op_sel_hi:[1,1]
    v_pk_add_f32 v[70:71], v[70:71], v[34:35] op_sel:[0,0] op_sel_hi:[1,1]
    v_mfma_f32_32x32x16_bf16 v[96:111], a[212:215], v[152:155], v[96:111]
    v_pk_add_f32 v[64:65], v[64:65], v[36:37] op_sel:[0,0] op_sel_hi:[1,1]
    v_pk_add_f32 v[66:67], v[66:67], v[38:39] op_sel:[0,0] op_sel_hi:[1,1]
    v_pk_add_f32 v[68:69], v[68:69], v[40:41] op_sel:[0,0] op_sel_hi:[1,1]
    v_pk_add_f32 v[70:71], v[70:71], v[42:43] op_sel:[0,0] op_sel_hi:[1,1]
    s_waitcnt vmcnt(0)
    v_mfma_f32_32x32x16_bf16 v[112:127], a[124:127], v[156:159], v[112:127]
    v_cvt_pk_bf16_f32 v44, v64, v65
    v_cvt_pk_bf16_f32 v45, v66, v67
    v_cvt_pk_bf16_f32 v46, v68, v69
    v_cvt_pk_bf16_f32 v47, v70, v71
    v_mfma_f32_32x32x16_bf16 v[96:111], a[220:223], v[156:159], v[96:111]
    s_add_u32 s65, s40, 0
    s_cmp_eq_u32 s12, 0
    s_cbranch_scc1 WT_44
    buffer_store_dwordx4 v[44:47], v1, s[8:11], s65 offen
RT_45:
    v_pk_add_f32 v[72:73], v[64:65], v[66:67] op_sel:[0,0] op_sel_hi:[1,1]
    v_pk_mul_f32 v[74:75], v[64:65], v[64:65] op_sel:[0,0] op_sel_hi:[1,1]
    v_pk_add_f32 v[72:73], v[72:73], v[68:69] op_sel:[0,0] op_sel_hi:[1,1]
    v_pk_fma_f32 v[74:75], v[66:67], v[66:67], v[74:75] op_sel:[0,0,0] op_sel_hi:[1,1,1]
    v_pk_add_f32 v[72:73], v[72:73], v[70:71] op_sel:[0,0] op_sel_hi:[1,1]
    v_pk_fma_f32 v[74:75], v[68:69], v[68:69], v[74:75] op_sel:[0,0,0] op_sel_hi:[1,1,1]
    v_add_f32 v72, v72, v73
    v_pk_fma_f32 v[74:75], v[70:71], v[70:71], v[74:75] op_sel:[0,0,0] op_sel_hi:[1,1,1]
    v_add_f32 v74, v74, v75
    s_nop 1
    v_permlane32_swap_b32 v72, v74
    v_add_f32 v72, v72, v74
    ds_write_b128 v17, v[112:115] offset:0
    ds_write_b32 v14, v72 offset:0
    v_lshlrev_b32 v80, 16, v44
    v_and_b32 v81, 0xffff0000, v44
    ds_write_b128 v17, v[116:119] offset:1024
    v_lshlrev_b32 v82, 16, v45
    v_and_b32 v83, 0xffff0000, v45
    v_lshlrev_b32 v84, 16, v46
    ds_write_b128 v18, v[120:123] offset:0
    v_and_b32 v85, 0xffff0000, v46
    v_lshlrev_b32 v86, 16, v47
    v_and_b32 v87, 0xffff0000, v47
    ds_write_b128 v18, v[124:127] offset:1024
    v_accvgpr_write_b32 a224, v80
    v_accvgpr_write_b32 a225, v81
    v_accvgpr_write_b32 a226, v82
    ds_write_b128 v16, v[104:107] offset:0
    v_accvgpr_write_b32 a227, v83
    v_accvgpr_write_b32 a228, v84
    v_accvgpr_write_b32 a229, v85
    ds_write_b128 v16, v[108:111] offset:1024
    v_accvgpr_write_b32 a230, v86
    v_accvgpr_write_b32 a231, v87
    s_waitcnt lgkmcnt(0)
    s_barrier
    ds_read_b128 v[20:23], v19 offset:0
    ds_read_b128 v[24:27], v19 offset:1024
    ds_read_b128 v[28:31], v19 offset:2048
    ds_read_b128 v[32:35], v19 offset:3072
    ds_read_b128 v[36:39], v19 offset:4096
    ds_read_b128 v[40:43], v19 offset:5120
    s_waitcnt lgkmcnt(5)
    v_pk_add_f32 v[96:97], v[96:97], v[20:21] op_sel:[0,0] op_sel_hi:[1,1]
    v_pk_add_f32 v[98:99], v[98:99], v[22:23] op_sel:[0,0] op_sel_hi:[1,1]
    s_waitcnt lgkmcnt(4)
    v_pk_add_f32 v[100:101], v[100:101], v[24:25] op_sel:[0,0] op_sel_hi:[1,1]
    v_pk_add_f32 v[102:103], v[102:103], v[26:27] op_sel:[0,0] op_sel_hi:[1,1]
    s_waitcnt lgkmcnt(3)
    v_pk_add_f32 v[96:97], v[96:97], v[28:29] op_sel:[0,0] op_sel_hi:[1,1]
    v_pk_add_f32 v[98:99], v[98:99], v[30:31] op_sel:[0,0] op_sel_hi:[1,1]
    s_waitcnt lgkmcnt(2)
    v_pk_add_f32 v[100:101], v[100:101], v[32:33] op_sel:[0,0] op_sel_hi:[1,1]
    v_pk_add_f32 v[102:103], v[102:103], v[34:35] op_sel:[0,0] op_sel_hi:[1,1]
    s_waitcnt lgkmcnt(1)
    v_pk_add_f32 v[96:97], v[96:97], v[36:37] op_sel:[0,0] op_sel_hi:[1,1]
    v_pk_add_f32 v[98:99], v[98:99], v[38:39] op_sel:[0,0] op_sel_hi:[1,1]
    s_waitcnt lgkmcnt(0)
    v_pk_add_f32 v[100:101], v[100:101], v[40:41] op_sel:[0,0] op_sel_hi:[1,1]
    v_pk_add_f32 v[102:103], v[102:103], v[42:43] op_sel:[0,0] op_sel_hi:[1,1]
    v_cvt_pk_bf16_f32 v44, v96, v97
    v_cvt_pk_bf16_f32 v45, v98, v99
    v_cvt_pk_bf16_f32 v46, v100, v101
    v_cvt_pk_bf16_f32 v47, v102, v103
    s_add_u32 s65, s40, 32768
    s_cmp_eq_u32 s12, 0
    s_cbranch_scc1 WT_48
    buffer_store_dwordx4 v[44:47], v1, s[8:11], s65 offen
RT_49:
    v_pk_add_f32 v[104:105], v[96:97], v[98:99] op_sel:[0,0] op_sel_hi:[1,1]
    v_pk_mul_f32 v[106:107], v[96:97], v[96:97] op_sel:[0,0] op_sel_hi:[1,1]
    v_pk_add_f32 v[104:105], v[104:105], v[100:101] op_sel:[0,0] op_sel_hi:[1,1]
    v_pk_fma_f32 v[106:107], v[98:99], v[98:99], v[106:107] op_sel:[0,0,0] op_sel_hi:[1,1,1]
    v_pk_add_f32 v[104:105], v[104:105], v[102:103] op_sel:[0,0] op_sel_hi:[1,1]
    v_pk_fma_f32 v[106:107], v[100:101], v[100:101], v[106:107] op_sel:[0,0,0] op_sel_hi:[1,1,1]
    v_add_f32 v104, v104, v105
    v_pk_fma_f32 v[106:107], v[102:103], v[102:103], v[106:107] op_sel:[0,0,0] op_sel_hi:[1,1,1]
    v_add_f32 v106, v106, v107
    s_nop 1
    v_permlane32_swap_b32 v104, v106
    v_add_f32 v104, v104, v106
    ds_write_b32 v14, v104 offset:1024
    v_lshlrev_b32 v112, 16, v44
    v_and_b32 v113, 0xffff0000, v44
    v_lshlrev_b32 v114, 16, v45
    v_and_b32 v115, 0xffff0000, v45
    v_lshlrev_b32 v116, 16, v46
    v_and_b32 v117, 0xffff0000, v46
    v_lshlrev_b32 v118, 16, v47
    v_and_b32 v119, 0xffff0000, v47
    s_waitcnt lgkmcnt(0)
    s_barrier
    ds_read2st64_b32 v[48:49], v15 offset0:0 offset1:1
    ds_read2st64_b32 v[50:51], v15 offset0:2 offset1:3
    ds_read2st64_b32 v[52:53], v15 offset0:4 offset1:5
    ds_read2st64_b32 v[54:55], v15 offset0:6 offset1:7
    v_accvgpr_write_b32 a232, v112
    v_accvgpr_write_b32 a233, v113
    v_accvgpr_write_b32 a234, v114
    v_accvgpr_write_b32 a235, v115
    v_accvgpr_write_b32 a236, v116
    v_accvgpr_write_b32 a237, v117
    v_accvgpr_write_b32 a238, v118
    v_accvgpr_write_b32 a239, v119
    v_mov_b32 v62, 6
    s_waitcnt vmcnt(0)
    s_mov_b64 exec, 1
    s_cmp_eq_u32 s12, 0
    s_cbranch_scc1 WT_50
    buffer_store_dword v62, v10, s[8:11], s38 offen
RT_51:
    s_mov_b64 exec, -1
    s_waitcnt lgkmcnt(2)
    v_pk_add_f32 v[48:49], v[48:49], v[50:51] op_sel:[0,0] op_sel_hi:[1,1]
    v_add_f32 v48, v48, v49
    s_add_u32 s65, s41, 0
    s_mov_b64 exec, s[54:55]
    s_cmp_eq_u32 s12, 0
    s_cbranch_scc1 WT_52
    buffer_store_dword v48, v1, s[8:11], s65 offen
RT_53:
    s_mov_b64 exec, -1
    s_waitcnt lgkmcnt(0)
    v_pk_add_f32 v[52:53], v[52:53], v[54:55] op_sel:[0,0] op_sel_hi:[1,1]
    v_add_f32 v52, v52, v53
    s_add_u32 s65, s41, 2048
    s_mov_b64 exec, s[54:55]
    s_cmp_eq_u32 s12, 0
    s_cbranch_scc1 WT_54
    buffer_store_dword v52, v1, s[8:11], s65 offen
RT_55:
    s_mov_b64 exec, -1
L_layer1:
    v_lshrrev_b32 v14, 9, v1
    v_lshlrev_b32 v50, 8, v14
    v_and_b32 v14, 0xc0, v1
    v_add_u32 v50, v50, v14
    v_bfe_u32 v14, v1, 8, 1
    v_lshl_add_u32 v50, v14, 5, v50
    v_bfe_u32 v14, v1, 4, 2
    v_lshl_add_u32 v50, v14, 3, v50
    v_add_u32 v52, 0, v50
    v_add_u32 v51, 101376, v50
    v_add_u32 v50, 67584, v50
    s_barrier
    ds_read_b64_tr_b16 v[20:21], v50 offset:0
    ds_read_b64_tr_b16 v[22:23], v50 offset:512
    ds_read_b64_tr_b16 v[24:25], v51 offset:0
    ds_read_b64_tr_b16 v[26:27], v51 offset:512
    ds_read_b64_tr_b16 v[28:29], v50 offset:1024
    ds_read_b64_tr_b16 v[30:31], v50 offset:1536
    ds_read_b64_tr_b16 v[32:33], v51 offset:1024
    ds_read_b64_tr_b16 v[34:35], v51 offset:1536
    ds_read_b64_tr_b16 v[36:37], v50 offset:2048
    ds_read_b64_tr_b16 v[38:39], v50 offset:2560
    s_mov_b32 s62, 0
POLL_58:
    buffer_load_dword v63, v8, s[8:11], s37 offen sc1
    s_add_u32 s62, s62, 1
    s_cmp_gt_u32 s62, 0x200000
    s_cbranch_scc1 L_fail
    s_waitcnt vmcnt(0)
    v_cmp_gt_u32 vcc, 6, v63
    s_cbranch_vccnz POLL_58
    s_lshl_b32 s15, s32, 12
    s_add_u32 s15, s15, s39
    s_xor_b32 s64, s15, 0
    buffer_load_dwordx4 v[128:131], v1, s[8:11], s64 offen sc1
    buffer_load_dwordx4 v[132:135], v1, s[8:11], s64 offen offset:1024 sc1
    buffer_load_dwordx4 v[136:139], v1, s[8:11], s64 offen offset:2048 sc1
    buffer_load_dwordx4 v[140:143], v1, s[8:11], s64 offen offset:3072 sc1
    s_xor_b32 s64, s15, 4096
    buffer_load_dwordx4 v[144:147], v1, s[8:11], s64 offen sc1
    buffer_load_dwordx4 v[148:151], v1, s[8:11], s64 offen offset:1024 sc1
    buffer_load_dwordx4 v[152:155], v1, s[8:11], s64 offen offset:2048 sc1
    v_mov_b32 v62, 7
    s_mov_b64 exec, 1
    s_cmp_eq_u32 s12, 0
    s_cbranch_scc1 WT_56
    buffer_store_dword v62, v10, s[8:11], s38 offen
RT_57:
    s_mov_b64 exec, -1
    s_waitcnt vmcnt(7) lgkmcnt(8)
    v_mfma_f32_32x32x16_bf16 v[64:79], v[20:23], v[128:131], 0
    ds_read_b64_tr_b16 v[20:21], v51 offset:2048
    ds_read_b64_tr_b16 v[22:23], v51 offset:2560
    buffer_load_dwordx4 v[156:159], v1, s[8:11], s64 offen offset:3072 sc1
    s_waitcnt lgkmcnt(8)
    v_mfma_f32_32x32x16_bf16 v[80:95], v[24:27], v[128:131], 0
    ds_read_b64_tr_b16 v[24:25], v50 offset:3072
    ds_read_b64_tr_b16 v[26:27], v50 offset:3584
    s_waitcnt vmcnt(7) lgkmcnt(6)
    v_mfma_f32_32x32x16_bf16 v[64:79], v[28:31], v[132:135], v[64:79]
    ds_read_b64_tr_b16 v[28:29], v51 offset:3072
    ds_read_b64_tr_b16 v[30:31], v51 offset:3584
    s_xor_b32 s64, s15, 8192
    buffer_load_dwordx4 v[160:163], v1, s[8:11], s64 offen sc1
    v_mfma_f32_32x32x16_bf16 v[80:95], v[32:35], v[132:135], v[80:95]
    ds_read_b64_tr_b16 v[32:33], v50 offset:4096
    ds_read_b64_tr_b16 v[34:35], v50 offset:4608
    v_and_b32 v40, 0x1f0, v1
    s_waitcnt vmcnt(7) lgkmcnt(6)
    v_mfma_f32_32x32x16_bf16 v[64:79], v[36:39], v[136:139], v[64:79]
    ds_read_b64_tr_b16 v[36:37], v51 offset:4096
    ds_read_b64_tr_b16 v[38:39], v51 offset:4608
    buffer_load_dwordx4 v[164:167], v1, s[8:11], s64 offen offset:1024 sc1
    v_mfma_f32_32x32x16_bf16 v[80:95], v[20:23], v[136:139], v[80:95]
    ds_read_b64_tr_b16 v[20:21], v50 offset:5120
    ds_read_b64_tr_b16 v[22:23], v50 offset:5632
    v_lshlrev_b32 v40, 1, v40
    s_lshl_b32 s56, s28, 10
    s_waitcnt vmcnt(7) lgkmcnt(6)
    v_mfma_f32_32x32x16_bf16 v[64:79], v[24:27], v[140:143], v[64:79]
    ds_read_b64_tr_b16 v[24:25], v51 offset:5120
    ds_read_b64_tr_b16 v[26:27], v51 offset:5632
    buffer_load_dwordx4 v[168:171], v1, s[8:11], s64 offen offset:2048 sc1
    v_mfma_f32_32x32x16_bf16 v[80:95], v[28:31], v[140:143], v[80:95]
    ds_read_b64_tr_b16 v[28:29], v50 offset:6144
    ds_read_b64_tr_b16 v[30:31], v50 offset:6656
    s_add_u32 s56, s56, 135168
    s_waitcnt vmcnt(7) lgkmcnt(6)
    v_mfma_f32_32x32x16_bf16 v[64:79], v[32:35], v[144:147], v[64:79]
    ds_read_b64_tr_b16 v[32:33], v51 offset:6144
    ds_read_b64_tr_b16 v[34:35], v51 offset:6656
    buffer_load_dwordx4 v[172:175], v1, s[8:11], s64 offen offset:3072 sc1
    v_add_u32 v40, s56, v40
    v_mfma_f32_32x32x16_bf16 v[80:95], v[36:39], v[144:147], v[80:95]
    ds_read_b64_tr_b16 v[36:37], v50 offset:7168
    ds_read_b64_tr_b16 v[38:39], v50 offset:7680
    v_lshrrev_b32 v42, 9, v1
    s_waitcnt vmcnt(7) lgkmcnt(6)
    v_mfma_f32_32x32x16_bf16 v[64:79], v[20:23], v[148:151], v[64:79]
    ds_read_b64_tr_b16 v[20:21], v51 offset:7168
    ds_read_b64_tr_b16 v[22:23], v51 offset:7680
    s_xor_b32 s64, s15, 12288
    buffer_load_dwordx4 v[176:179], v1, s[8:11], s64 offen sc1
    v_mfma_f32_32x32x16_bf16 v[80:95], v[24:27], v[148:151], v[80:95]
    ds_read_b64_tr_b16 v[24:25], v50 offset:8192
    ds_read_b64_tr_b16 v[26:27], v50 offset:8704
    v_lshl_add_u32 v41, v42, 4, v40
    s_waitcnt vmcnt(7) lgkmcnt(6)
    v_mfma_f32_32x32x16_bf16 v[64:79], v[28:31], v[152:155], v[64:79]
    ds_read_b64_tr_b16 v[28:29], v51 offset:8192
    ds_read_b64_tr_b16 v[30:31], v51 offset:8704
    buffer_load_dwordx4 v[180:183], v1, s[8:11], s64 offen offset:1024 sc1
    v_mfma_f32_32x32x16_bf16 v[80:95], v[32:35], v[152:155], v[80:95]
    ds_read_b64_tr_b16 v[32:33], v50 offset:9216
    ds_read_b64_tr_b16 v[34:35], v50 offset:9728
    v_lshl_add_u32 v40, v42, 13, v40
    v_lshrrev_b32 v42, 1, v1
    s_waitcnt vmcnt(6) lgkmcnt(6)
    v_mfma_f32_32x32x16_bf16 v[64:79], v[36:39], v[156:159], v[64:79]
    ds_read_b64_tr_b16 v[36:37], v51 offset:9216
    ds_read_b64_tr_b16 v[38:39], v51 offset:9728
    buffer_load_dwordx4 v[184:187], v1, s[8:11], s64 offen offset:2048 sc1
    buffer_load_dword v63, v8, s[8:11], s37 offen sc1
    v_mfma_f32_32x32x16_bf16 v[80:95], v[20:23], v[156:159], v[80:95]
    ds_read_b64_tr_b16 v[20:21], v50 offset:10240
    ds_read_b64_tr_b16 v[22:23], v50 offset:10752
    s_waitcnt vmcnt(7) lgkmcnt(6)
    v_mfma_f32_32x32x16_bf16 v[64:79], v[24:27], v[160:163], v[64:79]
    ds_read_b64_tr_b16 v[24:25], v51 offset:10240
    ds_read_b64_tr_b16 v[26:27], v51 offset:10752
    buffer_load_dwordx4 v[188:191], v1, s[8:11], s64 offen offset:3072 sc1
    v_mfma_f32_32x32x16_bf16 v[80:95], v[28:31], v[160:163], v[80:95]
    ds_read_b64_tr_b16 v[28:29], v50 offset:11264
    ds_read_b64_tr_b16 v[30:31], v50 offset:11776
    s_lshl_b32 s56, s28, 12
    s_waitcnt vmcnt(7) lgkmcnt(6)
    v_mfma_f32_32x32x16_bf16 v[64:79], v[32:35], v[164:167], v[64:79]
    ds_read_b64_tr_b16 v[32:33], v51 offset:11264
    ds_read_b64_tr_b16 v[34:35], v51 offset:11776
    s_xor_b32 s64, s15, 16384
    buffer_load_dwordx4 v[192:195], v1, s[8:11], s64 offen sc1
    v_mfma_f32_32x32x16_bf16 v[80:95], v[36:39], v[164:167], v[80:95]
    ds_read_b64_tr_b16 v[36:37], v50 offset:12288
    ds_read_b64_tr_b16 v[38:39], v50 offset:12800
    s_add_u32 s56, s56, 135168
    s_waitcnt vmcnt(7) lgkmcnt(6)
    v_mfma_f32_32x32x16_bf16 v[64:79], v[20:23], v[168:171], v[64:79]
    ds_read_b64_tr_b16 v[20:21], v51 offset:12288
    ds_read_b64_tr_b16 v[22:23], v51 offset:12800
    buffer_load_dwordx4 v[196:199], v1, s[8:11], s64 offen offset:1024 sc1
    v_mfma_f32_32x32x16_bf16 v[80:95], v[24:27], v[168:171], v[80:95]
    ds_read_b64_tr_b16 v[24:25], v50 offset:13312
    ds_read_b64_tr_b16 v[26:27], v50 offset:13824
    s_lshr_b32 s57, s28, 1
    s_lshl_b32 s57, s57, 12
    s_waitcnt vmcnt(7) lgkmcnt(6)
    v_mfma_f32_32x32x16_bf16 v[64:79], v[28:31], v[172:175], v[64:79]
    ds_read_b64_tr_b16 v[28:29], v51 offset:13312
    ds_read_b64_tr_b16 v[30:31], v51 offset:13824
    buffer_load_dwordx4 v[200:203], v1, s[8:11], s64 offen offset:2048 sc1
    v_mfma_f32_32x32x16_bf16 v[80:95], v[32:35], v[172:175], v[80:95]
    ds_read_b64_tr_b16 v[32:33], v50 offset:14336
    ds_read_b64_tr_b16 v[34:35], v50 offset:14848
    s_add_u32 s57, s57, 151552
    s_waitcnt vmcnt(7) lgkmcnt(6)
    v_mfma_f32_32x32x16_bf16 v[64:79], v[36:39], v[176:179], v[64:79]
    ds_read_b64_tr_b16 v[36:37], v51 offset:14336
    ds_read_b64_tr_b16 v[38:39], v51 offset:14848
    buffer_load_dwordx4 v[204:207], v1, s[8:11], s64 offen offset:3072 sc1
    v_add_u32 v43, s57, v42
    v_mfma_f32_32x32x16_bf16 v[80:95], v[20:23], v[176:179], v[80:95]
    ds_read_b64_tr_b16 v[20:21], v50 offset:15360
    ds_read_b64_tr_b16 v[22:23], v50 offset:15872
    v_add_u32 v42, s56, v42
    s_waitcnt vmcnt(7) lgkmcnt(6)
    v_mfma_f32_32x32x16_bf16 v[64:79], v[24:27], v[180:183], v[64:79]
    ds_read_b64_tr_b16 v[24:25], v51 offset:15360
    ds_read_b64_tr_b16 v[26:27], v51 offset:15872
    s_xor_b32 s64, s15, 20480
    buffer_load_dwordx4 v[208:211], v1, s[8:11], s64 offen sc1
    v_mfma_f32_32x32x16_bf16 v[80:95], v[28:31], v[180:183], v[80:95]
    ds_read_b64_tr_b16 v[28:29], v50 offset:16384
    ds_read_b64_tr_b16 v[30:31], v50 offset:16896
    s_lshl_b32 s56, s28, 9
    s_waitcnt vmcnt(7) lgkmcnt(6)
    v_mfma_f32_32x32x16_bf16 v[64:79], v[32:35], v[184:187], v[64:79]
    ds_read_b64_tr_b16 v[32:33], v51 offset:16384
    ds_read_b64_tr_b16 v[34:35], v51 offset:16896
    buffer_load_dwordx4 v[212:215], v1, s[8:11], s64 offen offset:1024 sc1
    s_waitcnt vmcnt(7)
    v_cmp_gt_u32 vcc, 7, v63
    s_cbranch_vccz OK_59
    s_mov_b32 s62, 0
    SP_60:
    buffer_load_dword v63, v8, s[8:11], s37 offen sc1
    s_add_u32 s62, s62, 1
    s_cmp_gt_u32 s62, 0x200000
    s_cbranch_scc1 L_fail
    s_waitcnt vmcnt(0)
    v_cmp_gt_u32 vcc, 7, v63
    s_cbranch_vccnz SP_60
    OK_59:
    v_mfma_f32_32x32x16_bf16 v[80:95], v[36:39], v[184:187], v[80:95]
    ds_read_b64_tr_b16 v[36:37], v50 offset:17408
    ds_read_b64_tr_b16 v[38:39], v50 offset:17920
    s_lshr_b32 s65, s39, 4
    s_add_u32 s65, s65, 6918144
    buffer_load_dwordx4 v[54:57], v1, s[8:11], s65 offen sc1
    s_waitcnt vmcnt(7) lgkmcnt(6)
    v_mfma_f32_32x32x16_bf16 v[64:79], v[20:23], v[188:191], v[64:79]
    ds_read_b64_tr_b16 v[20:21], v51 offset:17408
    ds_read_b64_tr_b16 v[22:23], v51 offset:17920
    buffer_load_dwordx4 v[216:219], v1, s[8:11], s64 offen offset:2048 sc1
    v_mfma_f32_32x32x16_bf16 v[80:95], v[24:27], v[188:191], v[80:95]
    ds_read_b64_tr_b16 v[24:25], v50 offset:18432
    ds_read_b64_tr_b16 v[26:27], v50 offset:18944
    buffer_load_dwordx4 v[58:61], v1, s[8:11], s65 offen offset:1024 sc1
    s_waitcnt vmcnt(8) lgkmcnt(6)
    v_mfma_f32_32x32x16_bf16 v[64:79], v[28:31], v[192:195], v[64:79]
    ds_read_b64_tr_b16 v[28:29], v51 offset:18432
    ds_read_b64_tr_b16 v[30:31], v51 offset:18944
    buffer_load_dwordx4 v[220:223], v1, s[8:11], s64 offen offset:3072 sc1
    v_mfma_f32_32x32x16_bf16 v[80:95], v[32:35], v[192:195], v[80:95]
    ds_read_b64_tr_b16 v[32:33], v50 offset:19456
    ds_read_b64_tr_b16 v[34:35], v50 offset:19968
    s_waitcnt vmcnt(8) lgkmcnt(6)
    v_mfma_f32_32x32x16_bf16 v[64:79], v[36:39], v[196:199], v[64:79]
    ds_read_b64_tr_b16 v[36:37], v51 offset:19456
    ds_read_b64_tr_b16 v[38:39], v51 offset:19968
    s_xor_b32 s64, s15, 24576
    buffer_load_dwordx4 v[224:227], v1, s[8:11], s64 offen sc1
    v_mfma_f32_32x32x16_bf16 v[80:95], v[20:23], v[196:199], v[80:95]
    ds_read_b64_tr_b16 v[20:21], v50 offset:20480
    ds_read_b64_tr_b16 v[22:23], v50 offset:20992
    s_waitcnt vmcnt(8) lgkmcnt(6)
    v_mfma_f32_32x32x16_bf16 v[64:79], v[24:27], v[200:203], v[64:79]
    ds_read_b64_tr_b16 v[24:25], v51 offset:20480
    ds_read_b64_tr_b16 v[26:27], v51 offset:20992
    buffer_load_dwordx4 v[228:231], v1, s[8:11], s64 offen offset:1024 sc1
    v_mfma_f32_32x32x16_bf16 v[80:95], v[28:31], v[200:203], v[80:95]
    ds_read_b64_tr_b16 v[28:29], v50 offset:21504
    ds_read_b64_tr_b16 v[30:31], v50 offset:22016
    v_add_u32 v44, s56, v1
    s_waitcnt vmcnt(8) lgkmcnt(6)
    v_mfma_f32_32x32x16_bf16 v[64:79], v[32:35], v[204:207], v[64:79]
    ds_read_b64_tr_b16 v[32:33], v51 offset:21504
    ds_read_b64_tr_b16 v[34:35], v51 offset:22016
    buffer_load_dwordx4 v[232:235], v1, s[8:11], s64 offen offset:2048 sc1
    v_mfma_f32_32x32x16_bf16 v[80:95], v[36:39], v[204:207], v[80:95]
    ds_read_b64_tr_b16 v[36:37], v50 offset:22528
    ds_read_b64_tr_b16 v[38:39], v50 offset:23040
    s_lshl_b32 s56, s28, 5
    s_waitcnt vmcnt(8) lgkmcnt(6)
    v_mfma_f32_32x32x16_bf16 v[64:79], v[20:23], v[208:211], v[64:79]
    ds_read_b64_tr_b16 v[20:21], v51 offset:22528
    ds_read_b64_tr_b16 v[22:23], v51 offset:23040
    buffer_load_dwordx4 v[236:239], v1, s[8:11], s64 offen offset:3072 sc1
    s_add_u32 s56, s56, 2048
    v_mfma_f32_32x32x16_bf16 v[80:95], v[24:27], v[208:211], v[80:95]
    ds_read_b64_tr_b16 v[24:25], v50 offset:23552
    ds_read_b64_tr_b16 v[26:27], v50 offset:24064
    s_add_u32 s57, s56, 16
    s_waitcnt vmcnt(8) lgkmcnt(6)
    v_mfma_f32_32x32x16_bf16 v[64:79], v[28:31], v[212:215], v[64:79]
    ds_read_b64_tr_b16 v[28:29], v51 offset:23552
    ds_read_b64_tr_b16 v[30:31], v51 offset:24064
    s_xor_b32 s64, s15, 28672
    buffer_load_dwordx4 v[240:243], v1, s[8:11], s64 offen sc1
    v_mfma_f32_32x32x16_bf16 v[80:95], v[32:35], v[212:215], v[80:95]
    ds_read_b64_tr_b16 v[32:33], v50 offset:24576
    ds_read_b64_tr_b16 v[34:35], v50 offset:25088
    v_writelane_b32 v44, s56, 32
    s_waitcnt vmcnt(7) lgkmcnt(6)
    v_mfma_f32_32x32x16_bf16 v[64:79], v[36:39], v[216:219], v[64:79]
    ds_read_b64_tr_b16 v[36:37], v51 offset:24576
    ds_read_b64_tr_b16 v[38:39], v51 offset:25088
    buffer_load_dwordx4 v[244:247], v1, s[8:11], s64 offen offset:1024 sc1
    v_mfma_f32_32x32x16_bf16 v[80:95], v[20:23], v[216:219], v[80:95]
    ds_read_b64_tr_b16 v[20:21], v50 offset:25600
    ds_read_b64_tr_b16 v[22:23], v50 offset:26112
    v_writelane_b32 v44, s57, 48
    s_add_u32 s61, s50, 557056
    s_waitcnt vmcnt(6) lgkmcnt(6)
    v_mfma_f32_32x32x16_bf16 v[64:79], v[24:27], v[220:223], v[64:79]
    ds_read_b64_tr_b16 v[24:25], v51 offset:25600
    ds_read_b64_tr_b16 v[26:27], v51 offset:26112
    buffer_load_dwordx4 v[248:251], v1, s[8:11], s64 offen offset:2048 sc1
    v_mfma_f32_32x32x16_bf16 v[80:95], v[28:31], v[220:223], v[80:95]
    ds_read_b64_tr_b16 v[28:29], v50 offset:26624
    ds_read_b64_tr_b16 v[30:31], v50 offset:27136
    s_waitcnt vmcnt(6) lgkmcnt(6)
    v_mfma_f32_32x32x16_bf16 v[64:79], v[32:35], v[224:227], v[64:79]
    ds_read_b64_tr_b16 v[32:33], v51 offset:26624
    ds_read_b64_tr_b16 v[34:35], v51 offset:27136
    buffer_load_dwordx4 v[252:255], v1, s[8:11], s64 offen offset:3072 sc1
    v_mfma_f32_32x32x16_bf16 v[80:95], v[36:39], v[224:227], v[80:95]
    ds_read_b64_tr_b16 v[36:37], v50 offset:27648
    ds_read_b64_tr_b16 v[38:39], v50 offset:28160
    v_pk_add_f32 v[54:55], v[54:55], v[56:57] op_sel:[0,0] op_sel_hi:[1,1]
    s_waitcnt vmcnt(6) lgkmcnt(6)
    v_mfma_f32_32x32x16_bf16 v[64:79], v[20:23], v[228:231], v[64:79]
    ds_read_b64_tr_b16 v[20:21], v51 offset:27648
    ds_read_b64_tr_b16 v[22:23], v51 offset:28160
    v_pk_add_f32 v[58:59], v[58:59], v[60:61] op_sel:[0,0] op_sel_hi:[1,1]
    v_pk_add_f32 v[54:55], v[54:55], v[58:59] op_sel:[0,0] op_sel_hi:[1,1]
    v_add_f32 v54, v54, v55
    v_mfma_f32_32x32x16_bf16 v[80:95], v[24:27], v[228:231], v[80:95]
    ds_read_b64_tr_b16 v[24:25], v50 offset:28672
    ds_read_b64_tr_b16 v[26:27], v50 offset:29184
    v_mov_b32 v55, v54
    s_waitcnt vmcnt(5) lgkmcnt(6)
    v_mfma_f32_32x32x16_bf16 v[64:79], v[28:31], v[232:235], v[64:79]
    ds_read_b64_tr_b16 v[28:29], v51 offset:28672
    ds_read_b64_tr_b16 v[30:31], v51 offset:29184
    v_permlane32_swap_b32 v54, v55
    v_mfma_f32_32x32x16_bf16 v[80:95], v[32:35], v[232:235], v[80:95]
    ds_read_b64_tr_b16 v[32:33], v50 offset:29696
    ds_read_b64_tr_b16 v[34:35], v50 offset:30208
    v_mul_f32 v54, 0xbb000000, v54
    v_mul_f32 v55, 0x3b000000, v55
    s_waitcnt vmcnt(4) lgkmcnt(6)
    v_mfma_f32_32x32x16_bf16 v[64:79], v[36:39], v[236:239], v[64:79]
    ds_read_b64_tr_b16 v[36:37], v51 offset:29696
    ds_read_b64_tr_b16 v[38:39], v51 offset:30208
    v_fma_f32 v55, -v54, v54, v55
    v_cvt_pk_bf16_f32 v16, v54, v54
    v_mfma_f32_32x32x16_bf16 v[80:95], v[20:23], v[236:239], v[80:95]
    ds_read_b64_tr_b16 v[20:21], v50 offset:30720
    ds_read_b64_tr_b16 v[22:23], v50 offset:31232
    v_max_f32 v55, 0, v55
    v_cvt_pk_bf16_f32 v17, v54, v54
    s_waitcnt vmcnt(3) lgkmcnt(6)
    v_mfma_f32_32x32x16_bf16 v[64:79], v[24:27], v[240:243], v[64:79]
    ds_read_b64_tr_b16 v[24:25], v51 offset:30720
    ds_read_b64_tr_b16 v[26:27], v51 offset:31232
    v_add_f32 v55, 0x3727c5ac, v55
    v_cvt_pk_bf16_f32 v18, v54, v54
    v_mfma_f32_32x32x16_bf16 v[80:95], v[28:31], v[240:243], v[80:95]
    ds_read_b128 v[28:31], v4 offset:32768
    v_rsq_f32 v12, v55
    s_waitcnt vmcnt(2) lgkmcnt(5)
    v_mfma_f32_32x32x16_bf16 v[64:79], v[32:35], v[244:247], v[64:79]
    ds_read_b128 v[32:35], v5 offset:32768
    v_cvt_pk_bf16_f32 v19, v54, v54
    v_mul_f32 v13, v55, v12
    v_mfma_f32_32x32x16_bf16 v[80:95], v[36:39], v[244:247], v[80:95]
    ds_read_b64_tr_b16 v[36:37], v50 offset:31744
    ds_read_b64_tr_b16 v[38:39], v50 offset:32256
    v_mul_f32 v58, 0x3fb8aa3b, v12
    s_waitcnt vmcnt(1) lgkmcnt(4)
    v_mfma_f32_32x32x16_bf16 v[64:79], v[20:23], v[248:251], v[64:79]
    ds_read_b64_tr_b16 v[20:21], v51 offset:31744
    ds_read_b64_tr_b16 v[22:23], v51 offset:32256
    v_mfma_f32_32x32x16_bf16 v[80:95], v[24:27], v[248:251], v[80:95]
    s_waitcnt lgkmcnt(4)
    v_mfma_f32_32x32x16_bf16 v[64:79], v[28:31], v[16:19], v[64:79]
    v_mfma_f32_32x32x16_bf16 v[80:95], v[32:35], v[16:19], v[80:95]
    s_waitcnt vmcnt(0) lgkmcnt(0)
    v_mfma_f32_32x32x16_bf16 v[64:79], v[36:39], v[252:255], v[64:79]
    v_mfma_f32_32x32x16_bf16 v[80:95], v[20:23], v[252:255], v[80:95]
    s_nop 10
    v_cvt_pk_bf16_f32 v20, v64, v65
    v_cvt_pk_bf16_f32 v21, v66, v67
    v_cvt_pk_bf16_f32 v22, v68, v69
    v_cvt_pk_bf16_f32 v23, v70, v71
    v_cvt_pk_bf16_f32 v24, v72, v73
    v_cvt_pk_bf16_f32 v25, v74, v75
    v_cvt_pk_bf16_f32 v26, v76, v77
    v_cvt_pk_bf16_f32 v27, v78, v79
    v_mfma_f32_32x32x16_bf16 v[112:127], a[240:243], v[20:23], 0
    s_nop 0
    v_mfma_f32_32x32x16_bf16 v[112:127], a[244:247], v[24:27], v[112:127]
    s_barrier
    s_add_u32 m0, s52, 67584
    s_add_u32 s63, s47, 168960
    buffer_load_dwordx4 v1, s[8:11], s63 offen offset:0 lds
    buffer_load_dwordx4 v1, s[8:11], s63 offen offset:1024 lds
    buffer_load_dwordx4 v1, s[8:11], s63 offen offset:2048 lds
    buffer_load_dwordx4 v1, s[8:11], s63 offen offset:3072 lds
    v_pk_mul_f32 v[80:81], v[80:81], v[12:13] op_sel:[0,0] op_sel_hi:[1,0]
    v_pk_mul_f32 v[82:83], v[82:83], v[12:13] op_sel:[0,0] op_sel_hi:[1,0]
    v_pk_mul_f32 v[84:85], v[84:85], v[12:13] op_sel:[0,0] op_sel_hi:[1,0]
    v_pk_mul_f32 v[86:87], v[86:87], v[12:13] op_sel:[0,0] op_sel_hi:[1,0]
    v_pk_mul_f32 v[88:89], v[88:89], v[12:13] op_sel:[0,0] op_sel_hi:[1,0]
    v_pk_mul_f32 v[90:91], v[90:91], v[12:13] op_sel:[0,0] op_sel_hi:[1,0]
    v_pk_mul_f32 v[92:93], v[92:93], v[12:13] op_sel:[0,0] op_sel_hi:[1,0]
    v_pk_mul_f32 v[94:95], v[94:95], v[12:13] op_sel:[0,0] op_sel_hi:[1,0]
    v_cvt_pk_bf16_f32 v28, v80, v81
    v_cvt_pk_bf16_f32 v29, v82, v83
    v_cvt_pk_bf16_f32 v30, v84, v85
    v_cvt_pk_bf16_f32 v31, v86, v87
    v_cvt_pk_bf16_f32 v32, v88, v89
    v_cvt_pk_bf16_f32 v33, v90, v91
    v_cvt_pk_bf16_f32 v34, v92, v93
    v_cvt_pk_bf16_f32 v35, v94, v95
    ds_write_b128 v41, v[28:31] offset:16384
    ds_write_b128 v41, v[32:35] offset:20480
    s_add_u32 m0, s52, 71680
    s_add_u32 s63, s47, 173056
    buffer_load_dwordx4 v1, s[8:11], s63 offen offset:0 lds
    buffer_load_dwordx4 v1, s[8:11], s63 offen offset:1024 lds
    v_max3_f32 v14, v112, v113, v114
    v_min3_f32 v15, v112, v113, v114
    v_max3_f32 v14, v14, v115, v116
    v_min3_f32 v15, v15, v115, v116
    v_max3_f32 v14, v14, v117, v118
    v_min3_f32 v15, v15, v117, v118
    v_max3_f32 v14, v14, v119, v120
    v_min3_f32 v15, v15, v119, v120
    v_max3_f32 v14, v14, v121, v122
    v_min3_f32 v15, v15, v121, v122
    v_max3_f32 v14, v14, v123, v124
    v_min3_f32 v15, v15, v123, v124
    v_max3_f32 v14, v14, v125, v126
    v_min3_f32 v15, v15, v125, v126
    v_max_f32 v14, v14, v127
    v_min_f32 v15, v15, v127
    v_pk_mul_f32 v[14:15], v[14:15], v[58:59] op_sel:[0,0] op_sel_hi:[1,0]
    v_pk_fma_f32 v[64:65], v[112:113], v[58:59], v[14:15] op_sel:[0,0,0] op_sel_hi:[1,0,0] neg_lo:[0,0,1] neg_hi:[0,0,1]
    v_pk_fma_f32 v[66:67], v[114:115], v[58:59], v[14:15] op_sel:[0,0,0] op_sel_hi:[1,0,0] neg_lo:[0,0,1] neg_hi:[0,0,1]
    v_pk_fma_f32 v[68:69], v[116:117], v[58:59], v[14:15] op_sel:[0,0,0] op_sel_hi:[1,0,0] neg_lo:[0,0,1] neg_hi:[0,0,1]
    v_pk_fma_f32 v[70:71], v[118:119], v[58:59], v[14:15] op_sel:[0,0,0] op_sel_hi:[1,0,0] neg_lo:[0,0,1] neg_hi:[0,0,1]
    v_pk_fma_f32 v[72:73], v[120:121], v[58:59], v[14:15] op_sel:[0,0,0] op_sel_hi:[1,0,0] neg_lo:[0,0,1] neg_hi:[0,0,1]
    v_pk_fma_f32 v[74:75], v[122:123], v[58:59], v[14:15] op_sel:[0,0,0] op_sel_hi:[1,0,0] neg_lo:[0,0,1] neg_hi:[0,0,1]
    v_pk_fma_f32 v[76:77], v[124:125], v[58:59], v[14:15] op_sel:[0,0,0] op_sel_hi:[1,0,0] neg_lo:[0,0,1] neg_hi:[0,0,1]
    v_pk_fma_f32 v[78:79], v[126:127], v[58:59], v[14:15] op_sel:[0,0,0] op_sel_hi:[1,0,0] neg_lo:[0,0,1] neg_hi:[0,0,1]
    v_exp_f32 v64, v64
    v_exp_f32 v65, v65
    v_exp_f32 v66, v66
    v_exp_f32 v67, v67
    v_exp_f32 v68, v68
    v_exp_f32 v69, v69
    v_exp_f32 v70, v70
    v_exp_f32 v71, v71
    v_exp_f32 v72, v72
    v_exp_f32 v73, v73
    v_exp_f32 v74, v74
    v_exp_f32 v75, v75
    v_exp_f32 v76, v76
    v_exp_f32 v77, v77
    v_exp_f32 v78, v78
    v_exp_f32 v79, v79
    v_pk_add_f32 v[36:37], v[64:65], v[66:67] op_sel:[0,0] op_sel_hi:[1,1]
    v_pk_add_f32 v[36:37], v[36:37], v[68:69] op_sel:[0,0] op_sel_hi:[1,1]
    v_pk_add_f32 v[36:37], v[36:37], v[70:71] op_sel:[0,0] op_sel_hi:[1,1]
    v_pk_add_f32 v[36:37], v[36:37], v[72:73] op_sel:[0,0] op_sel_hi:[1,1]
    v_pk_add_f32 v[36:37], v[36:37], v[74:75] op_sel:[0,0] op_sel_hi:[1,1]
    v_pk_add_f32 v[36:37], v[36:37], v[76:77] op_sel:[0,0] op_sel_hi:[1,1]
    v_pk_add_f32 v[36:37], v[36:37], v[78:79] op_sel:[0,0] op_sel_hi:[1,1]
    v_add_f32 v36, v36, v37
    v_rcp_f32 v36, v36
    s_nop 0
    v_pk_mul_f32 v[64:65], v[64:65], v[36:37] op_sel:[0,0] op_sel_hi:[1,0]
    v_pk_mul_f32 v[66:67], v[66:67], v[36:37] op_sel:[0,0] op_sel_hi:[1,0]
    v_pk_mul_f32 v[68:69], v[68:69], v[36:37] op_sel:[0,0] op_sel_hi:[1,0]
    v_pk_mul_f32 v[70:71], v[70:71], v[36:37] op_sel:[0,0] op_sel_hi:[1,0]
    v_pk_mul_f32 v[72:73], v[72:73], v[36:37] op_sel:[0,0] op_sel_hi:[1,0]
    v_pk_mul_f32 v[74:75], v[74:75], v[36:37] op_sel:[0,0] op_sel_hi:[1,0]
    v_pk_mul_f32 v[76:77], v[76:77], v[36:37] op_sel:[0,0] op_sel_hi:[1,0]
    v_pk_mul_f32 v[78:79], v[78:79], v[36:37] op_sel:[0,0] op_sel_hi:[1,0]
    v_cvt_pk_bf16_f32 v96, v64, v65
    v_cvt_pk_bf16_f32 v97, v66, v67
    v_cvt_pk_bf16_f32 v98, v68, v69
    v_cvt_pk_bf16_f32 v99, v70, v71
    v_cvt_pk_bf16_f32 v100, v72, v73
    v_cvt_pk_bf16_f32 v101, v74, v75
    v_cvt_pk_bf16_f32 v102, v76, v77
    v_cvt_pk_bf16_f32 v103, v78, v79
    ds_write_b128 v40, v[96:99]
    ds_write_b128 v40, v[100:103] offset:16
    v_pk_fma_f32 v[80:81], v[112:113], v[58:59], v[14:15] op_sel:[0,0,1] op_sel_hi:[1,0,1] neg_lo:[1,0,0] neg_hi:[1,0,0]
    v_pk_fma_f32 v[82:83], v[114:115], v[58:59], v[14:15] op_sel:[0,0,1] op_sel_hi:[1,0,1] neg_lo:[1,0,0] neg_hi:[1,0,0]
    v_pk_fma_f32 v[84:85], v[116:117], v[58:59], v[14:15] op_sel:[0,0,1] op_sel_hi:[1,0,1] neg_lo:[1,0,0] neg_hi:[1,0,0]
    v_pk_fma_f32 v[86:87], v[118:119], v[58:59], v[14:15] op_sel:[0,0,1] op_sel_hi:[1,0,1] neg_lo:[1,0,0] neg_hi:[1,0,0]
    v_pk_fma_f32 v[88:89], v[120:121], v[58:59], v[14:15] op_sel:[0,0,1] op_sel_hi:[1,0,1] neg_lo:[1,0,0] neg_hi:[1,0,0]
    v_pk_fma_f32 v[90:91], v[122:123], v[58:59], v[14:15] op_sel:[0,0,1] op_sel_hi:[1,0,1] neg_lo:[1,0,0] neg_hi:[1,0,0]
    v_pk_fma_f32 v[92:93], v[124:125], v[58:59], v[14:15] op_sel:[0,0,1] op_sel_hi:[1,0,1] neg_lo:[1,0,0] neg_hi:[1,0,0]
    v_pk_fma_f32 v[94:95], v[126:127], v[58:59], v[14:15] op_sel:[0,0,1] op_sel_hi:[1,0,1] neg_lo:[1,0,0] neg_hi:[1,0,0]
    v_exp_f32 v80, v80
    v_exp_f32 v81, v81
    v_exp_f32 v82, v82
    v_exp_f32 v83, v83
    v_exp_f32 v84, v84
    v_exp_f32 v85, v85
    v_exp_f32 v86, v86
    v_exp_f32 v87, v87
    v_exp_f32 v88, v88
    v_exp_f32 v89, v89
    v_exp_f32 v90, v90
    v_exp_f32 v91, v91
    v_exp_f32 v92, v92
    v_exp_f32 v93, v93
    v_exp_f32 v94, v94
    v_exp_f32 v95, v95
    v_pk_add_f32 v[38:39], v[80:81], v[82:83] op_sel:[0,0] op_sel_hi:[1,1]
    v_pk_add_f32 v[38:39], v[38:39], v[84:85] op_sel:[0,0] op_sel_hi:[1,1]
    v_pk_add_f32 v[38:39], v[38:39], v[86:87] op_sel:[0,0] op_sel_hi:[1,1]
    v_pk_add_f32 v[38:39], v[38:39], v[88:89] op_sel:[0,0] op_sel_hi:[1,1]
    v_pk_add_f32 v[38:39], v[38:39], v[90:91] op_sel:[0,0] op_sel_hi:[1,1]
    v_pk_add_f32 v[38:39], v[38:39], v[92:93] op_sel:[0,0] op_sel_hi:[1,1]
    v_pk_add_f32 v[38:39], v[38:39], v[94:95] op_sel:[0,0] op_sel_hi:[1,1]
    v_add_f32 v38, v38, v39
    v_rcp_f32 v38, v38
    s_nop 0
    v_pk_mul_f32 v[80:81], v[80:81], v[38:39] op_sel:[0,0] op_sel_hi:[1,0]
    v_pk_mul_f32 v[82:83], v[82:83], v[38:39] op_sel:[0,0] op_sel_hi:[1,0]
    v_pk_mul_f32 v[84:85], v[84:85], v[38:39] op_sel:[0,0] op_sel_hi:[1,0]
    v_pk_mul_f32 v[86:87], v[86:87], v[38:39] op_sel:[0,0] op_sel_hi:[1,0]
    v_pk_mul_f32 v[88:89], v[88:89], v[38:39] op_sel:[0,0] op_sel_hi:[1,0]
    v_pk_mul_f32 v[90:91], v[90:91], v[38:39] op_sel:[0,0] op_sel_hi:[1,0]
    v_pk_mul_f32 v[92:93], v[92:93], v[38:39] op_sel:[0,0] op_sel_hi:[1,0]
    v_pk_mul_f32 v[94:95], v[94:95], v[38:39] op_sel:[0,0] op_sel_hi:[1,0]
    v_cvt_pk_bf16_f32 v104, v80, v81
    v_cvt_pk_bf16_f32 v105, v82, v83
    v_cvt_pk_bf16_f32 v106, v84, v85
    v_cvt_pk_bf16_f32 v107, v86, v87
    ds_write_b128 v40, v[104:107] offset:4096
    v_cvt_pk_bf16_f32 v108, v88, v89
    v_cvt_pk_bf16_f32 v109, v90, v91
    v_cvt_pk_bf16_f32 v110, v92, v93
    v_cvt_pk_bf16_f32 v111, v94, v95
    ds_write_b128 v40, v[108:111] offset:4112
    buffer_load_dwordx4 v1, s[8:11], s63 offen offset:2048 lds
    buffer_load_dwordx4 v1, s[8:11], s63 offen offset:3072 lds
    s_add_u32 m0, s14, 67584
    s_add_u32 s63, s46, 168960
    buffer_load_dword v11, s[8:11], s63 offen lds
    s_waitcnt lgkmcnt(0)
    s_barrier
    ds_read_b64_tr_b16 v[64:65], v42 offset:0
    ds_read_b64_tr_b16 v[80:81], v43 offset:0
    ds_read_b64_tr_b16 v[66:67], v42 offset:512
    ds_read_b64_tr_b16 v[82:83], v43 offset:512
    ds_read_b64_tr_b16 v[68:69], v42 offset:1024
    ds_read_b64_tr_b16 v[84:85], v43 offset:1024
    ds_read_b64_tr_b16 v[70:71], v42 offset:1536
    ds_read_b64_tr_b16 v[86:87], v43 offset:1536
    ds_read_b64_tr_b16 v[72:73], v42 offset:2048
    ds_read_b64_tr_b16 v[88:89], v43 offset:2048
    ds_read_b64_tr_b16 v[74:75], v42 offset:2560
    ds_read_b64_tr_b16 v[90:91], v43 offset:2560
    ds_read_b64_tr_b16 v[76:77], v42 offset:3072
    ds_read_b64_tr_b16 v[92:93], v43 offset:3072
    ds_read_b64_tr_b16 v[78:79], v42 offset:3584
    ds_read_b64_tr_b16 v[94:95], v43 offset:3584
    s_waitcnt lgkmcnt(13)
    v_mfma_f32_16x16x32_bf16 v[116:119], v[64:67], a[252:255], 0
    s_waitcnt lgkmcnt(12)
    v_mfma_f32_16x16x32_bf16 v[112:115], v[64:67], v[80:83], 0
    s_waitcnt lgkmcnt(9)
    v_mfma_f32_16x16x32_bf16 v[116:119], v[68:71], a[252:255], v[116:119]
    s_waitcnt lgkmcnt(8)
    v_mfma_f32_16x16x32_bf16 v[112:115], v[68:71], v[84:87], v[112:115]
    s_waitcnt lgkmcnt(5)
    v_mfma_f32_16x16x32_bf16 v[116:119], v[72:75], a[252:255], v[116:119]
    s_waitcnt lgkmcnt(4)
    v_mfma_f32_16x16x32_bf16 v[112:115], v[72:75], v[88:91], v[112:115]
    s_waitcnt lgkmcnt(1)
    v_mfma_f32_16x16x32_bf16 v[116:119], v[76:79], a[252:255], v[116:119]
    s_waitcnt lgkmcnt(0)
    v_mfma_f32_16x16x32_bf16 v[112:115], v[76:79], v[92:95], v[112:115]
    s_nop 5
    v_cvt_pk_bf16_f32 v122, v116, v117
    v_cvt_pk_bf16_f32 v123, v118, v119
    v_cvt_pk_bf16_f32 v120, v112, v113
    v_cvt_pk_bf16_f32 v121, v114, v115
    s_nop 0
    v_permlane32_swap_b32 v120, v122
    v_permlane32_swap_b32 v121, v123
    v_min_u32 v120, -2, v120
    v_min_u32 v123, -2, v123
    s_mov_b32 exec_hi, 0x00010001
    buffer_store_dwordx4 v[120:123], v44, s[8:11], s61 offen sc1
    s_mov_b64 exec, -1
    ds_read_b64_tr_b16 v[20:21], v52 offset:0
    ds_read_b64_tr_b16 v[22:23], v52 offset:512
    ds_read_b64_tr_b16 v[24:25], v52 offset:1024
    ds_read_b64_tr_b16 v[26:27], v52 offset:1536
    ds_read_b64_tr_b16 v[28:29], v52 offset:2048
    ds_read_b64_tr_b16 v[30:31], v52 offset:2560
    ds_read_b64_tr_b16 v[32:33], v52 offset:3072
    ds_read_b64_tr_b16 v[34:35], v52 offset:3584
    ds_read_b64_tr_b16 v[36:37], v52 offset:4096
    ds_read_b64_tr_b16 v[38:39], v52 offset:4608
    s_waitcnt lgkmcnt(8)
    v_mfma_f32_32x32x16_bf16 v[96:111], v[20:23], v[128:131], 0
    ds_read_b64_tr_b16 v[20:21], v52 offset:5120
    ds_read_b64_tr_b16 v[22:23], v52 offset:5632
    s_add_u32 m0, s52, 101376
    s_add_u32 s63, s47, 135168
    buffer_load_dwordx4 v1, s[8:11], s63 offen offset:0 lds
    s_waitcnt lgkmcnt(8)
    v_mfma_f32_32x32x16_bf16 v[96:111], v[24:27], v[132:135], v[96:111]
    ds_read_b64_tr_b16 v[24:25], v52 offset:6144
    ds_read_b64_tr_b16 v[26:27], v52 offset:6656
    buffer_load_dwordx4 v1, s[8:11], s63 offen offset:1024 lds
    s_waitcnt lgkmcnt(6)
    v_mfma_f32_32x32x16_bf16 v[96:111], v[28:31], v[136:139], v[96:111]
    ds_read_b64_tr_b16 v[28:29], v52 offset:7168
    ds_read_b64_tr_b16 v[30:31], v52 offset:7680
    buffer_load_dwordx4 v1, s[8:11], s63 offen offset:2048 lds
    v_mfma_f32_32x32x16_bf16 v[96:111], v[32:35], v[140:143], v[96:111]
    ds_read_b64_tr_b16 v[32:33], v52 offset:8192
    ds_read_b64_tr_b16 v[34:35], v52 offset:8704
    buffer_load_dwordx4 v1, s[8:11], s63 offen offset:3072 lds
    s_waitcnt lgkmcnt(6)
    v_mfma_f32_32x32x16_bf16 v[96:111], v[36:39], v[144:147], v[96:111]
    ds_read_b64_tr_b16 v[36:37], v52 offset:9216
    ds_read_b64_tr_b16 v[38:39], v52 offset:9728
    s_add_u32 m0, s52, 105472
    s_add_u32 s63, s47, 139264
    buffer_load_dwordx4 v1, s[8:11], s63 offen offset:0 lds
    v_mfma_f32_32x32x16_bf16 v[96:111], v[20:23], v[148:151], v[96:111]
    ds_read_b64_tr_b16 v[20:21], v52 offset:10240
    ds_read_b64_tr_b16 v[22:23], v52 offset:10752
    s_waitcnt lgkmcnt(6)
    v_mfma_f32_32x32x16_bf16 v[96:111], v[24:27], v[152:155], v[96:111]
    ds_read_b64_tr_b16 v[24:25], v52 offset:11264
    ds_read_b64_tr_b16 v[26:27], v52 offset:11776
    buffer_load_dwordx4 v1, s[8:11], s63 offen offset:1024 lds
    v_mfma_f32_32x32x16_bf16 v[96:111], v[28:31], v[156:159], v[96:111]
    ds_read_b64_tr_b16 v[28:29], v52 offset:12288
    ds_read_b64_tr_b16 v[30:31], v52 offset:12800
    buffer_load_dwordx4 v1, s[8:11], s63 offen offset:2048 lds
    s_waitcnt lgkmcnt(6)
    v_mfma_f32_32x32x16_bf16 v[96:111], v[32:35], v[160:163], v[96:111]
    ds_read_b64_tr_b16 v[32:33], v52 offset:13312
    ds_read_b64_tr_b16 v[34:35], v52 offset:13824
    buffer_load_dwordx4 v1, s[8:11], s63 offen offset:3072 lds
    v_mfma_f32_32x32x16_bf16 v[96:111], v[36:39], v[164:167], v[96:111]
    ds_read_b64_tr_b16 v[36:37], v52 offset:14336
    ds_read_b64_tr_b16 v[38:39], v52 offset:14848
    s_add_u32 m0, s14, 101376
    s_add_u32 s63, s46, 135168
    buffer_load_dword v11, s[8:11], s63 offen lds
    s_waitcnt lgkmcnt(6)
    v_mfma_f32_32x32x16_bf16 v[96:111], v[20:23], v[168:171], v[96:111]
    ds_read_b64_tr_b16 v[20:21], v52 offset:15360
    ds_read_b64_tr_b16 v[22:23], v52 offset:15872
    v_mfma_f32_32x32x16_bf16 v[96:111], v[24:27], v[172:175], v[96:111]
    ds_read_b64_tr_b16 v[24:25], v52 offset:16384
    ds_read_b64_tr_b16 v[26:27], v52 offset:16896
    v_lshrrev_b32 v40, 9, v1
    s_waitcnt lgkmcnt(6)
    v_mfma_f32_32x32x16_bf16 v[96:111], v[28:31], v[176:179], v[96:111]
    ds_read_b64_tr_b16 v[28:29], v52 offset:17408
    ds_read_b64_tr_b16 v[30:31], v52 offset:17920
    v_mul_u32_u24 v40, 2176, v40
    v_and_b32 v41, 0x1f0, v1
    v_mfma_f32_32x32x16_bf16 v[96:111], v[32:35], v[180:183], v[96:111]
    ds_read_b64_tr_b16 v[32:33], v52 offset:18432
    ds_read_b64_tr_b16 v[34:35], v52 offset:18944
    v_add_u32 v40, v40, v41
    s_lshl_b32 s56, s28, 9
    s_waitcnt lgkmcnt(6)
    v_mfma_f32_32x32x16_bf16 v[96:111], v[36:39], v[184:187], v[96:111]
    ds_read_b64_tr_b16 v[36:37], v52 offset:19456
    ds_read_b64_tr_b16 v[38:39], v52 offset:19968
    v_add_u32 v40, s56, v40
    s_add_u32 s57, s56, 159744
    v_mfma_f32_32x32x16_bf16 v[96:111], v[20:23], v[188:191], v[96:111]
    ds_read_b64_tr_b16 v[20:21], v52 offset:20480
    ds_read_b64_tr_b16 v[22:23], v52 offset:20992
    v_add_u32 v43, s57, v41
    v_bfe_u32 v41, v1, 4, 4
    s_waitcnt lgkmcnt(6)
    v_mfma_f32_32x32x16_bf16 v[96:111], v[24:27], v[192:195], v[96:111]
    ds_read_b64_tr_b16 v[24:25], v52 offset:21504
    ds_read_b64_tr_b16 v[26:27], v52 offset:22016
    v_mul_u32_u24 v41, 2176, v41
    v_bfe_u32 v14, v1, 8, 1
    v_lshl_add_u32 v41, v14, 4, v41
    v_mfma_f32_32x32x16_bf16 v[96:111], v[28:31], v[196:199], v[96:111]
    ds_read_b64_tr_b16 v[28:29], v52 offset:22528
    ds_read_b64_tr_b16 v[30:31], v52 offset:23040
    s_lshl_b32 s56, s28, 5
    s_waitcnt lgkmcnt(6)
    v_mfma_f32_32x32x16_bf16 v[96:111], v[32:35], v[200:203], v[96:111]
    ds_read_b64_tr_b16 v[32:33], v52 offset:23552
    ds_read_b64_tr_b16 v[34:35], v52 offset:24064
    s_add_u32 s56, s56, 2048
    v_add_u32 v41, s56, v41
    v_and_b32 v42, 0x130, v1
    v_mov_b32 v168, 0
    v_mov_b32 v169, 0
    v_mfma_f32_32x32x16_bf16 v[96:111], v[36:39], v[204:207], v[96:111]
    ds_read_b64_tr_b16 v[36:37], v52 offset:24576
    ds_read_b64_tr_b16 v[38:39], v52 offset:25088
    v_bfe_u32 v14, v1, 6, 1
    v_lshl_add_u32 v42, v14, 7, v42
    v_mov_b32 v170, 0
    v_mov_b32 v171, 0
    s_waitcnt lgkmcnt(6)
    v_mfma_f32_32x32x16_bf16 v[96:111], v[20:23], v[208:211], v[96:111]
    ds_read_b64_tr_b16 v[20:21], v52 offset:25600
    ds_read_b64_tr_b16 v[22:23], v52 offset:26112
    v_bfe_u32 v14, v1, 7, 1
    v_lshl_add_u32 v42, v14, 6, v42
    v_mov_b32 v172, 0
    v_mov_b32 v173, 0
    v_mov_b32 v174, 0
    v_mov_b32 v175, 0
    v_mfma_f32_32x32x16_bf16 v[96:111], v[24:27], v[212:215], v[96:111]
    ds_read_b64_tr_b16 v[24:25], v52 offset:26624
    ds_read_b64_tr_b16 v[26:27], v52 offset:27136
    v_lshrrev_b32 v14, 9, v1
    v_lshl_add_u32 v42, v14, 3, v42
    v_mov_b32 v176, 0
    v_mov_b32 v177, 0
    s_waitcnt lgkmcnt(6)
    v_mfma_f32_32x32x16_bf16 v[96:111], v[28:31], v[216:219], v[96:111]
    ds_read_b64_tr_b16 v[28:29], v52 offset:27648
    ds_read_b64_tr_b16 v[30:31], v52 offset:28160
    v_add_u32 v42, s57, v42
    v_and_b32 v44, 0xf0, v1
    v_mov_b32 v178, 0
    v_mov_b32 v179, 0
    v_mov_b32 v180, 0
    v_mfma_f32_32x32x16_bf16 v[96:111], v[32:35], v[220:223], v[96:111]
    ds_read_b64_tr_b16 v[32:33], v52 offset:28672
    ds_read_b64_tr_b16 v[34:35], v52 offset:29184
    v_lshl_add_u32 v44, v14, 10, v44
    v_add_u32 v44, 159744, v44
    v_mov_b32 v181, 0
    v_mov_b32 v182, 0
    s_waitcnt lgkmcnt(6)
    v_mfma_f32_32x32x16_bf16 v[96:111], v[36:39], v[224:227], v[96:111]
    ds_read_b64_tr_b16 v[36:37], v52 offset:29696
    ds_read_b64_tr_b16 v[38:39], v52 offset:30208
    s_add_u32 s64, s51, 557056
    buffer_load_dwordx4 v[128:131], v41, s[8:11], s64 offen sc1
    v_mov_b32 v183, 0
    v_mov_b32 v184, 0
    v_mfma_f32_32x32x16_bf16 v[96:111], v[20:23], v[228:231], v[96:111]
    ds_read_b64_tr_b16 v[20:21], v52 offset:30720
    ds_read_b64_tr_b16 v[22:23], v52 offset:31232
    buffer_load_dwordx4 v[132:135], v40, s[8:11], s64 offen sc1
    v_mov_b32 v185, 0
    v_mov_b32 v186, 0
    v_mov_b32 v187, 0
    s_waitcnt lgkmcnt(6)
    v_mfma_f32_32x32x16_bf16 v[96:111], v[24:27], v[232:235], v[96:111]
    ds_read_b64_tr_b16 v[24:25], v52 offset:31744
    ds_read_b64_tr_b16 v[26:27], v52 offset:32256
    s_add_u32 s64, s51, 561408
    buffer_load_dwordx4 v[136:139], v40, s[8:11], s64 offen sc1
    v_mov_b32 v188, 0
    v_mov_b32 v189, 0
    v_mfma_f32_32x32x16_bf16 v[96:111], v[28:31], v[236:239], v[96:111]
    ds_read_b128 v[28:31], v2 offset:32768
    s_add_u32 s64, s51, 565760
    buffer_load_dwordx4 v[140:143], v40, s[8:11], s64 offen sc1
    v_mov_b32 v190, 0
    s_waitcnt lgkmcnt(5)
    v_mfma_f32_32x32x16_bf16 v[96:111], v[32:35], v[240:243], v[96:111]
    s_add_u32 s64, s51, 570112
    buffer_load_dwordx4 v[144:147], v40, s[8:11], s64 offen sc1
    v_mov_b32 v191, 0
    v_mov_b32 v192, 0
    v_mfma_f32_32x32x16_bf16 v[96:111], v[36:39], v[244:247], v[96:111]
    s_add_u32 s64, s51, 574464
    buffer_load_dwordx4 v[148:151], v40, s[8:11], s64 offen sc1
    v_mov_b32 v193, 0
    s_waitcnt lgkmcnt(1)
    v_mfma_f32_32x32x16_bf16 v[96:111], v[20:23], v[248:251], v[96:111]
    s_add_u32 s64, s51, 578816
    buffer_load_dwordx4 v[152:155], v40, s[8:11], s64 offen sc1
    v_mov_b32 v194, 0
    v_mov_b32 v195, 0
    v_mov_b32 v196, 0
    v_mfma_f32_32x32x16_bf16 v[96:111], v[24:27], v[252:255], v[96:111]
    s_add_u32 s64, s51, 583168
    buffer_load_dwordx4 v[156:159], v40, s[8:11], s64 offen sc1
    v_mov_b32 v197, 0
    s_waitcnt lgkmcnt(0)
    v_mfma_f32_32x32x16_bf16 v[96:111], v[28:31], v[16:19], v[96:111]
    s_add_u32 s64, s51, 587520
    buffer_load_dwordx4 v[160:163], v40, s[8:11], s64 offen sc1
    v_mov_b32 v198, 0
    v_mov_b32 v199, 0
    s_nop 7
    v_cvt_pk_bf16_f32 v20, v96, v97
    v_cvt_pk_bf16_f32 v21, v98, v99
    v_cvt_pk_bf16_f32 v22, v100, v101
    v_cvt_pk_bf16_f32 v23, v102, v103
    v_cvt_pk_bf16_f32 v24, v104, v105
    v_cvt_pk_bf16_f32 v25, v106, v107
    v_cvt_pk_bf16_f32 v26, v108, v109
    v_cvt_pk_bf16_f32 v27, v110, v111
    v_mfma_f32_32x32x16_bf16 v[112:127], a[240:243], v[20:23], 0
    s_nop 0
    v_mfma_f32_32x32x16_bf16 v[112:127], a[244:247], v[24:27], v[112:127]
    s_nop 11
    v_max3_f32 v14, v112, v113, v114
    v_min3_f32 v15, v112, v113, v114
    v_max3_f32 v14, v14, v115, v116
    v_min3_f32 v15, v15, v115, v116
    v_max3_f32 v14, v14, v117, v118
    v_min3_f32 v15, v15, v117, v118
    v_max3_f32 v14, v14, v119, v120
    v_min3_f32 v15, v15, v119, v120
    v_max3_f32 v14, v14, v121, v122
    v_min3_f32 v15, v15, v121, v122
    v_max3_f32 v14, v14, v123, v124
    v_min3_f32 v15, v15, v123, v124
    v_max3_f32 v14, v14, v125, v126
    v_min3_f32 v15, v15, v125, v126
    v_max_f32 v14, v14, v127
    v_min_f32 v15, v15, v127
    v_pk_mul_f32 v[14:15], v[14:15], v[58:59] op_sel:[0,0] op_sel_hi:[1,0]
    v_pk_fma_f32 v[64:65], v[112:113], v[58:59], v[14:15] op_sel:[0,0,0] op_sel_hi:[1,0,0] neg_lo:[0,0,1] neg_hi:[0,0,1]
    v_pk_fma_f32 v[66:67], v[114:115], v[58:59], v[14:15] op_sel:[0,0,0] op_sel_hi:[1,0,0] neg_lo:[0,0,1] neg_hi:[0,0,1]
    v_pk_fma_f32 v[68:69], v[116:117], v[58:59], v[14:15] op_sel:[0,0,0] op_sel_hi:[1,0,0] neg_lo:[0,0,1] neg_hi:[0,0,1]
    v_pk_fma_f32 v[70:71], v[118:119], v[58:59], v[14:15] op_sel:[0,0,0] op_sel_hi:[1,0,0] neg_lo:[0,0,1] neg_hi:[0,0,1]
    v_pk_fma_f32 v[72:73], v[120:121], v[58:59], v[14:15] op_sel:[0,0,0] op_sel_hi:[1,0,0] neg_lo:[0,0,1] neg_hi:[0,0,1]
    v_pk_fma_f32 v[74:75], v[122:123], v[58:59], v[14:15] op_sel:[0,0,0] op_sel_hi:[1,0,0] neg_lo:[0,0,1] neg_hi:[0,0,1]
    v_pk_fma_f32 v[76:77], v[124:125], v[58:59], v[14:15] op_sel:[0,0,0] op_sel_hi:[1,0,0] neg_lo:[0,0,1] neg_hi:[0,0,1]
    v_pk_fma_f32 v[78:79], v[126:127], v[58:59], v[14:15] op_sel:[0,0,0] op_sel_hi:[1,0,0] neg_lo:[0,0,1] neg_hi:[0,0,1]
    v_exp_f32 v64, v64
    v_exp_f32 v65, v65
    v_exp_f32 v66, v66
    v_exp_f32 v67, v67
    v_exp_f32 v68, v68
    v_exp_f32 v69, v69
    v_exp_f32 v70, v70
    v_exp_f32 v71, v71
    v_exp_f32 v72, v72
    v_exp_f32 v73, v73
    v_exp_f32 v74, v74
    v_exp_f32 v75, v75
    v_exp_f32 v76, v76
    v_exp_f32 v77, v77
    v_exp_f32 v78, v78
    v_exp_f32 v79, v79
    v_pk_add_f32 v[36:37], v[64:65], v[66:67] op_sel:[0,0] op_sel_hi:[1,1]
    v_pk_add_f32 v[36:37], v[36:37], v[68:69] op_sel:[0,0] op_sel_hi:[1,1]
    v_pk_add_f32 v[36:37], v[36:37], v[70:71] op_sel:[0,0] op_sel_hi:[1,1]
    v_pk_add_f32 v[36:37], v[36:37], v[72:73] op_sel:[0,0] op_sel_hi:[1,1]
    v_pk_add_f32 v[36:37], v[36:37], v[74:75] op_sel:[0,0] op_sel_hi:[1,1]
    v_pk_add_f32 v[36:37], v[36:37], v[76:77] op_sel:[0,0] op_sel_hi:[1,1]
    v_pk_add_f32 v[36:37], v[36:37], v[78:79] op_sel:[0,0] op_sel_hi:[1,1]
    v_add_f32 v36, v36, v37
    v_rcp_f32 v36, v36
    s_nop 0
    v_pk_mul_f32 v[64:65], v[64:65], v[36:37] op_sel:[0,0] op_sel_hi:[1,0]
    v_pk_mul_f32 v[66:67], v[66:67], v[36:37] op_sel:[0,0] op_sel_hi:[1,0]
    v_pk_mul_f32 v[68:69], v[68:69], v[36:37] op_sel:[0,0] op_sel_hi:[1,0]
    v_pk_mul_f32 v[70:71], v[70:71], v[36:37] op_sel:[0,0] op_sel_hi:[1,0]
    v_pk_mul_f32 v[72:73], v[72:73], v[36:37] op_sel:[0,0] op_sel_hi:[1,0]
    v_pk_mul_f32 v[74:75], v[74:75], v[36:37] op_sel:[0,0] op_sel_hi:[1,0]
    v_pk_mul_f32 v[76:77], v[76:77], v[36:37] op_sel:[0,0] op_sel_hi:[1,0]
    v_pk_mul_f32 v[78:79], v[78:79], v[36:37] op_sel:[0,0] op_sel_hi:[1,0]
    v_cvt_pk_bf16_f32 v96, v64, v65
    v_cvt_pk_bf16_f32 v97, v66, v67
    v_cvt_pk_bf16_f32 v100, v68, v69
    v_cvt_pk_bf16_f32 v101, v70, v71
    v_cvt_pk_bf16_f32 v98, v72, v73
    v_cvt_pk_bf16_f32 v99, v74, v75
    v_cvt_pk_bf16_f32 v102, v76, v77
    v_cvt_pk_bf16_f32 v103, v78, v79
    v_pk_fma_f32 v[80:81], v[112:113], v[58:59], v[14:15] op_sel:[0,0,1] op_sel_hi:[1,0,1] neg_lo:[1,0,0] neg_hi:[1,0,0]
    v_pk_fma_f32 v[82:83], v[114:115], v[58:59], v[14:15] op_sel:[0,0,1] op_sel_hi:[1,0,1] neg_lo:[1,0,0] neg_hi:[1,0,0]
    v_pk_fma_f32 v[84:85], v[116:117], v[58:59], v[14:15] op_sel:[0,0,1] op_sel_hi:[1,0,1] neg_lo:[1,0,0] neg_hi:[1,0,0]
    v_pk_fma_f32 v[86:87], v[118:119], v[58:59], v[14:15] op_sel:[0,0,1] op_sel_hi:[1,0,1] neg_lo:[1,0,0] neg_hi:[1,0,0]
    v_pk_fma_f32 v[88:89], v[120:121], v[58:59], v[14:15] op_sel:[0,0,1] op_sel_hi:[1,0,1] neg_lo:[1,0,0] neg_hi:[1,0,0]
    v_pk_fma_f32 v[90:91], v[122:123], v[58:59], v[14:15] op_sel:[0,0,1] op_sel_hi:[1,0,1] neg_lo:[1,0,0] neg_hi:[1,0,0]
    v_pk_fma_f32 v[92:93], v[124:125], v[58:59], v[14:15] op_sel:[0,0,1] op_sel_hi:[1,0,1] neg_lo:[1,0,0] neg_hi:[1,0,0]
    v_pk_fma_f32 v[94:95], v[126:127], v[58:59], v[14:15] op_sel:[0,0,1] op_sel_hi:[1,0,1] neg_lo:[1,0,0] neg_hi:[1,0,0]
    v_exp_f32 v80, v80
    v_exp_f32 v81, v81
    v_exp_f32 v82, v82
    v_exp_f32 v83, v83
    v_exp_f32 v84, v84
    v_exp_f32 v85, v85
    v_exp_f32 v86, v86
    v_exp_f32 v87, v87
    v_exp_f32 v88, v88
    v_exp_f32 v89, v89
    v_exp_f32 v90, v90
    v_exp_f32 v91, v91
    v_exp_f32 v92, v92
    v_exp_f32 v93, v93
    v_exp_f32 v94, v94
    v_exp_f32 v95, v95
    v_pk_add_f32 v[38:39], v[80:81], v[82:83] op_sel:[0,0] op_sel_hi:[1,1]
    v_pk_add_f32 v[38:39], v[38:39], v[84:85] op_sel:[0,0] op_sel_hi:[1,1]
    v_pk_add_f32 v[38:39], v[38:39], v[86:87] op_sel:[0,0] op_sel_hi:[1,1]
    v_pk_add_f32 v[38:39], v[38:39], v[88:89] op_sel:[0,0] op_sel_hi:[1,1]
    v_pk_add_f32 v[38:39], v[38:39], v[90:91] op_sel:[0,0] op_sel_hi:[1,1]
    v_pk_add_f32 v[38:39], v[38:39], v[92:93] op_sel:[0,0] op_sel_hi:[1,1]
    v_pk_add_f32 v[38:39], v[38:39], v[94:95] op_sel:[0,0] op_sel_hi:[1,1]
    v_add_f32 v38, v38, v39
    v_rcp_f32 v38, v38
    s_nop 0
    v_pk_mul_f32 v[80:81], v[80:81], v[38:39] op_sel:[0,0] op_sel_hi:[1,0]
    v_pk_mul_f32 v[82:83], v[82:83], v[38:39] op_sel:[0,0] op_sel_hi:[1,0]
    v_pk_mul_f32 v[84:85], v[84:85], v[38:39] op_sel:[0,0] op_sel_hi:[1,0]
    v_pk_mul_f32 v[86:87], v[86:87], v[38:39] op_sel:[0,0] op_sel_hi:[1,0]
    v_pk_mul_f32 v[88:89], v[88:89], v[38:39] op_sel:[0,0] op_sel_hi:[1,0]
    v_pk_mul_f32 v[90:91], v[90:91], v[38:39] op_sel:[0,0] op_sel_hi:[1,0]
    v_pk_mul_f32 v[92:93], v[92:93], v[38:39] op_sel:[0,0] op_sel_hi:[1,0]
    v_pk_mul_f32 v[94:95], v[94:95], v[38:39] op_sel:[0,0] op_sel_hi:[1,0]
    v_cvt_pk_bf16_f32 v104, v80, v81
    v_cvt_pk_bf16_f32 v105, v82, v83
    v_cvt_pk_bf16_f32 v108, v84, v85
    v_cvt_pk_bf16_f32 v109, v86, v87
    v_cvt_pk_bf16_f32 v106, v88, v89
    v_cvt_pk_bf16_f32 v107, v90, v91
    v_cvt_pk_bf16_f32 v110, v92, v93
    v_cvt_pk_bf16_f32 v111, v94, v95
    s_mov_b32 s62, 0
KV_61:
    s_waitcnt vmcnt(8)
    v_max_u32 v59, v128, v131
    s_mov_b32 exec_hi, 0
    ds_write_b128 v43, v[128:131] offset:2048
    s_mov_b64 exec, -1
    s_waitcnt vmcnt(7)
    v_mfma_f32_16x16x32_bf16 v[200:203], a[248:251], v[132:135], 0
    v_max3_u32 v59, v59, v132, v135
    s_waitcnt vmcnt(6)
    v_mfma_f32_16x16x32_bf16 v[200:203], a[248:251], v[136:139], v[200:203]
    v_max3_u32 v59, v59, v136, v139
    s_waitcnt vmcnt(5)
    v_mfma_f32_16x16x32_bf16 v[200:203], a[248:251], v[140:143], v[200:203]
    v_max3_u32 v59, v59, v140, v143
    s_waitcnt vmcnt(4)
    v_mfma_f32_16x16x32_bf16 v[200:203], a[248:251], v[144:147], v[200:203]
    v_max3_u32 v59, v59, v144, v147
    s_waitcnt vmcnt(3)
    v_mfma_f32_16x16x32_bf16 v[200:203], a[248:251], v[148:151], v[200:203]
    v_max3_u32 v59, v59, v148, v151
    s_waitcnt vmcnt(2)
    v_mfma_f32_16x16x32_bf16 v[200:203], a[248:251], v[152:155], v[200:203]
    v_max3_u32 v59, v59, v152, v155
    s_waitcnt vmcnt(1)
    v_mfma_f32_16x16x32_bf16 v[200:203], a[248:251], v[156:159], v[200:203]
    v_max3_u32 v59, v59, v156, v159
    s_waitcnt vmcnt(0)
    v_mfma_f32_16x16x32_bf16 v[200:203], a[248:251], v[160:163], v[200:203]
    v_max3_u32 v59, v59, v160, v163
    v_cmp_eq_u32 vcc, -1, v59
    s_cbranch_vccz KVOK_62
    v_max_u32 v59, v128, v131
    s_add_u32 s64, s51, 557056
    v_cmp_eq_u32 vcc, -1, v59
    s_cbranch_vccz RS_63
    s_mov_b64 exec, vcc
    buffer_load_dwordx4 v[128:131], v41, s[8:11], s64 offen sc1
    s_mov_b64 exec, -1
    RS_63:
    v_max_u32 v59, v132, v135
    s_add_u32 s64, s51, 557056
    v_cmp_eq_u32 vcc, -1, v59
    s_cbranch_vccz RS_64
    s_mov_b64 exec, vcc
    buffer_load_dwordx4 v[132:135], v40, s[8:11], s64 offen sc1
    s_mov_b64 exec, -1
    RS_64:
    v_max_u32 v59, v136, v139
    s_add_u32 s64, s51, 561408
    v_cmp_eq_u32 vcc, -1, v59
    s_cbranch_vccz RS_65
    s_mov_b64 exec, vcc
    buffer_load_dwordx4 v[136:139], v40, s[8:11], s64 offen sc1
    s_mov_b64 exec, -1
    RS_65:
    v_max_u32 v59, v140, v143
    s_add_u32 s64, s51, 565760
    v_cmp_eq_u32 vcc, -1, v59
    s_cbranch_vccz RS_66
    s_mov_b64 exec, vcc
    buffer_load_dwordx4 v[140:143], v40, s[8:11], s64 offen sc1
    s_mov_b64 exec, -1
    RS_66:
    v_max_u32 v59, v144, v147
    s_add_u32 s64, s51, 570112
    v_cmp_eq_u32 vcc, -1, v59
    s_cbranch_vccz RS_67
    s_mov_b64 exec, vcc
    buffer_load_dwordx4 v[144:147], v40, s[8:11], s64 offen sc1
    s_mov_b64 exec, -1
    RS_67:
    v_max_u32 v59, v148, v151
    s_add_u32 s64, s51, 574464
    v_cmp_eq_u32 vcc, -1, v59
    s_cbranch_vccz RS_68
    s_mov_b64 exec, vcc
    buffer_load_dwordx4 v[148:151], v40, s[8:11], s64 offen sc1
    s_mov_b64 exec, -1
    RS_68:
    v_max_u32 v59, v152, v155
    s_add_u32 s64, s51, 578816
    v_cmp_eq_u32 vcc, -1, v59
    s_cbranch_vccz RS_69
    s_mov_b64 exec, vcc
    buffer_load_dwordx4 v[152:155], v40, s[8:11], s64 offen sc1
    s_mov_b64 exec, -1
    RS_69:
    v_max_u32 v59, v156, v159
    s_add_u32 s64, s51, 583168
    v_cmp_eq_u32 vcc, -1, v59
    s_cbranch_vccz RS_70
    s_mov_b64 exec, vcc
    buffer_load_dwordx4 v[156:159], v40, s[8:11], s64 offen sc1
    s_mov_b64 exec, -1
    RS_70:
    v_max_u32 v59, v160, v163
    s_add_u32 s64, s51, 587520
    v_cmp_eq_u32 vcc, -1, v59
    s_cbranch_vccz RS_71
    s_mov_b64 exec, vcc
    buffer_load_dwordx4 v[160:163], v40, s[8:11], s64 offen sc1
    s_mov_b64 exec, -1
    RS_71:
    s_add_u32 s62, s62, 1
    s_cmp_gt_u32 s62, 0x80000
    s_cbranch_scc1 L_fail
    s_waitcnt vmcnt(0)
    s_branch KV_61
KVOK_62:
    s_nop 4
    v_cvt_pk_bf16_f32 v204, v200, v201
    v_cvt_pk_bf16_f32 v205, v202, v203
    ds_write_b64 v42, v[204:205]
    s_waitcnt lgkmcnt(0)
    s_barrier
    s_mov_b32 exec_lo, 0x0000ffff
    s_mov_b32 exec_hi, 0xffff0000
    ds_read_b128 v[184:187], v44 offset:2048
    ds_read_b128 v[188:191], v44 offset:2304
    ds_read_b128 v[192:195], v44 offset:2560
    ds_read_b128 v[196:199], v44 offset:2816
    ds_read_b128 v[168:171], v44 offset:0
    ds_read_b128 v[172:175], v44 offset:256
    ds_read_b128 v[176:179], v44 offset:512
    ds_read_b128 v[180:183], v44 offset:768
    s_mov_b64 exec, -1
    s_waitcnt lgkmcnt(7)
    v_mfma_f32_32x32x16_bf16 v[224:239], v[184:187], v[96:99], 0
    s_waitcnt lgkmcnt(6)
    v_mfma_f32_32x32x16_bf16 v[224:239], v[188:191], v[100:103], v[224:239]
    s_waitcnt lgkmcnt(5)
    v_mfma_f32_32x32x16_bf16 v[224:239], v[192:195], v[104:107], v[224:239]
    s_waitcnt lgkmcnt(4)
    v_mfma_f32_32x32x16_bf16 v[224:239], v[196:199], v[108:111], v[224:239]
    s_waitcnt lgkmcnt(3)
    v_mfma_f32_32x32x16_bf16 v[208:223], v[168:171], v[96:99], 0
    s_waitcnt lgkmcnt(2)
    v_mfma_f32_32x32x16_bf16 v[208:223], v[172:175], v[100:103], v[208:223]
    s_waitcnt lgkmcnt(1)
    v_mfma_f32_32x32x16_bf16 v[208:223], v[176:179], v[104:107], v[208:223]
    s_waitcnt lgkmcnt(0)
    v_mfma_f32_32x32x16_bf16 v[208:223], v[180:183], v[108:111], v[208:223]
    s_nop 3
    v_pk_add_f32 v[224:225], v[224:225], v[226:227] op_sel:[0,0] op_sel_hi:[1,1]
    v_pk_add_f32 v[228:229], v[228:229], v[230:231] op_sel:[0,0] op_sel_hi:[1,1]
    v_pk_add_f32 v[232:233], v[232:233], v[234:235] op_sel:[0,0] op_sel_hi:[1,1]
    v_pk_add_f32 v[236:237], v[236:237], v[238:239] op_sel:[0,0] op_sel_hi:[1,1]
    v_pk_add_f32 v[224:225], v[224:225], v[228:229] op_sel:[0,0] op_sel_hi:[1,1]
    v_pk_add_f32 v[232:233], v[232:233], v[236:237] op_sel:[0,0] op_sel_hi:[1,1]
    v_add_f32 v224, v224, v225
    v_add_f32 v232, v232, v233
    s_nop 1
    v_permlane32_swap_b32 v224, v232
    v_add_f32 v224, v224, v232
    v_add_f32 v224, 0x358637bd, v224
    v_rcp_f32 v224, v224
    s_nop 0
    v_mov_b32 v232, v224
    s_nop 1
    v_permlane32_swap_b32 v224, v232
    v_pk_mul_f32 v[208:209], v[208:209], v[224:225] op_sel:[0,0] op_sel_hi:[1,0]
    v_pk_mul_f32 v[210:211], v[210:211], v[224:225] op_sel:[0,0] op_sel_hi:[1,0]
    v_pk_mul_f32 v[212:213], v[212:213], v[224:225] op_sel:[0,0] op_sel_hi:[1,0]
    v_pk_mul_f32 v[214:215], v[214:215], v[224:225] op_sel:[0,0] op_sel_hi:[1,0]
    v_cvt_pk_bf16_f32 v40, v208, v209
    v_cvt_pk_bf16_f32 v41, v210, v211
    v_cvt_pk_bf16_f32 v42, v212, v213
    v_cvt_pk_bf16_f32 v43, v214, v215
    s_cmp_eq_u32 s12, 0
    s_cbranch_scc1 WT_72
    buffer_store_dwordx4 v[40:43], v1, s[8:11], s42 offen
RT_73:
    v_pk_mul_f32 v[216:217], v[216:217], v[232:233] op_sel:[0,0] op_sel_hi:[1,0]
    v_pk_mul_f32 v[218:219], v[218:219], v[232:233] op_sel:[0,0] op_sel_hi:[1,0]
    v_pk_mul_f32 v[220:221], v[220:221], v[232:233] op_sel:[0,0] op_sel_hi:[1,0]
    v_pk_mul_f32 v[222:223], v[222:223], v[232:233] op_sel:[0,0] op_sel_hi:[1,0]
    v_cvt_pk_bf16_f32 v44, v216, v217
    v_cvt_pk_bf16_f32 v45, v218, v219
    v_cvt_pk_bf16_f32 v46, v220, v221
    v_cvt_pk_bf16_f32 v47, v222, v223
    s_cmp_eq_u32 s12, 0
    s_cbranch_scc1 WT_74
    buffer_store_dwordx4 v[44:47], v1, s[8:11], s42 offen offset:1024
RT_75:
    v_accvgpr_read_b32 v64, a224
    v_accvgpr_read_b32 v65, a225
    v_accvgpr_read_b32 v66, a226
    v_accvgpr_read_b32 v67, a227
    v_accvgpr_read_b32 v68, a228
    v_accvgpr_read_b32 v69, a229
    v_accvgpr_read_b32 v70, a230
    v_accvgpr_read_b32 v71, a231
    v_pk_mul_f32 v[72:73], v[10:11], v[10:11] op_sel:[0,0] op_sel_hi:[0,0]
    v_pk_mul_f32 v[74:75], v[10:11], v[10:11] op_sel:[0,0] op_sel_hi:[0,0]
    v_pk_mul_f32 v[76:77], v[10:11], v[10:11] op_sel:[0,0] op_sel_hi:[0,0]
    v_pk_mul_f32 v[78:79], v[10:11], v[10:11] op_sel:[0,0] op_sel_hi:[0,0]
    v_accvgpr_read_b32 v96, a232
    v_accvgpr_read_b32 v97, a233
    v_accvgpr_read_b32 v98, a234
    v_accvgpr_read_b32 v99, a235
    v_accvgpr_read_b32 v100, a236
    v_accvgpr_read_b32 v101, a237
    v_accvgpr_read_b32 v102, a238
    v_accvgpr_read_b32 v103, a239
    v_pk_mul_f32 v[104:105], v[10:11], v[10:11] op_sel:[0,0] op_sel_hi:[0,0]
    v_pk_mul_f32 v[106:107], v[10:11], v[10:11] op_sel:[0,0] op_sel_hi:[0,0]
    v_pk_mul_f32 v[108:109], v[10:11], v[10:11] op_sel:[0,0] op_sel_hi:[0,0]
    v_pk_mul_f32 v[110:111], v[10:11], v[10:11] op_sel:[0,0] op_sel_hi:[0,0]
    v_mov_b32 v62, 8
    s_waitcnt vmcnt(0)
    s_mov_b64 exec, 1
    s_cmp_eq_u32 s12, 0
    s_cbranch_scc1 WT_76
    buffer_store_dword v62, v10, s[8:11], s38 offen
RT_77:
    s_mov_b64 exec, -1
    s_mov_b32 s62, 0
POLL_78:
    buffer_load_dword v63, v9, s[8:11], s37 offen sc1
    s_add_u32 s62, s62, 1
    s_cmp_gt_u32 s62, 0x200000
    s_cbranch_scc1 L_fail
    s_waitcnt vmcnt(0)
    v_cmp_gt_u32 vcc, 8, v63
    s_cbranch_vccnz POLL_78
    s_add_u32 s64, s43, 0
    buffer_load_dwordx4 v[192:195], v1, s[8:11], s64 offen sc1
    buffer_load_dwordx4 v[196:199], v1, s[8:11], s64 offen offset:1024 sc1
    buffer_load_dwordx4 v[200:203], v1, s[8:11], s64 offen offset:2048 sc1
    buffer_load_dwordx4 v[204:207], v1, s[8:11], s64 offen offset:3072 sc1
    s_add_u32 s64, s43, 4096
    buffer_load_dwordx4 v[208:211], v1, s[8:11], s64 offen sc1
    buffer_load_dwordx4 v[212:215], v1, s[8:11], s64 offen offset:1024 sc1
    buffer_load_dwordx4 v[216:219], v1, s[8:11], s64 offen offset:2048 sc1
    s_xor_b32 s56, s28, 1
    s_mul_i32 s56, s56, 6144
    s_add_u32 s56, s56, 135168
    v_add_u32 v16, s56, v1
    s_xor_b32 s56, s28, 2
    s_mul_i32 s56, s56, 6144
    s_add_u32 s56, s56, 137216
    v_add_u32 v17, s56, v1
    s_xor_b32 s56, s28, 3
    s_mul_i32 s56, s56, 6144
    s_add_u32 s56, s56, 139264
    v_add_u32 v18, s56, v1
    s_mul_i32 s56, s28, 6144
    s_add_u32 s56, s56, 135168
    v_add_u32 v19, s56, v1
    s_lshl_b32 s56, s28, 8
    s_add_u32 s56, s56, 159744
    v_add_u32 v14, s56, v11
    v_add_u32 v15, 159744, v11
    s_waitcnt vmcnt(6)
    v_mfma_f32_32x32x16_bf16 v[80:95], a[64:67], v[192:195], 0
    v_mfma_f32_32x32x16_bf16 v[64:79], a[60:63], v[192:195], v[64:79]
    buffer_load_dwordx4 v[220:223], v1, s[8:11], s64 offen offset:3072 sc1
    s_waitcnt vmcnt(6)
    v_mfma_f32_32x32x16_bf16 v[80:95], a[72:75], v[196:199], v[80:95]
    v_mfma_f32_32x32x16_bf16 v[64:79], a[68:71], v[196:199], v[64:79]
    s_add_u32 s64, s43, 114688
    buffer_load_dwordx4 v[224:227], v1, s[8:11], s64 offen sc1
    s_waitcnt vmcnt(6)
    v_mfma_f32_32x32x16_bf16 v[80:95], a[80:83], v[200:203], v[80:95]
    v_mfma_f32_32x32x16_bf16 v[64:79], a[76:79], v[200:203], v[64:79]
    buffer_load_dwordx4 v[228:231], v1, s[8:11], s64 offen offset:1024 sc1
    s_waitcnt vmcnt(6)
    v_mfma_f32_32x32x16_bf16 v[80:95], a[88:91], v[204:207], v[80:95]
    v_mfma_f32_32x32x16_bf16 v[64:79], a[84:87], v[204:207], v[64:79]
    buffer_load_dwordx4 v[232:235], v1, s[8:11], s64 offen offset:2048 sc1
    s_waitcnt vmcnt(6)
    v_mfma_f32_32x32x16_bf16 v[80:95], a[96:99], v[208:211], v[80:95]
    v_mfma_f32_32x32x16_bf16 v[64:79], a[92:95], v[208:211], v[64:79]
    buffer_load_dwordx4 v[236:239], v1, s[8:11], s64 offen offset:3072 sc1
    s_waitcnt vmcnt(6)
    v_mfma_f32_32x32x16_bf16 v[80:95], a[104:107], v[212:215], v[80:95]
    v_mfma_f32_32x32x16_bf16 v[64:79], a[100:103], v[212:215], v[64:79]
    s_add_u32 s64, s43, 118784
    buffer_load_dwordx4 v[240:243], v1, s[8:11], s64 offen sc1
    s_waitcnt vmcnt(6)
    v_mfma_f32_32x32x16_bf16 v[80:95], a[112:115], v[216:219], v[80:95]
    v_mfma_f32_32x32x16_bf16 v[64:79], a[108:111], v[216:219], v[64:79]
    buffer_load_dwordx4 v[244:247], v1, s[8:11], s64 offen offset:1024 sc1
    s_waitcnt vmcnt(6)
    v_mfma_f32_32x32x16_bf16 v[80:95], a[120:123], v[220:223], v[80:95]
    v_mfma_f32_32x32x16_bf16 v[64:79], a[116:119], v[220:223], v[64:79]
    buffer_load_dwordx4 v[248:251], v1, s[8:11], s64 offen offset:2048 sc1
    s_waitcnt vmcnt(6)
    v_mfma_f32_32x32x16_bf16 v[112:127], a[64:67], v[224:227], 0
    v_mfma_f32_32x32x16_bf16 v[96:111], a[60:63], v[224:227], v[96:111]
    s_nop 6
    ds_write_b128 v17, v[80:83] offset:0
    buffer_load_dwordx4 v[252:255], v1, s[8:11], s64 offen offset:3072 sc1
    s_waitcnt vmcnt(6)
    v_mfma_f32_32x32x16_bf16 v[112:127], a[72:75], v[228:231], v[112:127]
    ds_write_b128 v17, v[84:87] offset:1024
    v_mfma_f32_32x32x16_bf16 v[96:111], a[68:71], v[228:231], v[96:111]
    ds_write_b128 v18, v[88:91] offset:0
    s_waitcnt vmcnt(5)
    v_mfma_f32_32x32x16_bf16 v[112:127], a[80:83], v[232:235], v[112:127]
    ds_write_b128 v18, v[92:95] offset:1024
    v_mfma_f32_32x32x16_bf16 v[96:111], a[76:79], v[232:235], v[96:111]
    ds_write_b128 v16, v[72:75] offset:0
    s_add_u32 m0, s52, 0
    s_add_u32 s63, s47, 101376
    buffer_load_dwordx4 v1, s[8:11], s63 offen offset:0 lds
    buffer_load_dwordx4 v1, s[8:11], s63 offen offset:1024 lds
    s_waitcnt vmcnt(6)
    v_mfma_f32_32x32x16_bf16 v[112:127], a[88:91], v[236:239], v[112:127]
    ds_write_b128 v16, v[76:79] offset:1024
    v_mfma_f32_32x32x16_bf16 v[96:111], a[84:87], v[236:239], v[96:111]
    buffer_load_dwordx4 v1, s[8:11], s63 offen offset:2048 lds
    s_waitcnt vmcnt(6)
    v_mfma_f32_32x32x16_bf16 v[112:127], a[96:99], v[240:243], v[112:127]
    v_mfma_f32_32x32x16_bf16 v[96:111], a[92:95], v[240:243], v[96:111]
    buffer_load_dwordx4 v1, s[8:11], s63 offen offset:3072 lds
    s_add_u32 m0, s52, 4096
    s_add_u32 s63, s47, 105472
    buffer_load_dwordx4 v1, s[8:11], s63 offen offset:0 lds
    s_waitcnt vmcnt(7)
    v_mfma_f32_32x32x16_bf16 v[112:127], a[104:107], v[244:247], v[112:127]
    s_waitcnt lgkmcnt(0)
    s_barrier
    v_mfma_f32_32x32x16_bf16 v[96:111], a[100:103], v[244:247], v[96:111]
    ds_read_b128 v[20:23], v19 offset:0
    ds_read_b128 v[24:27], v19 offset:1024
    buffer_load_dwordx4 v1, s[8:11], s63 offen offset:1024 lds
    s_waitcnt vmcnt(7)
    v_mfma_f32_32x32x16_bf16 v[112:127], a[112:115], v[248:251], v[112:127]
    ds_read_b128 v[28:31], v19 offset:2048
    ds_read_b128 v[32:35], v19 offset:3072
    v_mfma_f32_32x32x16_bf16 v[96:111], a[108:111], v[248:251], v[96:111]
    ds_read_b128 v[36:39], v19 offset:4096
    ds_read_b128 v[40:43], v19 offset:5120
    buffer_load_dwordx4 v1, s[8:11], s63 offen offset:2048 lds
    buffer_load_dwordx4 v1, s[8:11], s63 offen offset:3072 lds
    s_waitcnt vmcnt(8)
    v_mfma_f32_32x32x16_bf16 v[112:127], a[120:123], v[252:255], v[112:127]
    v_mfma_f32_32x32x16_bf16 v[96:111], a[116:119], v[252:255], v[96:111]
    s_waitcnt lgkmcnt(0)
    s_barrier
    s_lshr_b32 s66, s2, 3
    s_lshl_b32 s66, s66, 2
    s_add_u32 s66, s66, s28
    s_lshl_b32 s66, s66, 9
    s_add_u32 s66, s66, L_p3_1-L_pc
    v_lshl_add_u32 v58, v1, 3, s66
    v_min_u32 v58, L_end-L_pc-4, v58
    s_mov_b64 exec, 15
    global_load_dword v58, v58, s[4:5]
    s_mov_b64 exec, -1
    s_add_u32 m0, s14, 0
    s_add_u32 s63, s46, 101376
    buffer_load_dword v11, s[8:11], s63 offen lds
    v_pk_add_f32 v[64:65], v[64:65], v[20:21] op_sel:[0,0] op_sel_hi:[1,1]
    v_pk_add_f32 v[66:67], v[66:67], v[22:23] op_sel:[0,0] op_sel_hi:[1,1]
    v_pk_add_f32 v[68:69], v[68:69], v[24:25] op_sel:[0,0] op_sel_hi:[1,1]
    v_pk_add_f32 v[70:71], v[70:71], v[26:27] op_sel:[0,0] op_sel_hi:[1,1]
    v_pk_add_f32 v[64:65], v[64:65], v[28:29] op_sel:[0,0] op_sel_hi:[1,1]
    v_pk_add_f32 v[66:67], v[66:67], v[30:31] op_sel:[0,0] op_sel_hi:[1,1]
    v_pk_add_f32 v[68:69], v[68:69], v[32:33] op_sel:[0,0] op_sel_hi:[1,1]
    v_pk_add_f32 v[70:71], v[70:71], v[34:35] op_sel:[0,0] op_sel_hi:[1,1]
    ds_write_b128 v17, v[112:115] offset:0
    v_pk_add_f32 v[64:65], v[64:65], v[36:37] op_sel:[0,0] op_sel_hi:[1,1]
    v_pk_add_f32 v[66:67], v[66:67], v[38:39] op_sel:[0,0] op_sel_hi:[1,1]
    v_pk_add_f32 v[68:69], v[68:69], v[40:41] op_sel:[0,0] op_sel_hi:[1,1]
    v_pk_add_f32 v[70:71], v[70:71], v[42:43] op_sel:[0,0] op_sel_hi:[1,1]
    v_cvt_pk_bf16_f32 v44, v64, v65
    v_cvt_pk_bf16_f32 v45, v66, v67
    v_cvt_pk_bf16_f32 v46, v68, v69
    ds_write_b128 v17, v[116:119] offset:1024
    v_cvt_pk_bf16_f32 v47, v70, v71
    s_add_u32 s65, s40, 0
    s_cmp_eq_u32 s12, 0
    s_cbranch_scc1 WT_79
    buffer_store_dwordx4 v[44:47], v1, s[8:11], s65 offen
RT_80:
    v_pk_add_f32 v[72:73], v[64:65], v[66:67] op_sel:[0,0] op_sel_hi:[1,1]
    v_pk_mul_f32 v[74:75], v[64:65], v[64:65] op_sel:[0,0] op_sel_hi:[1,1]
    v_pk_add_f32 v[72:73], v[72:73], v[68:69] op_sel:[0,0] op_sel_hi:[1,1]
    v_pk_fma_f32 v[74:75], v[66:67], v[66:67], v[74:75] op_sel:[0,0,0] op_sel_hi:[1,1,1]
    ds_write_b128 v18, v[120:123] offset:0
    v_pk_add_f32 v[72:73], v[72:73], v[70:71] op_sel:[0,0] op_sel_hi:[1,1]
    v_pk_fma_f32 v[74:75], v[68:69], v[68:69], v[74:75] op_sel:[0,0,0] op_sel_hi:[1,1,1]
    v_add_f32 v72, v72, v73
    v_pk_fma_f32 v[74:75], v[70:71], v[70:71], v[74:75] op_sel:[0,0,0] op_sel_hi:[1,1,1]
    v_add_f32 v74, v74, v75
    s_nop 1
    v_permlane32_swap_b32 v72, v74
    ds_write_b128 v18, v[124:127] offset:1024
    v_add_f32 v72, v72, v74
    ds_write_b32 v14, v72 offset:0
    v_lshlrev_b32 v80, 16, v44
    v_and_b32 v81, 0xffff0000, v44
    v_lshlrev_b32 v82, 16, v45
    v_and_b32 v83, 0xffff0000, v45
    ds_write_b128 v16, v[104:107] offset:0
    v_lshlrev_b32 v84, 16, v46
    v_and_b32 v85, 0xffff0000, v46
    v_lshlrev_b32 v86, 16, v47
    v_and_b32 v87, 0xffff0000, v47
    v_accvgpr_write_b32 a224, v80
    v_accvgpr_write_b32 a225, v81
    ds_write_b128 v16, v[108:111] offset:1024
    v_accvgpr_write_b32 a226, v82
    v_accvgpr_write_b32 a227, v83
    v_accvgpr_write_b32 a228, v84
    v_accvgpr_write_b32 a229, v85
    v_accvgpr_write_b32 a230, v86
    v_accvgpr_write_b32 a231, v87
    s_waitcnt lgkmcnt(0)
    s_barrier
    ds_read_b128 v[20:23], v19 offset:0
    ds_read_b128 v[24:27], v19 offset:1024
    ds_read_b128 v[28:31], v19 offset:2048
    ds_read_b128 v[32:35], v19 offset:3072
    ds_read_b128 v[36:39], v19 offset:4096
    ds_read_b128 v[40:43], v19 offset:5120
    s_waitcnt lgkmcnt(5)
    v_pk_add_f32 v[96:97], v[96:97], v[20:21] op_sel:[0,0] op_sel_hi:[1,1]
    v_pk_add_f32 v[98:99], v[98:99], v[22:23] op_sel:[0,0] op_sel_hi:[1,1]
    s_waitcnt lgkmcnt(4)
    v_pk_add_f32 v[100:101], v[100:101], v[24:25] op_sel:[0,0] op_sel_hi:[1,1]
    v_pk_add_f32 v[102:103], v[102:103], v[26:27] op_sel:[0,0] op_sel_hi:[1,1]
    s_waitcnt lgkmcnt(3)
    v_pk_add_f32 v[96:97], v[96:97], v[28:29] op_sel:[0,0] op_sel_hi:[1,1]
    v_pk_add_f32 v[98:99], v[98:99], v[30:31] op_sel:[0,0] op_sel_hi:[1,1]
    s_waitcnt lgkmcnt(2)
    v_pk_add_f32 v[100:101], v[100:101], v[32:33] op_sel:[0,0] op_sel_hi:[1,1]
    v_pk_add_f32 v[102:103], v[102:103], v[34:35] op_sel:[0,0] op_sel_hi:[1,1]
    s_waitcnt lgkmcnt(1)
    v_pk_add_f32 v[96:97], v[96:97], v[36:37] op_sel:[0,0] op_sel_hi:[1,1]
    v_pk_add_f32 v[98:99], v[98:99], v[38:39] op_sel:[0,0] op_sel_hi:[1,1]
    s_waitcnt lgkmcnt(0)
    v_pk_add_f32 v[100:101], v[100:101], v[40:41] op_sel:[0,0] op_sel_hi:[1,1]
    v_pk_add_f32 v[102:103], v[102:103], v[42:43] op_sel:[0,0] op_sel_hi:[1,1]
    v_cvt_pk_bf16_f32 v44, v96, v97
    v_cvt_pk_bf16_f32 v45, v98, v99
    v_cvt_pk_bf16_f32 v46, v100, v101
    v_cvt_pk_bf16_f32 v47, v102, v103
    s_add_u32 s65, s40, 32768
    s_cmp_eq_u32 s12, 0
    s_cbranch_scc1 WT_81
    buffer_store_dwordx4 v[44:47], v1, s[8:11], s65 offen
RT_82:
    v_pk_add_f32 v[104:105], v[96:97], v[98:99] op_sel:[0,0] op_sel_hi:[1,1]
    v_pk_mul_f32 v[106:107], v[96:97], v[96:97] op_sel:[0,0] op_sel_hi:[1,1]
    v_pk_add_f32 v[104:105], v[104:105], v[100:101] op_sel:[0,0] op_sel_hi:[1,1]
    v_pk_fma_f32 v[106:107], v[98:99], v[98:99], v[106:107] op_sel:[0,0,0] op_sel_hi:[1,1,1]
    v_pk_add_f32 v[104:105], v[104:105], v[102:103] op_sel:[0,0] op_sel_hi:[1,1]
    v_pk_fma_f32 v[106:107], v[100:101], v[100:101], v[106:107] op_sel:[0,0,0] op_sel_hi:[1,1,1]
    v_add_f32 v104, v104, v105
    v_pk_fma_f32 v[106:107], v[102:103], v[102:103], v[106:107] op_sel:[0,0,0] op_sel_hi:[1,1,1]
    v_add_f32 v106, v106, v107
    s_nop 1
    v_permlane32_swap_b32 v104, v106
    v_add_f32 v104, v104, v106
    ds_write_b32 v14, v104 offset:1024
    v_lshlrev_b32 v112, 16, v44
    v_and_b32 v113, 0xffff0000, v44
    v_lshlrev_b32 v114, 16, v45
    v_and_b32 v115, 0xffff0000, v45
    v_lshlrev_b32 v116, 16, v46
    v_and_b32 v117, 0xffff0000, v46
    v_lshlrev_b32 v118, 16, v47
    v_and_b32 v119, 0xffff0000, v47
    s_waitcnt lgkmcnt(0)
    s_barrier
    ds_read2st64_b32 v[48:49], v15 offset0:0 offset1:1
    ds_read2st64_b32 v[50:51], v15 offset0:2 offset1:3
    ds_read2st64_b32 v[52:53], v15 offset0:4 offset1:5
    ds_read2st64_b32 v[54:55], v15 offset0:6 offset1:7
    v_accvgpr_write_b32 a232, v112
    v_accvgpr_write_b32 a233, v113
    v_accvgpr_write_b32 a234, v114
    v_accvgpr_write_b32 a235, v115
    v_accvgpr_write_b32 a236, v116
    v_accvgpr_write_b32 a237, v117
    v_accvgpr_write_b32 a238, v118
    v_accvgpr_write_b32 a239, v119
    v_mov_b32 v62, 9
    s_waitcnt vmcnt(0)
    s_mov_b64 exec, 1
    s_cmp_eq_u32 s12, 0
    s_cbranch_scc1 WT_83
    buffer_store_dword v62, v10, s[8:11], s38 offen
RT_84:
    s_mov_b64 exec, -1
    s_waitcnt lgkmcnt(2)
    v_pk_add_f32 v[48:49], v[48:49], v[50:51] op_sel:[0,0] op_sel_hi:[1,1]
    v_add_f32 v48, v48, v49
    s_add_u32 s65, s41, 0
    s_mov_b64 exec, s[54:55]
    s_cmp_eq_u32 s12, 0
    s_cbranch_scc1 WT_85
    buffer_store_dword v48, v1, s[8:11], s65 offen
RT_86:
    s_mov_b64 exec, -1
    s_waitcnt lgkmcnt(0)
    v_pk_add_f32 v[52:53], v[52:53], v[54:55] op_sel:[0,0] op_sel_hi:[1,1]
    v_add_f32 v52, v52, v53
    s_add_u32 s65, s41, 2048
    s_mov_b64 exec, s[54:55]
    s_cmp_eq_u32 s12, 0
    s_cbranch_scc1 WT_87
    buffer_store_dword v52, v1, s[8:11], s65 offen
RT_88:
    s_mov_b64 exec, -1
L_p3_1:
    s_barrier
    ds_read_b128 v[20:23], v3 offset:0
    ds_read_b128 v[24:27], v4 offset:0
    ds_read_b128 v[28:31], v3 offset:1024
    ds_read_b128 v[32:35], v4 offset:1024
    ds_read_b128 v[36:39], v3 offset:2048
    s_mov_b32 s62, 0
POLL_93:
    buffer_load_dword v63, v8, s[8:11], s37 offen sc1
    s_add_u32 s62, s62, 1
    s_cmp_gt_u32 s62, 0x200000
    s_cbranch_scc1 L_fail
    s_waitcnt vmcnt(0)
    v_cmp_gt_u32 vcc, 9, v63
    s_cbranch_vccnz POLL_93
    s_add_u32 s64, s39, 0
    buffer_load_dwordx4 v[128:131], v1, s[8:11], s64 offen sc1
    buffer_load_dwordx4 v[132:135], v1, s[8:11], s64 offen offset:1024 sc1
    buffer_load_dwordx4 v[136:139], v1, s[8:11], s64 offen offset:2048 sc1
    buffer_load_dwordx4 v[140:143], v1, s[8:11], s64 offen offset:3072 sc1
    s_add_u32 s64, s39, 4096
    buffer_load_dwordx4 v[144:147], v1, s[8:11], s64 offen sc1
    buffer_load_dwordx4 v[148:151], v1, s[8:11], s64 offen offset:1024 sc1
    buffer_load_dwordx4 v[152:155], v1, s[8:11], s64 offen offset:2048 sc1
    v_mov_b32 v62, 10
    s_mov_b64 exec, 1
    s_cmp_eq_u32 s12, 0
    s_cbranch_scc1 WT_89
    buffer_store_dword v62, v10, s[8:11], s38 offen
RT_90:
    s_mov_b64 exec, -1
    s_waitcnt vmcnt(7) lgkmcnt(4)
    v_mfma_f32_32x32x16_bf16 v[64:79], v[20:23], v[128:131], 0
    ds_read_b128 v[20:23], v4 offset:2048
    buffer_load_dwordx4 v[156:159], v1, s[8:11], s64 offen offset:3072 sc1
    s_waitcnt lgkmcnt(4)
    v_mfma_f32_32x32x16_bf16 v[80:95], v[24:27], v[128:131], 0
    ds_read_b128 v[24:27], v3 offset:3072
    s_waitcnt vmcnt(7) lgkmcnt(3)
    v_mfma_f32_32x32x16_bf16 v[64:79], v[28:31], v[132:135], v[64:79]
    ds_read_b128 v[28:31], v4 offset:3072
    s_add_u32 s64, s39, 8192
    buffer_load_dwordx4 v[160:163], v1, s[8:11], s64 offen sc1
    v_mfma_f32_32x32x16_bf16 v[80:95], v[32:35], v[132:135], v[80:95]
    ds_read_b128 v[32:35], v3 offset:4096
    s_waitcnt vmcnt(7) lgkmcnt(3)
    v_mfma_f32_32x32x16_bf16 v[64:79], v[36:39], v[136:139], v[64:79]
    ds_read_b128 v[36:39], v4 offset:4096
    buffer_load_dwordx4 v[164:167], v1, s[8:11], s64 offen offset:1024 sc1
    v_mfma_f32_32x32x16_bf16 v[80:95], v[20:23], v[136:139], v[80:95]
    ds_read_b128 v[20:23], v3 offset:5120
    s_waitcnt vmcnt(7) lgkmcnt(3)
    v_mfma_f32_32x32x16_bf16 v[64:79], v[24:27], v[140:143], v[64:79]
    ds_read_b128 v[24:27], v4 offset:5120
    buffer_load_dwordx4 v[168:171], v1, s[8:11], s64 offen offset:2048 sc1
    v_mfma_f32_32x32x16_bf16 v[80:95], v[28:31], v[140:143], v[80:95]
    ds_read_b128 v[28:31], v3 offset:6144
    s_waitcnt vmcnt(7) lgkmcnt(3)
    v_mfma_f32_32x32x16_bf16 v[64:79], v[32:35], v[144:147], v[64:79]
    ds_read_b128 v[32:35], v4 offset:6144
    buffer_load_dwordx4 v[172:175], v1, s[8:11], s64 offen offset:3072 sc1
    v_mfma_f32_32x32x16_bf16 v[80:95], v[36:39], v[144:147], v[80:95]
    ds_read_b128 v[36:39], v3 offset:7168
    s_waitcnt vmcnt(7) lgkmcnt(3)
    v_mfma_f32_32x32x16_bf16 v[64:79], v[20:23], v[148:151], v[64:79]
    ds_read_b128 v[20:23], v4 offset:7168
    s_add_u32 s64, s39, 12288
    buffer_load_dwordx4 v[176:179], v1, s[8:11], s64 offen sc1
    v_mfma_f32_32x32x16_bf16 v[80:95], v[24:27], v[148:151], v[80:95]
    ds_read_b128 v[24:27], v3 offset:8192
    s_waitcnt vmcnt(7) lgkmcnt(3)
    v_mfma_f32_32x32x16_bf16 v[64:79], v[28:31], v[152:155], v[64:79]
    ds_read_b128 v[28:31], v4 offset:8192
    buffer_load_dwordx4 v[180:183], v1, s[8:11], s64 offen offset:1024 sc1
    v_mfma_f32_32x32x16_bf16 v[80:95], v[32:35], v[152:155], v[80:95]
    ds_read_b128 v[32:35], v3 offset:9216
    s_waitcnt vmcnt(6) lgkmcnt(3)
    v_mfma_f32_32x32x16_bf16 v[64:79], v[36:39], v[156:159], v[64:79]
    ds_read_b128 v[36:39], v4 offset:9216
    buffer_load_dwordx4 v[184:187], v1, s[8:11], s64 offen offset:2048 sc1
    buffer_load_dword v63, v8, s[8:11], s37 offen sc1
    v_mfma_f32_32x32x16_bf16 v[80:95], v[20:23], v[156:159], v[80:95]
    ds_read_b128 v[20:23], v3 offset:10240
    s_waitcnt vmcnt(7) lgkmcnt(3)
    v_mfma_f32_32x32x16_bf16 v[64:79], v[24:27], v[160:163], v[64:79]
    ds_read_b128 v[24:27], v4 offset:10240
    buffer_load_dwordx4 v[188:191], v1, s[8:11], s64 offen offset:3072 sc1
    v_mfma_f32_32x32x16_bf16 v[80:95], v[28:31], v[160:163], v[80:95]
    ds_read_b128 v[28:31], v3 offset:11264
    s_waitcnt vmcnt(7) lgkmcnt(3)
    v_mfma_f32_32x32x16_bf16 v[64:79], v[32:35], v[164:167], v[64:79]
    ds_read_b128 v[32:35], v4 offset:11264
    s_add_u32 s64, s39, 16384
    buffer_load_dwordx4 v[192:195], v1, s[8:11], s64 offen sc1
    v_mfma_f32_32x32x16_bf16 v[80:95], v[36:39], v[164:167], v[80:95]
    ds_read_b128 v[36:39], v3 offset:12288
    s_waitcnt vmcnt(7) lgkmcnt(3)
    v_mfma_f32_32x32x16_bf16 v[64:79], v[20:23], v[168:171], v[64:79]
    ds_read_b128 v[20:23], v4 offset:12288
    buffer_load_dwordx4 v[196:199], v1, s[8:11], s64 offen offset:1024 sc1
    v_mfma_f32_32x32x16_bf16 v[80:95], v[24:27], v[168:171], v[80:95]
    ds_read_b128 v[24:27], v3 offset:13312
    s_waitcnt vmcnt(7) lgkmcnt(3)
    v_mfma_f32_32x32x16_bf16 v[64:79], v[28:31], v[172:175], v[64:79]
    ds_read_b128 v[28:31], v4 offset:13312
    buffer_load_dwordx4 v[200:203], v1, s[8:11], s64 offen offset:2048 sc1
    v_mfma_f32_32x32x16_bf16 v[80:95], v[32:35], v[172:175], v[80:95]
    ds_read_b128 v[32:35], v3 offset:14336
    s_waitcnt vmcnt(7) lgkmcnt(3)
    v_mfma_f32_32x32x16_bf16 v[64:79], v[36:39], v[176:179], v[64:79]
    ds_read_b128 v[36:39], v4 offset:14336
    buffer_load_dwordx4 v[204:207], v1, s[8:11], s64 offen offset:3072 sc1
    v_mfma_f32_32x32x16_bf16 v[80:95], v[20:23], v[176:179], v[80:95]
    ds_read_b128 v[20:23], v3 offset:15360
    s_waitcnt vmcnt(7) lgkmcnt(3)
    v_mfma_f32_32x32x16_bf16 v[64:79], v[24:27], v[180:183], v[64:79]
    ds_read_b128 v[24:27], v4 offset:15360
    s_add_u32 s64, s39, 20480
    buffer_load_dwordx4 v[208:211], v1, s[8:11], s64 offen sc1
    v_mfma_f32_32x32x16_bf16 v[80:95], v[28:31], v[180:183], v[80:95]
    ds_read_b128 v[28:31], v3 offset:16384
    s_waitcnt vmcnt(7) lgkmcnt(3)
    v_mfma_f32_32x32x16_bf16 v[64:79], v[32:35], v[184:187], v[64:79]
    ds_read_b128 v[32:35], v4 offset:16384
    buffer_load_dwordx4 v[212:215], v1, s[8:11], s64 offen offset:1024 sc1
    s_waitcnt vmcnt(7)
    v_cmp_gt_u32 vcc, 10, v63
    s_cbranch_vccz OK_94
    s_mov_b32 s62, 0
    SP_95:
    buffer_load_dword v63, v8, s[8:11], s37 offen sc1
    s_add_u32 s62, s62, 1
    s_cmp_gt_u32 s62, 0x200000
    s_cbranch_scc1 L_fail
    s_waitcnt vmcnt(0)
    v_cmp_gt_u32 vcc, 10, v63
    s_cbranch_vccnz SP_95
    OK_94:
    v_mfma_f32_32x32x16_bf16 v[80:95], v[36:39], v[184:187], v[80:95]
    ds_read_b128 v[36:39], v3 offset:17408
    s_lshr_b32 s65, s39, 4
    s_add_u32 s65, s65, 6918144
    buffer_load_dwordx4 v[52:55], v1, s[8:11], s65 offen sc1
    s_waitcnt vmcnt(7) lgkmcnt(3)
    v_mfma_f32_32x32x16_bf16 v[64:79], v[20:23], v[188:191], v[64:79]
    ds_read_b128 v[20:23], v4 offset:17408
    buffer_load_dwordx4 v[216:219], v1, s[8:11], s64 offen offset:2048 sc1
    v_mfma_f32_32x32x16_bf16 v[80:95], v[24:27], v[188:191], v[80:95]
    ds_read_b128 v[24:27], v3 offset:18432
    buffer_load_dwordx4 v[56:59], v1, s[8:11], s65 offen offset:1024 sc1
    s_waitcnt vmcnt(8) lgkmcnt(3)
    v_mfma_f32_32x32x16_bf16 v[64:79], v[28:31], v[192:195], v[64:79]
    ds_read_b128 v[28:31], v4 offset:18432
    buffer_load_dwordx4 v[220:223], v1, s[8:11], s64 offen offset:3072 sc1
    v_mfma_f32_32x32x16_bf16 v[80:95], v[32:35], v[192:195], v[80:95]
    ds_read_b128 v[32:35], v3 offset:19456
    s_waitcnt vmcnt(8) lgkmcnt(3)
    v_mfma_f32_32x32x16_bf16 v[64:79], v[36:39], v[196:199], v[64:79]
    ds_read_b128 v[36:39], v4 offset:19456
    s_add_u32 s64, s39, 24576
    buffer_load_dwordx4 v[224:227], v1, s[8:11], s64 offen sc1
    v_mfma_f32_32x32x16_bf16 v[80:95], v[20:23], v[196:199], v[80:95]
    ds_read_b128 v[20:23], v3 offset:20480
    s_waitcnt vmcnt(8) lgkmcnt(3)
    v_mfma_f32_32x32x16_bf16 v[64:79], v[24:27], v[200:203], v[64:79]
    ds_read_b128 v[24:27], v4 offset:20480
    buffer_load_dwordx4 v[228:231], v1, s[8:11], s64 offen offset:1024 sc1
    v_mfma_f32_32x32x16_bf16 v[80:95], v[28:31], v[200:203], v[80:95]
    ds_read_b128 v[28:31], v3 offset:21504
    s_waitcnt vmcnt(8) lgkmcnt(3)
    v_mfma_f32_32x32x16_bf16 v[64:79], v[32:35], v[204:207], v[64:79]
    ds_read_b128 v[32:35], v4 offset:21504
    buffer_load_dwordx4 v[232:235], v1, s[8:11], s64 offen offset:2048 sc1
    v_mfma_f32_32x32x16_bf16 v[80:95], v[36:39], v[204:207], v[80:95]
    ds_read_b128 v[36:39], v3 offset:22528
    s_waitcnt vmcnt(8) lgkmcnt(3)
    v_mfma_f32_32x32x16_bf16 v[64:79], v[20:23], v[208:211], v[64:79]
    ds_read_b128 v[20:23], v4 offset:22528
    buffer_load_dwordx4 v[236:239], v1, s[8:11], s64 offen offset:3072 sc1
    v_mfma_f32_32x32x16_bf16 v[80:95], v[24:27], v[208:211], v[80:95]
    ds_read_b128 v[24:27], v3 offset:23552
    s_waitcnt vmcnt(8) lgkmcnt(3)
    v_mfma_f32_32x32x16_bf16 v[64:79], v[28:31], v[212:215], v[64:79]
    ds_read_b128 v[28:31], v4 offset:23552
    s_add_u32 s64, s39, 28672
    buffer_load_dwordx4 v[240:243], v1, s[8:11], s64 offen sc1
    v_mfma_f32_32x32x16_bf16 v[80:95], v[32:35], v[212:215], v[80:95]
    ds_read_b128 v[32:35], v3 offset:24576
    s_waitcnt vmcnt(7) lgkmcnt(3)
    v_mfma_f32_32x32x16_bf16 v[64:79], v[36:39], v[216:219], v[64:79]
    ds_read_b128 v[36:39], v4 offset:24576
    buffer_load_dwordx4 v[244:247], v1, s[8:11], s64 offen offset:1024 sc1
    v_mfma_f32_32x32x16_bf16 v[80:95], v[20:23], v[216:219], v[80:95]
    ds_read_b128 v[20:23], v3 offset:25600
    s_waitcnt vmcnt(6) lgkmcnt(3)
    v_mfma_f32_32x32x16_bf16 v[64:79], v[24:27], v[220:223], v[64:79]
    ds_read_b128 v[24:27], v4 offset:25600
    buffer_load_dwordx4 v[248:251], v1, s[8:11], s64 offen offset:2048 sc1
    v_mfma_f32_32x32x16_bf16 v[80:95], v[28:31], v[220:223], v[80:95]
    ds_read_b128 v[28:31], v3 offset:26624
    s_waitcnt vmcnt(6) lgkmcnt(3)
    v_mfma_f32_32x32x16_bf16 v[64:79], v[32:35], v[224:227], v[64:79]
    ds_read_b128 v[32:35], v4 offset:26624
    buffer_load_dwordx4 v[252:255], v1, s[8:11], s64 offen offset:3072 sc1
    v_mfma_f32_32x32x16_bf16 v[80:95], v[36:39], v[224:227], v[80:95]
    ds_read_b128 v[36:39], v3 offset:27648
    v_pk_add_f32 v[52:53], v[52:53], v[54:55] op_sel:[0,0] op_sel_hi:[1,1]
    s_waitcnt vmcnt(6) lgkmcnt(3)
    v_mfma_f32_32x32x16_bf16 v[64:79], v[20:23], v[228:231], v[64:79]
    ds_read_b128 v[20:23], v4 offset:27648
    v_pk_add_f32 v[56:57], v[56:57], v[58:59] op_sel:[0,0] op_sel_hi:[1,1]
    v_pk_add_f32 v[52:53], v[52:53], v[56:57] op_sel:[0,0] op_sel_hi:[1,1]
    v_add_f32 v52, v52, v53
    v_mfma_f32_32x32x16_bf16 v[80:95], v[24:27], v[228:231], v[80:95]
    ds_read_b128 v[24:27], v3 offset:28672
    v_mov_b32 v53, v52
    s_waitcnt vmcnt(5) lgkmcnt(3)
    v_mfma_f32_32x32x16_bf16 v[64:79], v[28:31], v[232:235], v[64:79]
    ds_read_b128 v[28:31], v4 offset:28672
    v_permlane32_swap_b32 v52, v53
    v_mfma_f32_32x32x16_bf16 v[80:95], v[32:35], v[232:235], v[80:95]
    ds_read_b128 v[32:35], v3 offset:29696
    v_mul_f32 v52, 0xbb000000, v52
    v_mul_f32 v53, 0x3b000000, v53
    s_waitcnt vmcnt(4) lgkmcnt(3)
    v_mfma_f32_32x32x16_bf16 v[64:79], v[36:39], v[236:239], v[64:79]
    ds_read_b128 v[36:39], v4 offset:29696
    v_fma_f32 v53, -v52, v52, v53
    v_cvt_pk_bf16_f32 v16, v52, v52
    v_mfma_f32_32x32x16_bf16 v[80:95], v[20:23], v[236:239], v[80:95]
    ds_read_b128 v[20:23], v3 offset:30720
    v_max_f32 v53, 0, v53
    v_cvt_pk_bf16_f32 v17, v52, v52
    s_waitcnt vmcnt(3) lgkmcnt(3)
    v_mfma_f32_32x32x16_bf16 v[64:79], v[24:27], v[240:243], v[64:79]
    ds_read_b128 v[24:27], v4 offset:30720
    v_add_f32 v53, 0x3727c5ac, v53
    v_cvt_pk_bf16_f32 v18, v52, v52
    v_mfma_f32_32x32x16_bf16 v[80:95], v[28:31], v[240:243], v[80:95]
    ds_read_b128 v[28:31], v3 offset:32768
    v_rsq_f32 v12, v53
    s_waitcnt vmcnt(2) lgkmcnt(3)
    v_mfma_f32_32x32x16_bf16 v[64:79], v[32:35], v[244:247], v[64:79]
    ds_read_b128 v[32:35], v4 offset:32768
    v_cvt_pk_bf16_f32 v19, v52, v52
    v_mul_f32 v13, v53, v12
    v_mfma_f32_32x32x16_bf16 v[80:95], v[36:39], v[244:247], v[80:95]
    ds_read_b128 v[36:39], v3 offset:31744
    v_mul_f32 v12, 0xbfb8aa3b, v12
    s_waitcnt vmcnt(1) lgkmcnt(3)
    v_mfma_f32_32x32x16_bf16 v[64:79], v[20:23], v[248:251], v[64:79]
    ds_read_b128 v[20:23], v4 offset:31744
    v_mfma_f32_32x32x16_bf16 v[80:95], v[24:27], v[248:251], v[80:95]
    ds_read_b128 v[24:27], v5 offset:0
    s_waitcnt lgkmcnt(3)
    v_mfma_f32_32x32x16_bf16 v[64:79], v[28:31], v[16:19], v[64:79]
    ds_read_b128 v[28:31], v5 offset:1024
    v_mfma_f32_32x32x16_bf16 v[80:95], v[32:35], v[16:19], v[80:95]
    ds_read_b128 v[32:35], v5 offset:2048
    s_waitcnt vmcnt(0) lgkmcnt(3)
    v_mfma_f32_32x32x16_bf16 v[64:79], v[36:39], v[252:255], v[64:79]
    ds_read_b128 v[36:39], v5 offset:3072
    v_mfma_f32_32x32x16_bf16 v[80:95], v[20:23], v[252:255], v[80:95]
    ds_read_b128 v[20:23], v5 offset:4096
    s_waitcnt lgkmcnt(3)
    v_mfma_f32_32x32x16_bf16 v[96:111], v[24:27], v[128:131], 0
    ds_read_b128 v[24:27], v5 offset:5120
    s_barrier
    v_mfma_f32_32x32x16_bf16 v[96:111], v[28:31], v[132:135], v[96:111]
    ds_read_b128 v[28:31], v5 offset:6144
    s_add_u32 m0, s52, 33792
    s_add_u32 s63, s47, 67584
    buffer_load_dwordx4 v1, s[8:11], s63 offen offset:0 lds
    s_waitcnt lgkmcnt(3)
    v_mfma_f32_32x32x16_bf16 v[96:111], v[32:35], v[136:139], v[96:111]
    ds_read_b128 v[32:35], v5 offset:7168
    v_mfma_f32_32x32x16_bf16 v[96:111], v[36:39], v[140:143], v[96:111]
    ds_read_b128 v[36:39], v5 offset:8192
    v_mul_f32 v44, v64, v12
    v_mul_f32 v45, v65, v12
    v_exp_f32 v44, v44
    v_mul_f32 v46, v66, v12
    s_waitcnt lgkmcnt(3)
    v_mfma_f32_32x32x16_bf16 v[96:111], v[20:23], v[144:147], v[96:111]
    ds_read_b128 v[20:23], v5 offset:9216
    buffer_load_dwordx4 v1, s[8:11], s63 offen offset:1024 lds
    v_exp_f32 v45, v45
    v_fma_f32 v44, v44, v13, v13
    v_mfma_f32_32x32x16_bf16 v[96:111], v[24:27], v[148:151], v[96:111]
    ds_read_b128 v[24:27], v5 offset:10240
    v_mul_f32 v47, v67, v12
    v_exp_f32 v46, v46
    v_fma_f32 v45, v45, v13, v13
    v_rcp_f32 v44, v44
    s_waitcnt lgkmcnt(3)
    v_mfma_f32_32x32x16_bf16 v[96:111], v[28:31], v[152:155], v[96:111]
    ds_read_b128 v[28:31], v5 offset:11264
    v_mul_f32 v48, v68, v12
    v_exp_f32 v47, v47
    v_fma_f32 v46, v46, v13, v13
    v_mfma_f32_32x32x16_bf16 v[96:111], v[32:35], v[156:159], v[96:111]
    ds_read_b128 v[32:35], v5 offset:12288
    buffer_load_dwordx4 v1, s[8:11], s63 offen offset:2048 lds
    v_rcp_f32 v45, v45
    v_mul_f32 v44, v44, v72
    v_mul_f32 v49, v69, v12
    s_waitcnt lgkmcnt(3)
    v_mfma_f32_32x32x16_bf16 v[96:111], v[36:39], v[160:163], v[96:111]
    ds_read_b128 v[36:39], v5 offset:13312
    v_exp_f32 v48, v48
    v_fma_f32 v47, v47, v13, v13
    v_rcp_f32 v46, v46
    v_mfma_f32_32x32x16_bf16 v[96:111], v[20:23], v[164:167], v[96:111]
    ds_read_b128 v[20:23], v5 offset:14336
    v_mul_f32 v45, v45, v73
    v_mul_f32 v50, v70, v12
    v_exp_f32 v49, v49
    v_fma_f32 v48, v48, v13, v13
    s_waitcnt lgkmcnt(3)
    v_mfma_f32_32x32x16_bf16 v[96:111], v[24:27], v[168:171], v[96:111]
    ds_read_b128 v[24:27], v5 offset:15360
    v_rcp_f32 v47, v47
    v_mul_f32 v46, v46, v74
    v_cvt_pk_bf16_f32 v40, v44, v45
    v_mul_f32 v51, v71, v12
    v_mfma_f32_32x32x16_bf16 v[96:111], v[28:31], v[172:175], v[96:111]
    ds_read_b128 v[28:31], v5 offset:16384
    buffer_load_dwordx4 v1, s[8:11], s63 offen offset:3072 lds
    v_exp_f32 v50, v50
    v_fma_f32 v49, v49, v13, v13
    s_waitcnt lgkmcnt(3)
    v_mfma_f32_32x32x16_bf16 v[96:111], v[32:35], v[176:179], v[96:111]
    ds_read_b128 v[32:35], v5 offset:17408
    v_rcp_f32 v48, v48
    v_mul_f32 v47, v47, v75
    v_exp_f32 v51, v51
    v_fma_f32 v50, v50, v13, v13
    v_mfma_f32_32x32x16_bf16 v[96:111], v[36:39], v[180:183], v[96:111]
    ds_read_b128 v[36:39], v5 offset:18432
    v_rcp_f32 v49, v49
    v_mul_f32 v48, v48, v76
    v_cvt_pk_bf16_f32 v41, v46, v47
    v_fma_f32 v51, v51, v13, v13
    s_waitcnt lgkmcnt(3)
    v_mfma_f32_32x32x16_bf16 v[96:111], v[20:23], v[184:187], v[96:111]
    ds_read_b128 v[20:23], v5 offset:19456
    s_add_u32 m0, s52, 37888
    s_add_u32 s63, s47, 71680
    buffer_load_dwordx4 v1, s[8:11], s63 offen offset:0 lds
    v_rcp_f32 v50, v50
    v_mfma_f32_32x32x16_bf16 v[96:111], v[24:27], v[188:191], v[96:111]
    ds_read_b128 v[24:27], v5 offset:20480
    v_mul_f32 v49, v49, v77
    v_rcp_f32 v51, v51
    v_mul_f32 v50, v50, v78
    s_waitcnt lgkmcnt(3)
    v_mfma_f32_32x32x16_bf16 v[96:111], v[28:31], v[192:195], v[96:111]
    ds_read_b128 v[28:31], v5 offset:21504
    v_cvt_pk_bf16_f32 v42, v48, v49
    v_mul_f32 v51, v51, v79
    v_cvt_pk_bf16_f32 v43, v50, v51
    s_add_u32 s65, s44, 6144
    buffer_store_dwordx4 v[40:43], v1, s[8:11], s65 offen sc1
    v_mfma_f32_32x32x16_bf16 v[96:111], v[32:35], v[196:199], v[96:111]
    ds_read_b128 v[32:35], v5 offset:22528
    v_mul_f32 v44, v80, v12
    v_mul_f32 v45, v81, v12
    v_exp_f32 v44, v44
    s_waitcnt lgkmcnt(3)
    v_mfma_f32_32x32x16_bf16 v[96:111], v[36:39], v[200:203], v[96:111]
    ds_read_b128 v[36:39], v5 offset:23552
    buffer_load_dwordx4 v1, s[8:11], s63 offen offset:1024 lds
    v_mul_f32 v46, v82, v12
    v_exp_f32 v45, v45
    v_fma_f32 v44, v44, v13, v13
    v_mfma_f32_32x32x16_bf16 v[96:111], v[20:23], v[204:207], v[96:111]
    ds_read_b128 v[20:23], v5 offset:24576
    v_mul_f32 v47, v83, v12
    v_exp_f32 v46, v46
    v_fma_f32 v45, v45, v13, v13
    s_waitcnt lgkmcnt(3)
    v_mfma_f32_32x32x16_bf16 v[96:111], v[24:27], v[208:211], v[96:111]
    ds_read_b128 v[24:27], v5 offset:25600
    v_rcp_f32 v44, v44
    v_mul_f32 v48, v84, v12
    v_exp_f32 v47, v47
    v_fma_f32 v46, v46, v13, v13
    v_mfma_f32_32x32x16_bf16 v[96:111], v[28:31], v[212:215], v[96:111]
    ds_read_b128 v[28:31], v5 offset:26624
    buffer_load_dwordx4 v1, s[8:11], s63 offen offset:2048 lds
    v_rcp_f32 v45, v45
    v_mul_f32 v44, v44, v88
    s_waitcnt lgkmcnt(3)
    v_mfma_f32_32x32x16_bf16 v[96:111], v[32:35], v[216:219], v[96:111]
    ds_read_b128 v[32:35], v5 offset:27648
    v_mul_f32 v49, v85, v12
    v_exp_f32 v48, v48
    v_fma_f32 v47, v47, v13, v13
    v_rcp_f32 v46, v46
    v_mfma_f32_32x32x16_bf16 v[96:111], v[36:39], v[220:223], v[96:111]
    ds_read_b128 v[36:39], v5 offset:28672
    v_mul_f32 v45, v45, v89
    v_mul_f32 v50, v86, v12
    v_exp_f32 v49, v49
    s_waitcnt lgkmcnt(3)
    v_mfma_f32_32x32x16_bf16 v[96:111], v[20:23], v[224:227], v[96:111]
    ds_read_b128 v[20:23], v5 offset:29696
    v_fma_f32 v48, v48, v13, v13
    v_rcp_f32 v47, v47
    v_mul_f32 v46, v46, v90
    v_cvt_pk_bf16_f32 v40, v44, v45
    v_mul_f32 v51, v87, v12
    v_mfma_f32_32x32x16_bf16 v[96:111], v[24:27], v[228:231], v[96:111]
    ds_read_b128 v[24:27], v5 offset:30720
    buffer_load_dwordx4 v1, s[8:11], s63 offen offset:3072 lds
    v_exp_f32 v50, v50
    v_fma_f32 v49, v49, v13, v13
    s_waitcnt lgkmcnt(3)
    v_mfma_f32_32x32x16_bf16 v[96:111], v[28:31], v[232:235], v[96:111]
    ds_read_b128 v[28:31], v5 offset:31744
    v_rcp_f32 v48, v48
    v_mul_f32 v47, v47, v91
    v_exp_f32 v51, v51
    v_mfma_f32_32x32x16_bf16 v[96:111], v[32:35], v[236:239], v[96:111]
    ds_read_b128 v[32:35], v5 offset:32768
    s_barrier
    v_fma_f32 v50, v50, v13, v13
    v_rcp_f32 v49, v49
    s_waitcnt lgkmcnt(3)
    v_mfma_f32_32x32x16_bf16 v[96:111], v[36:39], v[240:243], v[96:111]
    ds_read_b128 v[36:39], v2 offset:0
    s_add_u32 m0, s14, 33792
    s_add_u32 s63, s46, 67584
    buffer_load_dword v11, s[8:11], s63 offen lds
    v_mul_f32 v48, v48, v92
    v_mfma_f32_32x32x16_bf16 v[96:111], v[20:23], v[244:247], v[96:111]
    ds_read_b128 v[20:23], v2 offset:1024
    v_cvt_pk_bf16_f32 v41, v46, v47
    v_fma_f32 v51, v51, v13, v13
    v_rcp_f32 v50, v50
    v_mul_f32 v49, v49, v93
    s_waitcnt lgkmcnt(3)
    v_mfma_f32_32x32x16_bf16 v[96:111], v[24:27], v[248:251], v[96:111]
    ds_read_b128 v[24:27], v2 offset:2048
    v_rcp_f32 v51, v51
    v_mul_f32 v50, v50, v94
    v_cvt_pk_bf16_f32 v42, v48, v49
    v_mul_f32 v51, v51, v95
    v_mfma_f32_32x32x16_bf16 v[96:111], v[28:31], v[252:255], v[96:111]
    ds_read_b128 v[28:31], v2 offset:3072
    v_cvt_pk_bf16_f32 v43, v50, v51
    s_add_u32 s65, s44, 5120
    buffer_store_dwordx4 v[40:43], v1, s[8:11], s65 offen sc1
    s_waitcnt lgkmcnt(3)
    v_mfma_f32_32x32x16_bf16 v[96:111], v[32:35], v[16:19], v[96:111]
    ds_read_b128 v[32:35], v2 offset:4096
    v_mfma_f32_32x32x16_bf16 v[112:127], v[36:39], v[128:131], 0
    ds_read_b128 v[36:39], v2 offset:5120
    s_waitcnt lgkmcnt(3)
    v_mfma_f32_32x32x16_bf16 v[112:127], v[20:23], v[132:135], v[112:127]
    ds_read_b128 v[20:23], v2 offset:6144
    s_add_u32 m0, s52, 67584
    s_add_u32 s63, s47, 33792
    buffer_load_dwordx4 v1, s[8:11], s63 offen offset:0 lds
    v_mfma_f32_32x32x16_bf16 v[112:127], v[24:27], v[136:139], v[112:127]
    ds_read_b128 v[24:27], v2 offset:7168
    s_waitcnt lgkmcnt(3)
    v_mfma_f32_32x32x16_bf16 v[112:127], v[28:31], v[140:143], v[112:127]
    ds_read_b128 v[28:31], v2 offset:8192
    v_mul_f32 v44, v96, v12
    v_mul_f32 v45, v97, v12
    v_exp_f32 v44, v44
    v_mfma_f32_32x32x16_bf16 v[112:127], v[32:35], v[144:147], v[112:127]
    ds_read_b128 v[32:35], v2 offset:9216
    buffer_load_dwordx4 v1, s[8:11], s63 offen offset:1024 lds
    s_waitcnt lgkmcnt(3)
    v_mfma_f32_32x32x16_bf16 v[112:127], v[36:39], v[148:151], v[112:127]
    ds_read_b128 v[36:39], v2 offset:10240
    v_mul_f32 v46, v98, v12
    v_exp_f32 v45, v45
    v_mfma_f32_32x32x16_bf16 v[112:127], v[20:23], v[152:155], v[112:127]
    ds_read_b128 v[20:23], v2 offset:11264
    v_fma_f32 v44, v44, v13, v13
    v_mul_f32 v47, v99, v12
    s_waitcnt lgkmcnt(3)
    v_mfma_f32_32x32x16_bf16 v[112:127], v[24:27], v[156:159], v[112:127]
    ds_read_b128 v[24:27], v2 offset:12288
    buffer_load_dwordx4 v1, s[8:11], s63 offen offset:2048 lds
    v_exp_f32 v46, v46
    v_mfma_f32_32x32x16_bf16 v[112:127], v[28:31], v[160:163], v[112:127]
    ds_read_b128 v[28:31], v2 offset:13312
    v_fma_f32 v45, v45, v13, v13
    v_rcp_f32 v44, v44
    s_waitcnt lgkmcnt(3)
    v_mfma_f32_32x32x16_bf16 v[112:127], v[32:35], v[164:167], v[112:127]
    ds_read_b128 v[32:35], v2 offset:14336
    v_mul_f32 v48, v100, v12
    v_exp_f32 v47, v47
    v_mfma_f32_32x32x16_bf16 v[112:127], v[36:39], v[168:171], v[112:127]
    ds_read_b128 v[36:39], v2 offset:15360
    v_fma_f32 v46, v46, v13, v13
    v_rcp_f32 v45, v45
    s_waitcnt lgkmcnt(3)
    v_mfma_f32_32x32x16_bf16 v[112:127], v[20:23], v[172:175], v[112:127]
    ds_read_b128 v[20:23], v2 offset:16384
    buffer_load_dwordx4 v1, s[8:11], s63 offen offset:3072 lds
    v_mul_f32 v44, v44, v104
    v_mfma_f32_32x32x16_bf16 v[112:127], v[24:27], v[176:179], v[112:127]
    ds_read_b128 v[24:27], v2 offset:17408
    v_mul_f32 v49, v101, v12
    v_exp_f32 v48, v48
    s_waitcnt lgkmcnt(3)
    v_mfma_f32_32x32x16_bf16 v[112:127], v[28:31], v[180:183], v[112:127]
    ds_read_b128 v[28:31], v2 offset:18432
    v_fma_f32 v47, v47, v13, v13
    v_rcp_f32 v46, v46
    v_mfma_f32_32x32x16_bf16 v[112:127], v[32:35], v[184:187], v[112:127]
    ds_read_b128 v[32:35], v2 offset:19456
    s_add_u32 m0, s52, 71680
    s_add_u32 s63, s47, 37888
    buffer_load_dwordx4 v1, s[8:11], s63 offen offset:0 lds
    s_waitcnt lgkmcnt(3)
    v_mfma_f32_32x32x16_bf16 v[112:127], v[36:39], v[188:191], v[112:127]
    ds_read_b128 v[36:39], v2 offset:20480
    v_mul_f32 v45, v45, v105
    v_mul_f32 v50, v102, v12
    v_mfma_f32_32x32x16_bf16 v[112:127], v[20:23], v[192:195], v[112:127]
    ds_read_b128 v[20:23], v2 offset:21504
    v_exp_f32 v49, v49
    v_fma_f32 v48, v48, v13, v13
    s_waitcnt lgkmcnt(3)
    v_mfma_f32_32x32x16_bf16 v[112:127], v[24:27], v[196:199], v[112:127]
    ds_read_b128 v[24:27], v2 offset:22528
    v_rcp_f32 v47, v47
    v_mul_f32 v46, v46, v106
    v_mfma_f32_32x32x16_bf16 v[112:127], v[28:31], v[200:203], v[112:127]
    ds_read_b128 v[28:31], v2 offset:23552
    buffer_load_dwordx4 v1, s[8:11], s63 offen offset:1024 lds
    v_cvt_pk_bf16_f32 v40, v44, v45
    s_waitcnt lgkmcnt(3)
    v_mfma_f32_32x32x16_bf16 v[112:127], v[32:35], v[204:207], v[112:127]
    ds_read_b128 v[32:35], v2 offset:24576
    v_mul_f32 v51, v103, v12
    v_exp_f32 v50, v50
    v_mfma_f32_32x32x16_bf16 v[112:127], v[36:39], v[208:211], v[112:127]
    ds_read_b128 v[36:39], v2 offset:25600
    v_fma_f32 v49, v49, v13, v13
    v_rcp_f32 v48, v48
    s_waitcnt lgkmcnt(3)
    v_mfma_f32_32x32x16_bf16 v[112:127], v[20:23], v[212:215], v[112:127]
    ds_read_b128 v[20:23], v2 offset:26624
    buffer_load_dwordx4 v1, s[8:11], s63 offen offset:2048 lds
    v_mul_f32 v47, v47, v107
    v_mfma_f32_32x32x16_bf16 v[112:127], v[24:27], v[216:219], v[112:127]
    ds_read_b128 v[24:27], v2 offset:27648
    v_exp_f32 v51, v51
    v_fma_f32 v50, v50, v13, v13
    s_waitcnt lgkmcnt(3)
    v_mfma_f32_32x32x16_bf16 v[112:127], v[28:31], v[220:223], v[112:127]
    ds_read_b128 v[28:31], v2 offset:28672
    v_rcp_f32 v49, v49
    v_mul_f32 v48, v48, v108
    v_mfma_f32_32x32x16_bf16 v[112:127], v[32:35], v[224:227], v[112:127]
    ds_read_b128 v[32:35], v2 offset:29696
    v_cvt_pk_bf16_f32 v41, v46, v47
    v_fma_f32 v51, v51, v13, v13
    s_waitcnt lgkmcnt(3)
    v_mfma_f32_32x32x16_bf16 v[112:127], v[36:39], v[228:231], v[112:127]
    ds_read_b128 v[36:39], v2 offset:30720
    buffer_load_dwordx4 v1, s[8:11], s63 offen offset:3072 lds
    v_rcp_f32 v50, v50
    v_mfma_f32_32x32x16_bf16 v[112:127], v[20:23], v[232:235], v[112:127]
    ds_read_b128 v[20:23], v2 offset:31744
    v_mul_f32 v49, v49, v109
    v_rcp_f32 v51, v51
    s_waitcnt lgkmcnt(3)
    v_mfma_f32_32x32x16_bf16 v[112:127], v[24:27], v[236:239], v[112:127]
    ds_read_b128 v[24:27], v2 offset:32768
    s_waitcnt vmcnt(9)
    s_barrier
    v_mul_f32 v50, v50, v110
    v_mfma_f32_32x32x16_bf16 v[112:127], v[28:31], v[240:243], v[112:127]
    ds_read_b128 v[28:31], v3 offset:0
    s_add_u32 m0, s14, 67584
    s_add_u32 s63, s46, 33792
    buffer_load_dword v11, s[8:11], s63 offen lds
    s_waitcnt lgkmcnt(3)
    v_mfma_f32_32x32x16_bf16 v[112:127], v[32:35], v[244:247], v[112:127]
    ds_read_b128 v[32:35], v3 offset:1024
    v_cvt_pk_bf16_f32 v42, v48, v49
    v_mfma_f32_32x32x16_bf16 v[112:127], v[36:39], v[248:251], v[112:127]
    ds_read_b128 v[36:39], v3 offset:2048
    v_mul_f32 v51, v51, v111
    v_cvt_pk_bf16_f32 v43, v50, v51
    s_waitcnt lgkmcnt(3)
    v_mfma_f32_32x32x16_bf16 v[112:127], v[20:23], v[252:255], v[112:127]
    ds_read_b128 v[20:23], v3 offset:3072
    s_add_u32 s65, s44, 4096
    buffer_store_dwordx4 v[40:43], v1, s[8:11], s65 offen sc1
    v_mfma_f32_32x32x16_bf16 v[112:127], v[24:27], v[16:19], v[112:127]
    ds_read_b128 v[24:27], v3 offset:4096
    s_waitcnt lgkmcnt(3)
    v_mfma_f32_32x32x16_bf16 v[64:79], v[28:31], v[128:131], 0
    ds_read_b128 v[28:31], v3 offset:5120
    v_mfma_f32_32x32x16_bf16 v[64:79], v[32:35], v[132:135], v[64:79]
    ds_read_b128 v[32:35], v3 offset:6144
    s_add_u32 m0, s52, 101376
    s_add_u32 s63, s47, 0
    buffer_load_dwordx4 v1, s[8:11], s63 offen offset:0 lds
    s_waitcnt lgkmcnt(3)
    v_mfma_f32_32x32x16_bf16 v[64:79], v[36:39], v[136:139], v[64:79]
    ds_read_b128 v[36:39], v3 offset:7168
    v_mfma_f32_32x32x16_bf16 v[64:79], v[20:23], v[140:143], v[64:79]
    ds_read_b128 v[20:23], v3 offset:8192
    v_mul_f32 v44, v112, v12
    v_mul_f32 v45, v113, v12
    v_exp_f32 v44, v44
    s_waitcnt lgkmcnt(3)
    v_mfma_f32_32x32x16_bf16 v[64:79], v[24:27], v[144:147], v[64:79]
    ds_read_b128 v[24:27], v3 offset:9216
    buffer_load_dwordx4 v1, s[8:11], s63 offen offset:1024 lds
    v_mul_f32 v46, v114, v12
    v_mfma_f32_32x32x16_bf16 v[64:79], v[28:31], v[148:151], v[64:79]
    ds_read_b128 v[28:31], v3 offset:10240
    v_exp_f32 v45, v45
    v_fma_f32 v44, v44, v13, v13
    v_mul_f32 v47, v115, v12
    s_waitcnt lgkmcnt(3)
    v_mfma_f32_32x32x16_bf16 v[64:79], v[32:35], v[152:155], v[64:79]
    ds_read_b128 v[32:35], v3 offset:11264
    v_exp_f32 v46, v46
    v_fma_f32 v45, v45, v13, v13
    v_rcp_f32 v44, v44
    v_mfma_f32_32x32x16_bf16 v[64:79], v[36:39], v[156:159], v[64:79]
    ds_read_b128 v[36:39], v3 offset:12288
    buffer_load_dwordx4 v1, s[8:11], s63 offen offset:2048 lds
    s_waitcnt lgkmcnt(3)
    v_mfma_f32_32x32x16_bf16 v[64:79], v[20:23], v[160:163], v[64:79]
    ds_read_b128 v[20:23], v3 offset:13312
    v_mul_f32 v48, v116, v12
    v_exp_f32 v47, v47
    v_fma_f32 v46, v46, v13, v13
    v_mfma_f32_32x32x16_bf16 v[64:79], v[24:27], v[164:167], v[64:79]
    ds_read_b128 v[24:27], v3 offset:14336
    v_rcp_f32 v45, v45
    v_mul_f32 v44, v44, v120
    v_mul_f32 v49, v117, v12
    s_waitcnt lgkmcnt(3)
    v_mfma_f32_32x32x16_bf16 v[64:79], v[28:31], v[168:171], v[64:79]
    ds_read_b128 v[28:31], v3 offset:15360
    v_exp_f32 v48, v48
    v_fma_f32 v47, v47, v13, v13
    v_rcp_f32 v46, v46
    v_mfma_f32_32x32x16_bf16 v[64:79], v[32:35], v[172:175], v[64:79]
    ds_read_b128 v[32:35], v3 offset:16384
    buffer_load_dwordx4 v1, s[8:11], s63 offen offset:3072 lds
    v_mul_f32 v45, v45, v121
    s_waitcnt lgkmcnt(3)
    v_mfma_f32_32x32x16_bf16 v[64:79], v[36:39], v[176:179], v[64:79]
    ds_read_b128 v[36:39], v3 offset:17408
    v_mul_f32 v50, v118, v12
    v_exp_f32 v49, v49
    v_fma_f32 v48, v48, v13, v13
    v_mfma_f32_32x32x16_bf16 v[64:79], v[20:23], v[180:183], v[64:79]
    ds_read_b128 v[20:23], v3 offset:18432
    v_rcp_f32 v47, v47
    v_mul_f32 v46, v46, v122
    s_waitcnt lgkmcnt(3)
    v_mfma_f32_32x32x16_bf16 v[64:79], v[24:27], v[184:187], v[64:79]
    ds_read_b128 v[24:27], v3 offset:19456
    s_add_u32 m0, s52, 105472
    s_add_u32 s63, s47, 4096
    buffer_load_dwordx4 v1, s[8:11], s63 offen offset:0 lds
    v_mfma_f32_32x32x16_bf16 v[64:79], v[28:31], v[188:191], v[64:79]
    ds_read_b128 v[28:31], v3 offset:20480
    v_cvt_pk_bf16_f32 v40, v44, v45
    v_mul_f32 v51, v119, v12
    v_exp_f32 v50, v50
    s_waitcnt lgkmcnt(3)
    v_mfma_f32_32x32x16_bf16 v[64:79], v[32:35], v[192:195], v[64:79]
    ds_read_b128 v[32:35], v3 offset:21504
    v_fma_f32 v49, v49, v13, v13
    v_rcp_f32 v48, v48
    v_mul_f32 v47, v47, v123
    v_mfma_f32_32x32x16_bf16 v[64:79], v[36:39], v[196:199], v[64:79]
    ds_read_b128 v[36:39], v3 offset:22528
    v_exp_f32 v51, v51
    v_fma_f32 v50, v50, v13, v13
    s_waitcnt lgkmcnt(3)
    v_mfma_f32_32x32x16_bf16 v[64:79], v[20:23], v[200:203], v[64:79]
    ds_read_b128 v[20:23], v3 offset:23552
    buffer_load_dwordx4 v1, s[8:11], s63 offen offset:1024 lds
    v_rcp_f32 v49, v49
    v_mul_f32 v48, v48, v124
    v_mfma_f32_32x32x16_bf16 v[64:79], v[24:27], v[204:207], v[64:79]
    ds_read_b128 v[24:27], v3 offset:24576
    v_cvt_pk_bf16_f32 v41, v46, v47
    v_fma_f32 v51, v51, v13, v13
    s_waitcnt lgkmcnt(3)
    v_mfma_f32_32x32x16_bf16 v[64:79], v[28:31], v[208:211], v[64:79]
    ds_read_b128 v[28:31], v3 offset:25600
    v_rcp_f32 v50, v50
    v_mul_f32 v49, v49, v125
    v_rcp_f32 v51, v51
    v_mfma_f32_32x32x16_bf16 v[64:79], v[32:35], v[212:215], v[64:79]
    ds_read_b128 v[32:35], v3 offset:26624
    buffer_load_dwordx4 v1, s[8:11], s63 offen offset:2048 lds
    v_mul_f32 v50, v50, v126
    s_waitcnt lgkmcnt(3)
    v_mfma_f32_32x32x16_bf16 v[64:79], v[36:39], v[216:219], v[64:79]
    ds_read_b128 v[36:39], v3 offset:27648
    v_cvt_pk_bf16_f32 v42, v48, v49
    v_mul_f32 v51, v51, v127
    v_cvt_pk_bf16_f32 v43, v50, v51
    v_mfma_f32_32x32x16_bf16 v[64:79], v[20:23], v[220:223], v[64:79]
    ds_read_b128 v[20:23], v3 offset:28672
    s_add_u32 s65, s44, 3072
    buffer_store_dwordx4 v[40:43], v1, s[8:11], s65 offen sc1
    s_waitcnt lgkmcnt(3)
    v_mfma_f32_32x32x16_bf16 v[64:79], v[24:27], v[224:227], v[64:79]
    ds_read_b128 v[24:27], v3 offset:29696
    v_mfma_f32_32x32x16_bf16 v[64:79], v[28:31], v[228:231], v[64:79]
    ds_read_b128 v[28:31], v3 offset:30720
    buffer_load_dwordx4 v1, s[8:11], s63 offen offset:3072 lds
    s_waitcnt lgkmcnt(3)
    v_mfma_f32_32x32x16_bf16 v[64:79], v[32:35], v[232:235], v[64:79]
    ds_read_b128 v[32:35], v3 offset:31744
    v_mfma_f32_32x32x16_bf16 v[64:79], v[36:39], v[236:239], v[64:79]
    ds_read_b128 v[36:39], v3 offset:32768
    s_waitcnt vmcnt(10)
    s_barrier
    s_waitcnt lgkmcnt(3)
    v_mfma_f32_32x32x16_bf16 v[64:79], v[20:23], v[240:243], v[64:79]
    ds_read_b128 v[20:23], v4 offset:0
    s_add_u32 m0, s14, 101376
    s_add_u32 s63, s46, 0
    buffer_load_dword v11, s[8:11], s63 offen lds
    v_mfma_f32_32x32x16_bf16 v[64:79], v[24:27], v[244:247], v[64:79]
    ds_read_b128 v[24:27], v4 offset:1024
    s_waitcnt lgkmcnt(3)
    v_mfma_f32_32x32x16_bf16 v[64:79], v[28:31], v[248:251], v[64:79]
    ds_read_b128 v[28:31], v4 offset:2048
    v_mfma_f32_32x32x16_bf16 v[64:79], v[32:35], v[252:255], v[64:79]
    ds_read_b128 v[32:35], v4 offset:3072
    s_waitcnt lgkmcnt(3)
    v_mfma_f32_32x32x16_bf16 v[64:79], v[36:39], v[16:19], v[64:79]
    ds_read_b128 v[36:39], v4 offset:4096
    v_mfma_f32_32x32x16_bf16 v[96:111], v[20:23], v[128:131], 0
    ds_read_b128 v[20:23], v4 offset:5120
    s_add_u32 s66, s48, 49152
    buffer_load_dwordx4 a[60:63], v7, s[8:11], s66 offen
    s_waitcnt lgkmcnt(3)
    v_mfma_f32_32x32x16_bf16 v[96:111], v[24:27], v[132:135], v[96:111]
    ds_read_b128 v[24:27], v4 offset:6144
    v_mfma_f32_32x32x16_bf16 v[96:111], v[28:31], v[136:139], v[96:111]
    ds_read_b128 v[28:31], v4 offset:7168
    s_add_u32 s66, s48, 8192
    buffer_load_dwordx4 a[64:67], v6, s[8:11], s66 offen
    s_waitcnt lgkmcnt(3)
    v_mfma_f32_32x32x16_bf16 v[96:111], v[32:35], v[140:143], v[96:111]
    ds_read_b128 v[32:35], v4 offset:8192
    v_mul_f32 v44, v64, v12
    v_mul_f32 v45, v65, v12
    v_exp_f32 v44, v44
    v_mfma_f32_32x32x16_bf16 v[96:111], v[36:39], v[144:147], v[96:111]
    ds_read_b128 v[36:39], v4 offset:9216
    v_mul_f32 v46, v66, v12
    v_exp_f32 v45, v45
    s_waitcnt lgkmcnt(3)
    v_mfma_f32_32x32x16_bf16 v[96:111], v[20:23], v[148:151], v[96:111]
    ds_read_b128 v[20:23], v4 offset:10240
    buffer_load_dwordx4 a[68:71], v7, s[8:11], s66 offen
    v_fma_f32 v44, v44, v13, v13
    v_mfma_f32_32x32x16_bf16 v[96:111], v[24:27], v[152:155], v[96:111]
    ds_read_b128 v[24:27], v4 offset:11264
    v_mul_f32 v47, v67, v12
    v_exp_f32 v46, v46
    s_waitcnt lgkmcnt(3)
    v_mfma_f32_32x32x16_bf16 v[96:111], v[28:31], v[156:159], v[96:111]
    ds_read_b128 v[28:31], v4 offset:12288
    v_fma_f32 v45, v45, v13, v13
    v_rcp_f32 v44, v44
    v_mul_f32 v48, v68, v12
    v_mfma_f32_32x32x16_bf16 v[96:111], v[32:35], v[160:163], v[96:111]
    ds_read_b128 v[32:35], v4 offset:13312
    buffer_load_dwordx4 a[72:75], v6, s[8:11], s66 offen offset:2048
    s_waitcnt lgkmcnt(3)
    v_mfma_f32_32x32x16_bf16 v[96:111], v[36:39], v[164:167], v[96:111]
    ds_read_b128 v[36:39], v4 offset:14336
    v_exp_f32 v47, v47
    v_fma_f32 v46, v46, v13, v13
    v_rcp_f32 v45, v45
    v_mfma_f32_32x32x16_bf16 v[96:111], v[20:23], v[168:171], v[96:111]
    ds_read_b128 v[20:23], v4 offset:15360
    v_mul_f32 v44, v44, v72
    v_mul_f32 v49, v69, v12
    s_waitcnt lgkmcnt(3)
    v_mfma_f32_32x32x16_bf16 v[96:111], v[24:27], v[172:175], v[96:111]
    ds_read_b128 v[24:27], v4 offset:16384
    buffer_load_dwordx4 a[76:79], v7, s[8:11], s66 offen offset:2048
    v_exp_f32 v48, v48
    v_mfma_f32_32x32x16_bf16 v[96:111], v[28:31], v[176:179], v[96:111]
    ds_read_b128 v[28:31], v4 offset:17408
    v_fma_f32 v47, v47, v13, v13
    v_rcp_f32 v46, v46
    s_waitcnt lgkmcnt(3)
    v_mfma_f32_32x32x16_bf16 v[96:111], v[32:35], v[180:183], v[96:111]
    ds_read_b128 v[32:35], v4 offset:18432
    v_mul_f32 v45, v45, v73
    v_mul_f32 v50, v70, v12
    v_exp_f32 v49, v49
    v_mfma_f32_32x32x16_bf16 v[96:111], v[36:39], v[184:187], v[96:111]
    ds_read_b128 v[36:39], v4 offset:19456
    s_add_u32 s66, s48, 12288
    buffer_load_dwordx4 a[80:83], v6, s[8:11], s66 offen
    s_waitcnt lgkmcnt(3)
    v_mfma_f32_32x32x16_bf16 v[96:111], v[20:23], v[188:191], v[96:111]
    ds_read_b128 v[20:23], v4 offset:20480
    v_fma_f32 v48, v48, v13, v13
    v_rcp_f32 v47, v47
    v_mfma_f32_32x32x16_bf16 v[96:111], v[24:27], v[192:195], v[96:111]
    ds_read_b128 v[24:27], v4 offset:21504
    v_mul_f32 v46, v46, v74
    v_cvt_pk_bf16_f32 v40, v44, v45
    v_mul_f32 v51, v71, v12
    s_waitcnt lgkmcnt(3)
    v_mfma_f32_32x32x16_bf16 v[96:111], v[28:31], v[196:199], v[96:111]
    ds_read_b128 v[28:31], v4 offset:22528
    buffer_load_dwordx4 a[84:87], v7, s[8:11], s66 offen
    v_exp_f32 v50, v50
    v_mfma_f32_32x32x16_bf16 v[96:111], v[32:35], v[200:203], v[96:111]
    ds_read_b128 v[32:35], v4 offset:23552
    v_mov_b32 v62, 11
    s_waitcnt vmcnt(9)
    s_mov_b64 exec, 1
    s_cmp_eq_u32 s12, 0
    s_cbranch_scc1 WT_91
    buffer_store_dword v62, v10, s[8:11], s38 offen
RT_92:
    s_mov_b64 exec, -1
    s_waitcnt lgkmcnt(3)
    v_mfma_f32_32x32x16_bf16 v[96:111], v[36:39], v[204:207], v[96:111]
    ds_read_b128 v[36:39], v4 offset:24576
    v_mfma_f32_32x32x16_bf16 v[96:111], v[20:23], v[208:211], v[96:111]
    ds_read_b128 v[20:23], v4 offset:25600
    s_add_u32 s66, s48, 22528
    buffer_load_dwordx4 a[88:91], v6, s[8:11], s66 offen
    s_waitcnt lgkmcnt(3)
    v_mfma_f32_32x32x16_bf16 v[96:111], v[24:27], v[212:215], v[96:111]
    ds_read_b128 v[24:27], v4 offset:26624
    v_mfma_f32_32x32x16_bf16 v[96:111], v[28:31], v[216:219], v[96:111]
    ds_read_b128 v[28:31], v4 offset:27648
    v_fma_f32 v49, v49, v13, v13
    v_rcp_f32 v48, v48
    s_waitcnt lgkmcnt(3)
    v_mfma_f32_32x32x16_bf16 v[96:111], v[32:35], v[220:223], v[96:111]
    ds_read_b128 v[32:35], v4 offset:28672
    buffer_load_dwordx4 a[92:95], v7, s[8:11], s66 offen
    v_mul_f32 v47, v47, v75
    v_mfma_f32_32x32x16_bf16 v[96:111], v[36:39], v[224:227], v[96:111]
    ds_read_b128 v[36:39], v4 offset:29696
    v_exp_f32 v51, v51
    v_fma_f32 v50, v50, v13, v13
    s_waitcnt lgkmcnt(3)
    v_mfma_f32_32x32x16_bf16 v[96:111], v[20:23], v[228:231], v[96:111]
    ds_read_b128 v[20:23], v4 offset:30720
    v_rcp_f32 v49, v49
    v_mul_f32 v48, v48, v76
    v_cvt_pk_bf16_f32 v41, v46, v47
    v_mfma_f32_32x32x16_bf16 v[96:111], v[24:27], v[232:235], v[96:111]
    ds_read_b128 v[24:27], v4 offset:31744
    buffer_load_dwordx4 a[96:99], v6, s[8:11], s66 offen offset:2048
    v_fma_f32 v51, v51, v13, v13
    s_waitcnt lgkmcnt(3)
    v_mfma_f32_32x32x16_bf16 v[96:111], v[28:31], v[236:239], v[96:111]
    ds_read_b128 v[28:31], v4 offset:32768
    s_waitcnt vmcnt(11)
    s_barrier
    v_rcp_f32 v50, v50
    v_mfma_f32_32x32x16_bf16 v[96:111], v[32:35], v[240:243], v[96:111]
    ds_read_b128 v[32:35], v5 offset:0
    v_mul_f32 v49, v49, v77
    v_rcp_f32 v51, v51
    s_waitcnt lgkmcnt(3)
    v_mfma_f32_32x32x16_bf16 v[96:111], v[36:39], v[244:247], v[96:111]
    ds_read_b128 v[36:39], v5 offset:1024
    buffer_load_dwordx4 a[100:103], v7, s[8:11], s66 offen offset:2048
    v_mul_f32 v50, v50, v78
    v_mfma_f32_32x32x16_bf16 v[96:111], v[20:23], v[248:251], v[96:111]
    ds_read_b128 v[20:23], v5 offset:2048
    v_cvt_pk_bf16_f32 v42, v48, v49
    v_mul_f32 v51, v51, v79
    v_cvt_pk_bf16_f32 v43, v50, v51
    s_waitcnt lgkmcnt(3)
    v_mfma_f32_32x32x16_bf16 v[96:111], v[24:27], v[252:255], v[96:111]
    ds_read_b128 v[24:27], v5 offset:3072
    s_add_u32 s65, s44, 2048
    buffer_store_dwordx4 v[40:43], v1, s[8:11], s65 offen sc1
    v_mfma_f32_32x32x16_bf16 v[96:111], v[28:31], v[16:19], v[96:111]
    ds_read_b128 v[28:31], v5 offset:4096
    s_waitcnt lgkmcnt(3)
    v_mfma_f32_32x32x16_bf16 v[112:127], v[32:35], v[128:131], 0
    ds_read_b128 v[32:35], v5 offset:5120
    s_add_u32 s66, s48, 26624
    buffer_load_dwordx4 a[104:107], v6, s[8:11], s66 offen
    v_mfma_f32_32x32x16_bf16 v[112:127], v[36:39], v[132:135], v[112:127]
    ds_read_b128 v[36:39], v5 offset:6144
    buffer_load_dword v63, v9, s[8:11], s37 offen sc1
    s_waitcnt lgkmcnt(3)
    v_mfma_f32_32x32x16_bf16 v[112:127], v[20:23], v[136:139], v[112:127]
    ds_read_b128 v[20:23], v5 offset:7168
    v_accvgpr_read_b32 v64, a224
    v_accvgpr_read_b32 v65, a225
    v_mfma_f32_32x32x16_bf16 v[112:127], v[24:27], v[140:143], v[112:127]
    ds_read_b128 v[24:27], v5 offset:8192
    buffer_load_dwordx4 a[108:111], v7, s[8:11], s66 offen
    v_mul_f32 v44, v96, v12
    s_waitcnt lgkmcnt(3)
    v_mfma_f32_32x32x16_bf16 v[112:127], v[28:31], v[144:147], v[112:127]
    ds_read_b128 v[28:31], v5 offset:9216
    v_accvgpr_read_b32 v66, a226
    v_mul_f32 v45, v97, v12
    v_exp_f32 v44, v44
    v_mfma_f32_32x32x16_bf16 v[112:127], v[32:35], v[148:151], v[112:127]
    ds_read_b128 v[32:35], v5 offset:10240
    v_accvgpr_read_b32 v67, a227
    v_mul_f32 v46, v98, v12
    v_exp_f32 v45, v45
    s_waitcnt lgkmcnt(3)
    v_mfma_f32_32x32x16_bf16 v[112:127], v[36:39], v[152:155], v[112:127]
    ds_read_b128 v[36:39], v5 offset:11264
    s_add_u32 s66, s48, 36864
    buffer_load_dwordx4 a[112:115], v6, s[8:11], s66 offen
    v_fma_f32 v44, v44, v13, v13
    v_mfma_f32_32x32x16_bf16 v[112:127], v[20:23], v[156:159], v[112:127]
    ds_read_b128 v[20:23], v5 offset:12288
    v_mul_f32 v47, v99, v12
    v_exp_f32 v46, v46
    s_waitcnt lgkmcnt(3)
    v_mfma_f32_32x32x16_bf16 v[112:127], v[24:27], v[160:163], v[112:127]
    ds_read_b128 v[24:27], v5 offset:13312
    v_accvgpr_read_b32 v68, a228
    v_accvgpr_read_b32 v69, a229
    v_fma_f32 v45, v45, v13, v13
    v_mfma_f32_32x32x16_bf16 v[112:127], v[28:31], v[164:167], v[112:127]
    ds_read_b128 v[28:31], v5 offset:14336
    buffer_load_dwordx4 a[116:119], v7, s[8:11], s66 offen
    v_rcp_f32 v44, v44
    s_waitcnt lgkmcnt(3)
    v_mfma_f32_32x32x16_bf16 v[112:127], v[32:35], v[168:171], v[112:127]
    ds_read_b128 v[32:35], v5 offset:15360
    v_mul_f32 v48, v100, v12
    v_exp_f32 v47, v47
    v_fma_f32 v46, v46, v13, v13
    v_mfma_f32_32x32x16_bf16 v[112:127], v[36:39], v[172:175], v[112:127]
    ds_read_b128 v[36:39], v5 offset:16384
    v_accvgpr_read_b32 v70, a230
    v_rcp_f32 v45, v45
    s_waitcnt lgkmcnt(3)
    v_mfma_f32_32x32x16_bf16 v[112:127], v[20:23], v[176:179], v[112:127]
    ds_read_b128 v[20:23], v5 offset:17408
    buffer_load_dwordx4 a[120:123], v6, s[8:11], s66 offen offset:2048
    v_mul_f32 v44, v44, v104
    v_mul_f32 v49, v101, v12
    v_mfma_f32_32x32x16_bf16 v[112:127], v[24:27], v[180:183], v[112:127]
    ds_read_b128 v[24:27], v5 offset:18432
    v_accvgpr_read_b32 v71, a231
    v_exp_f32 v48, v48
    v_fma_f32 v47, v47, v13, v13
    s_waitcnt lgkmcnt(3)
    v_mfma_f32_32x32x16_bf16 v[112:127], v[28:31], v[184:187], v[112:127]
    ds_read_b128 v[28:31], v5 offset:19456
    v_pk_mul_f32 v[72:73], v[10:11], v[10:11] op_sel:[0,0] op_sel_hi:[0,0]
    v_pk_mul_f32 v[74:75], v[10:11], v[10:11] op_sel:[0,0] op_sel_hi:[0,0]
    v_rcp_f32 v46, v46
    v_mfma_f32_32x32x16_bf16 v[112:127], v[32:35], v[188:191], v[112:127]
    ds_read_b128 v[32:35], v5 offset:20480
    s_waitcnt vmcnt(4)
    v_cmp_gt_u32 vcc, 11, v63
    s_cbranch_vccz OK_96
    s_mov_b32 s62, 0
    SP_97:
    buffer_load_dword v63, v9, s[8:11], s37 offen sc1
    s_add_u32 s62, s62, 1
    s_cmp_gt_u32 s62, 0x200000
    s_cbranch_scc1 L_fail
    s_waitcnt vmcnt(0)
    v_cmp_gt_u32 vcc, 11, v63
    s_cbranch_vccnz SP_97
    OK_96:
    v_mul_f32 v45, v45, v105
    v_mul_f32 v50, v102, v12
    s_waitcnt lgkmcnt(3)
    v_mfma_f32_32x32x16_bf16 v[112:127], v[36:39], v[192:195], v[112:127]
    ds_read_b128 v[36:39], v5 offset:21504
    s_add_u32 s64, s45, 3072
    buffer_load_dwordx4 v[128:131], v1, s[8:11], s64 offen sc1
    v_mfma_f32_32x32x16_bf16 v[112:127], v[20:23], v[196:199], v[112:127]
    ds_read_b128 v[20:23], v5 offset:22528
    buffer_load_dwordx4 v[132:135], v1, s[8:11], s64 offen offset:1024 sc1
    v_exp_f32 v49, v49
    s_waitcnt lgkmcnt(3)
    v_mfma_f32_32x32x16_bf16 v[112:127], v[24:27], v[200:203], v[112:127]
    ds_read_b128 v[24:27], v5 offset:23552
    buffer_load_dwordx4 v[136:139], v1, s[8:11], s64 offen offset:2048 sc1
    v_fma_f32 v48, v48, v13, v13
    v_rcp_f32 v47, v47
    v_mfma_f32_32x32x16_bf16 v[112:127], v[28:31], v[204:207], v[112:127]
    ds_read_b128 v[28:31], v5 offset:24576
    buffer_load_dwordx4 v[140:143], v1, s[8:11], s64 offen offset:3072 sc1
    s_waitcnt lgkmcnt(3)
    v_mfma_f32_32x32x16_bf16 v[112:127], v[32:35], v[208:211], v[112:127]
    ds_read_b128 v[32:35], v5 offset:25600
    s_add_u32 s64, s45, 10240
    buffer_load_dwordx4 v[144:147], v1, s[8:11], s64 offen sc1
    v_mul_f32 v46, v46, v106
    v_mfma_f32_32x32x16_bf16 v[112:127], v[36:39], v[212:215], v[112:127]
    ds_read_b128 v[36:39], v5 offset:26624
    buffer_load_dwordx4 v[148:151], v1, s[8:11], s64 offen offset:1024 sc1
    v_cvt_pk_bf16_f32 v40, v44, v45
    v_mul_f32 v51, v103, v12
    s_waitcnt lgkmcnt(3)
    v_mfma_f32_32x32x16_bf16 v[112:127], v[20:23], v[216:219], v[112:127]
    ds_read_b128 v[20:23], v5 offset:27648
    buffer_load_dwordx4 v[152:155], v1, s[8:11], s64 offen offset:2048 sc1
    v_exp_f32 v50, v50
    v_mfma_f32_32x32x16_bf16 v[112:127], v[24:27], v[220:223], v[112:127]
    ds_read_b128 v[24:27], v5 offset:28672
    buffer_load_dwordx4 v[156:159], v1, s[8:11], s64 offen offset:3072 sc1
    v_fma_f32 v49, v49, v13, v13
    s_waitcnt lgkmcnt(3)
    v_mfma_f32_32x32x16_bf16 v[112:127], v[28:31], v[224:227], v[112:127]
    ds_read_b128 v[28:31], v5 offset:29696
    s_add_u32 s64, s45, 17408
    buffer_load_dwordx4 v[160:163], v1, s[8:11], s64 offen sc1
    v_rcp_f32 v48, v48
    v_mfma_f32_32x32x16_bf16 v[112:127], v[32:35], v[228:231], v[112:127]
    ds_read_b128 v[32:35], v5 offset:30720
    buffer_load_dwordx4 v[164:167], v1, s[8:11], s64 offen offset:1024 sc1
    s_waitcnt lgkmcnt(3)
    v_mfma_f32_32x32x16_bf16 v[112:127], v[36:39], v[232:235], v[112:127]
    ds_read_b128 v[36:39], v5 offset:31744
    v_mul_f32 v47, v47, v107
    v_exp_f32 v51, v51
    v_fma_f32 v50, v50, v13, v13
    v_mfma_f32_32x32x16_bf16 v[112:127], v[20:23], v[236:239], v[112:127]
    ds_read_b128 v[20:23], v5 offset:32768
    v_rcp_f32 v49, v49
    v_mul_f32 v48, v48, v108
    s_waitcnt lgkmcnt(3)
    v_mfma_f32_32x32x16_bf16 v[112:127], v[24:27], v[240:243], v[112:127]
    v_cvt_pk_bf16_f32 v41, v46, v47
    v_fma_f32 v51, v51, v13, v13
    v_rcp_f32 v50, v50
    v_mul_f32 v49, v49, v109
    v_mfma_f32_32x32x16_bf16 v[112:127], v[28:31], v[244:247], v[112:127]
    v_rcp_f32 v51, v51
    v_mul_f32 v50, v50, v110
    s_waitcnt lgkmcnt(1)
    v_mfma_f32_32x32x16_bf16 v[112:127], v[32:35], v[248:251], v[112:127]
    v_cvt_pk_bf16_f32 v42, v48, v49
    v_mul_f32 v51, v51, v111
    v_cvt_pk_bf16_f32 v43, v50, v51
    v_mfma_f32_32x32x16_bf16 v[112:127], v[36:39], v[252:255], v[112:127]
    s_add_u32 s65, s44, 1024
    buffer_store_dwordx4 v[40:43], v1, s[8:11], s65 offen sc1
    s_waitcnt lgkmcnt(0)
    v_mfma_f32_32x32x16_bf16 v[112:127], v[20:23], v[16:19], v[112:127]
    v_pk_mul_f32 v[76:77], v[10:11], v[10:11] op_sel:[0,0] op_sel_hi:[0,0]
    v_pk_mul_f32 v[78:79], v[10:11], v[10:11] op_sel:[0,0] op_sel_hi:[0,0]
    s_nop 9
    v_pk_mul_f32 v[44:45], v[112:113], v[12:13] op_sel:[0,0] op_sel_hi:[1,0]
    v_pk_mul_f32 v[46:47], v[114:115], v[12:13] op_sel:[0,0] op_sel_hi:[1,0]
    v_pk_mul_f32 v[48:49], v[116:117], v[12:13] op_sel:[0,0] op_sel_hi:[1,0]
    v_pk_mul_f32 v[50:51], v[118:119], v[12:13] op_sel:[0,0] op_sel_hi:[1,0]
    v_exp_f32 v44, v44
    v_exp_f32 v45, v45
    v_exp_f32 v46, v46
    v_exp_f32 v47, v47
    v_exp_f32 v48, v48
    v_exp_f32 v49, v49
    v_exp_f32 v50, v50
    v_exp_f32 v51, v51
    v_pk_fma_f32 v[44:45], v[44:45], v[12:13], v[12:13] op_sel:[0,1,1] op_sel_hi:[1,1,1]
    v_pk_fma_f32 v[46:47], v[46:47], v[12:13], v[12:13] op_sel:[0,1,1] op_sel_hi:[1,1,1]
    v_pk_fma_f32 v[48:49], v[48:49], v[12:13], v[12:13] op_sel:[0,1,1] op_sel_hi:[1,1,1]
    v_pk_fma_f32 v[50:51], v[50:51], v[12:13], v[12:13] op_sel:[0,1,1] op_sel_hi:[1,1,1]
    v_rcp_f32 v44, v44
    v_rcp_f32 v45, v45
    v_rcp_f32 v46, v46
    v_rcp_f32 v47, v47
    v_rcp_f32 v48, v48
    v_rcp_f32 v49, v49
    v_rcp_f32 v50, v50
    v_rcp_f32 v51, v51
    v_pk_mul_f32 v[44:45], v[44:45], v[120:121] op_sel:[0,0] op_sel_hi:[1,1]
    v_pk_mul_f32 v[46:47], v[46:47], v[122:123] op_sel:[0,0] op_sel_hi:[1,1]
    v_pk_mul_f32 v[48:49], v[48:49], v[124:125] op_sel:[0,0] op_sel_hi:[1,1]
    v_pk_mul_f32 v[50:51], v[50:51], v[126:127] op_sel:[0,0] op_sel_hi:[1,1]
    v_cvt_pk_bf16_f32 v40, v44, v45
    v_cvt_pk_bf16_f32 v41, v46, v47
    v_cvt_pk_bf16_f32 v42, v48, v49
    v_cvt_pk_bf16_f32 v43, v50, v51
    s_add_u32 s65, s44, 0
    s_cmp_eq_u32 s12, 0
    s_cbranch_scc1 WT_98
    buffer_store_dwordx4 v[40:43], v1, s[8:11], s65 offen
RT_99:
    buffer_load_dwordx4 v[168:171], v1, s[8:11], s64 offen offset:2048 sc1
    s_waitcnt vmcnt(12)
    v_mfma_f32_32x32x16_bf16 v[80:95], a[28:31], v[128:131], 0
    v_mfma_f32_32x32x16_bf16 v[64:79], a[24:27], v[128:131], v[64:79]
    v_accvgpr_read_b32 v96, a232
    buffer_load_dwordx4 v[172:175], v1, s[8:11], s64 offen offset:3072 sc1
    s_waitcnt vmcnt(12)
    v_mfma_f32_32x32x16_bf16 v[80:95], a[68:71], v[132:135], v[80:95]
    v_mfma_f32_32x32x16_bf16 v[64:79], a[64:67], v[132:135], v[64:79]
    v_accvgpr_read_b32 v97, a233
    s_add_u32 s64, s45, 24576
    buffer_load_dwordx4 v[176:179], v1, s[8:11], s64 offen sc1
    s_waitcnt vmcnt(12)
    v_mfma_f32_32x32x16_bf16 v[80:95], a[76:79], v[136:139], v[80:95]
    v_mfma_f32_32x32x16_bf16 v[64:79], a[72:75], v[136:139], v[64:79]
    v_accvgpr_read_b32 v98, a234
    buffer_load_dwordx4 v[180:183], v1, s[8:11], s64 offen offset:1024 sc1
    s_waitcnt vmcnt(12)
    v_mfma_f32_32x32x16_bf16 v[80:95], a[84:87], v[140:143], v[80:95]
    v_mfma_f32_32x32x16_bf16 v[64:79], a[80:83], v[140:143], v[64:79]
    v_accvgpr_read_b32 v99, a235
    buffer_load_dwordx4 v[184:187], v1, s[8:11], s64 offen offset:2048 sc1
    s_waitcnt vmcnt(12)
    v_mfma_f32_32x32x16_bf16 v[80:95], a[128:131], v[144:147], v[80:95]
    v_mfma_f32_32x32x16_bf16 v[64:79], a[56:59], v[144:147], v[64:79]
    v_accvgpr_read_b32 v100, a236
    buffer_load_dwordx4 v[188:191], v1, s[8:11], s64 offen offset:3072 sc1
    s_waitcnt vmcnt(12)
    v_mfma_f32_32x32x16_bf16 v[80:95], a[92:95], v[148:151], v[80:95]
    v_mfma_f32_32x32x16_bf16 v[64:79], a[88:91], v[148:151], v[64:79]
    v_accvgpr_read_b32 v101, a237
    v_mov_b32 v62, 12
    s_waitcnt vmcnt(6)
    s_mov_b64 exec, 1
    s_cmp_eq_u32 s12, 0
    s_cbranch_scc1 WT_100
    buffer_store_dword v62, v10, s[8:11], s38 offen
RT_101:
    s_mov_b64 exec, -1
    s_add_u32 s64, s45, 117760
    buffer_load_dwordx4 v[128:131], v1, s[8:11], s64 offen sc1
    v_mfma_f32_32x32x16_bf16 v[80:95], a[100:103], v[152:155], v[80:95]
    v_mfma_f32_32x32x16_bf16 v[64:79], a[96:99], v[152:155], v[64:79]
    v_accvgpr_read_b32 v102, a238
    buffer_load_dwordx4 v[132:135], v1, s[8:11], s64 offen offset:1024 sc1
    v_mfma_f32_32x32x16_bf16 v[80:95], a[108:111], v[156:159], v[80:95]
    v_mfma_f32_32x32x16_bf16 v[64:79], a[104:107], v[156:159], v[64:79]
    v_accvgpr_read_b32 v103, a239
    buffer_load_dwordx4 v[136:139], v1, s[8:11], s64 offen offset:2048 sc1
    v_mfma_f32_32x32x16_bf16 v[80:95], a[160:163], v[160:163], v[80:95]
    v_mfma_f32_32x32x16_bf16 v[64:79], a[156:159], v[160:163], v[64:79]
    v_pk_mul_f32 v[104:105], v[10:11], v[10:11] op_sel:[0,0] op_sel_hi:[0,0]
    buffer_load_dwordx4 v[140:143], v1, s[8:11], s64 offen offset:3072 sc1
    v_mfma_f32_32x32x16_bf16 v[80:95], a[116:119], v[164:167], v[80:95]
    v_mfma_f32_32x32x16_bf16 v[64:79], a[112:115], v[164:167], v[64:79]
    v_pk_mul_f32 v[106:107], v[10:11], v[10:11] op_sel:[0,0] op_sel_hi:[0,0]
    s_add_u32 s64, s45, 124928
    buffer_load_dwordx4 v[144:147], v1, s[8:11], s64 offen sc1
    s_waitcnt vmcnt(11)
    v_mfma_f32_32x32x16_bf16 v[80:95], a[192:195], v[168:171], v[80:95]
    v_mfma_f32_32x32x16_bf16 v[64:79], a[120:123], v[168:171], v[64:79]
    v_pk_mul_f32 v[108:109], v[10:11], v[10:11] op_sel:[0,0] op_sel_hi:[0,0]
    buffer_load_dwordx4 v[148:151], v1, s[8:11], s64 offen offset:1024 sc1
    s_waitcnt vmcnt(11)
    v_mfma_f32_32x32x16_bf16 v[80:95], a[200:203], v[172:175], v[80:95]
    v_mfma_f32_32x32x16_bf16 v[64:79], a[196:199], v[172:175], v[64:79]
    v_pk_mul_f32 v[110:111], v[10:11], v[10:11] op_sel:[0,0] op_sel_hi:[0,0]
    buffer_load_dwordx4 v[152:155], v1, s[8:11], s64 offen offset:2048 sc1
    s_waitcnt vmcnt(11)
    v_mfma_f32_32x32x16_bf16 v[80:95], a[60:63], v[176:179], v[80:95]
    v_mfma_f32_32x32x16_bf16 v[64:79], a[188:191], v[176:179], v[64:79]
    buffer_load_dword v63, v9, s[8:11], s37 offen sc1
    buffer_load_dwordx4 v[156:159], v1, s[8:11], s64 offen offset:3072 sc1
    s_waitcnt vmcnt(12)
    v_mfma_f32_32x32x16_bf16 v[80:95], a[208:211], v[180:183], v[80:95]
    v_mfma_f32_32x32x16_bf16 v[64:79], a[204:207], v[180:183], v[64:79]
    s_add_u32 s64, s45, 132096
    buffer_load_dwordx4 v[160:163], v1, s[8:11], s64 offen sc1
    s_waitcnt vmcnt(12)
    v_mfma_f32_32x32x16_bf16 v[80:95], a[216:219], v[184:187], v[80:95]
    v_mfma_f32_32x32x16_bf16 v[64:79], a[212:215], v[184:187], v[64:79]
    buffer_load_dwordx4 v[164:167], v1, s[8:11], s64 offen offset:1024 sc1
    s_waitcnt vmcnt(12)
    v_mfma_f32_32x32x16_bf16 v[80:95], a[124:127], v[188:191], v[80:95]
    v_mfma_f32_32x32x16_bf16 v[64:79], a[220:223], v[188:191], v[64:79]
    buffer_load_dwordx4 v[168:171], v1, s[8:11], s64 offen offset:2048 sc1
    s_waitcnt vmcnt(11)
    v_mfma_f32_32x32x16_bf16 v[112:127], a[28:31], v[128:131], 0
    v_mfma_f32_32x32x16_bf16 v[96:111], a[24:27], v[128:131], v[96:111]
    buffer_load_dwordx4 v[172:175], v1, s[8:11], s64 offen offset:3072 sc1
    s_waitcnt vmcnt(11)
    v_mfma_f32_32x32x16_bf16 v[112:127], a[68:71], v[132:135], v[112:127]
    v_mfma_f32_32x32x16_bf16 v[96:111], a[64:67], v[132:135], v[96:111]
    s_add_u32 s64, s45, 139264
    buffer_load_dwordx4 v[176:179], v1, s[8:11], s64 offen sc1
    s_waitcnt vmcnt(11)
    v_mfma_f32_32x32x16_bf16 v[112:127], a[76:79], v[136:139], v[112:127]
    v_mfma_f32_32x32x16_bf16 v[96:111], a[72:75], v[136:139], v[96:111]
    buffer_load_dwordx4 v[180:183], v1, s[8:11], s64 offen offset:1024 sc1
    s_waitcnt vmcnt(11)
    v_mfma_f32_32x32x16_bf16 v[112:127], a[84:87], v[140:143], v[112:127]
    v_mfma_f32_32x32x16_bf16 v[96:111], a[80:83], v[140:143], v[96:111]
    s_waitcnt vmcnt(7)
    v_cmp_gt_u32 vcc, 12, v63
    s_cbranch_vccz OK_102
    s_mov_b32 s62, 0
    SP_103:
    buffer_load_dword v63, v9, s[8:11], s37 offen sc1
    s_add_u32 s62, s62, 1
    s_cmp_gt_u32 s62, 0x200000
    s_cbranch_scc1 L_fail
    s_waitcnt vmcnt(0)
    v_cmp_gt_u32 vcc, 12, v63
    s_cbranch_vccnz SP_103
    OK_102:
    s_add_u32 s64, s45, 0
    buffer_load_dwordx4 v[184:187], v1, s[8:11], s64 offen sc1
    v_mfma_f32_32x32x16_bf16 v[112:127], a[128:131], v[144:147], v[112:127]
    v_mfma_f32_32x32x16_bf16 v[96:111], a[56:59], v[144:147], v[96:111]
    buffer_load_dwordx4 v[188:191], v1, s[8:11], s64 offen offset:1024 sc1
    v_mfma_f32_32x32x16_bf16 v[112:127], a[92:95], v[148:151], v[112:127]
    v_mfma_f32_32x32x16_bf16 v[96:111], a[88:91], v[148:151], v[96:111]
    buffer_load_dwordx4 v[128:131], v1, s[8:11], s64 offen offset:2048 sc1
    v_mfma_f32_32x32x16_bf16 v[112:127], a[100:103], v[152:155], v[112:127]
    v_mfma_f32_32x32x16_bf16 v[96:111], a[96:99], v[152:155], v[96:111]
    s_xor_b32 s56, s28, 1
    s_mul_i32 s56, s56, 6144
    s_add_u32 s56, s56, 135168
    v_add_u32 v16, s56, v1
    s_add_u32 s64, s45, 7168
    buffer_load_dwordx4 v[132:135], v1, s[8:11], s64 offen sc1
    s_waitcnt vmcnt(10)
    v_mfma_f32_32x32x16_bf16 v[112:127], a[108:111], v[156:159], v[112:127]
    v_mfma_f32_32x32x16_bf16 v[96:111], a[104:107], v[156:159], v[96:111]
    s_xor_b32 s56, s28, 2
    s_mul_i32 s56, s56, 6144
    s_add_u32 s56, s56, 137216
    v_add_u32 v17, s56, v1
    buffer_load_dwordx4 v[136:139], v1, s[8:11], s64 offen offset:1024 sc1
    s_waitcnt vmcnt(10)
    v_mfma_f32_32x32x16_bf16 v[112:127], a[160:163], v[160:163], v[112:127]
    v_mfma_f32_32x32x16_bf16 v[96:111], a[156:159], v[160:163], v[96:111]
    s_xor_b32 s56, s28, 3
    s_mul_i32 s56, s56, 6144
    s_add_u32 s56, s56, 139264
    v_add_u32 v18, s56, v1
    buffer_load_dwordx4 v[140:143], v1, s[8:11], s64 offen offset:2048 sc1
    s_waitcnt vmcnt(10)
    v_mfma_f32_32x32x16_bf16 v[112:127], a[116:119], v[164:167], v[112:127]
    v_mfma_f32_32x32x16_bf16 v[96:111], a[112:115], v[164:167], v[96:111]
    s_mul_i32 s56, s28, 6144
    s_add_u32 s56, s56, 135168
    v_add_u32 v19, s56, v1
    s_add_u32 s64, s45, 14336
    buffer_load_dwordx4 v[144:147], v1, s[8:11], s64 offen sc1
    s_waitcnt vmcnt(10)
    v_mfma_f32_32x32x16_bf16 v[112:127], a[192:195], v[168:171], v[112:127]
    v_mfma_f32_32x32x16_bf16 v[96:111], a[120:123], v[168:171], v[96:111]
    v_and_b32 v13, 0x1f0, v1
    buffer_load_dwordx4 v[148:151], v1, s[8:11], s64 offen offset:1024 sc1
    s_waitcnt vmcnt(10)
    v_mfma_f32_32x32x16_bf16 v[112:127], a[200:203], v[172:175], v[112:127]
    v_mfma_f32_32x32x16_bf16 v[96:111], a[196:199], v[172:175], v[96:111]
    v_lshlrev_b32 v13, 6, v13
    buffer_load_dwordx4 v[152:155], v1, s[8:11], s64 offen offset:2048 sc1
    s_waitcnt vmcnt(10)
    v_mfma_f32_32x32x16_bf16 v[112:127], a[60:63], v[176:179], v[112:127]
    v_mfma_f32_32x32x16_bf16 v[96:111], a[188:191], v[176:179], v[96:111]
    v_lshrrev_b32 v12, 9, v1
    s_add_u32 s64, s45, 21504
    buffer_load_dwordx4 v[156:159], v1, s[8:11], s64 offen sc1
    s_waitcnt vmcnt(10)
    v_mfma_f32_32x32x16_bf16 v[112:127], a[208:211], v[180:183], v[112:127]
    v_mfma_f32_32x32x16_bf16 v[96:111], a[204:207], v[180:183], v[96:111]
    v_lshl_add_u32 v12, v12, 4, v13
    buffer_load_dwordx4 v[160:163], v1, s[8:11], s64 offen offset:1024 sc1
    s_waitcnt vmcnt(10)
    v_mfma_f32_32x32x16_bf16 v[80:95], a[4:7], v[184:187], v[80:95]
    v_mfma_f32_32x32x16_bf16 v[64:79], a[0:3], v[184:187], v[64:79]
    buffer_load_dwordx4 v[164:167], v1, s[8:11], s64 offen offset:2048 sc1
    s_waitcnt vmcnt(10)
    v_mfma_f32_32x32x16_bf16 v[80:95], a[12:15], v[188:191], v[80:95]
    v_mfma_f32_32x32x16_bf16 v[64:79], a[8:11], v[188:191], v[64:79]
    s_add_u32 s64, s45, 141312
    buffer_load_dwordx4 v[168:171], v1, s[8:11], s64 offen sc1
    s_waitcnt vmcnt(10)
    v_mfma_f32_32x32x16_bf16 v[80:95], a[20:23], v[128:131], v[80:95]
    v_mfma_f32_32x32x16_bf16 v[64:79], a[16:19], v[128:131], v[64:79]
    buffer_load_dwordx4 v[172:175], v1, s[8:11], s64 offen offset:1024 sc1
    s_waitcnt vmcnt(10)
    v_mfma_f32_32x32x16_bf16 v[80:95], a[36:39], v[132:135], v[80:95]
    v_mfma_f32_32x32x16_bf16 v[64:79], a[32:35], v[132:135], v[64:79]
    s_add_u32 s64, s45, 114688
    buffer_load_dwordx4 v[176:179], v1, s[8:11], s64 offen sc1
    s_waitcnt vmcnt(10)
    v_mfma_f32_32x32x16_bf16 v[80:95], a[44:47], v[136:139], v[80:95]
    v_mfma_f32_32x32x16_bf16 v[64:79], a[40:43], v[136:139], v[64:79]
    buffer_load_dwordx4 v[180:183], v1, s[8:11], s64 offen offset:1024 sc1
    s_waitcnt vmcnt(10)
    v_mfma_f32_32x32x16_bf16 v[80:95], a[52:55], v[140:143], v[80:95]
    v_mfma_f32_32x32x16_bf16 v[64:79], a[48:51], v[140:143], v[64:79]
    buffer_load_dwordx4 v[184:187], v1, s[8:11], s64 offen offset:2048 sc1
    s_waitcnt vmcnt(10)
    v_mfma_f32_32x32x16_bf16 v[80:95], a[136:139], v[144:147], v[80:95]
    v_mfma_f32_32x32x16_bf16 v[64:79], a[132:135], v[144:147], v[64:79]
    s_add_u32 s64, s45, 121856
    buffer_load_dwordx4 v[188:191], v1, s[8:11], s64 offen sc1
    s_waitcnt vmcnt(10)
    v_mfma_f32_32x32x16_bf16 v[80:95], a[144:147], v[148:151], v[80:95]
    v_mfma_f32_32x32x16_bf16 v[64:79], a[140:143], v[148:151], v[64:79]
    buffer_load_dwordx4 v[128:131], v1, s[8:11], s64 offen offset:1024 sc1
    s_waitcnt vmcnt(10)
    v_mfma_f32_32x32x16_bf16 v[80:95], a[152:155], v[152:155], v[80:95]
    v_mfma_f32_32x32x16_bf16 v[64:79], a[148:151], v[152:155], v[64:79]
    buffer_load_dwordx4 v[132:135], v1, s[8:11], s64 offen offset:2048 sc1
    s_waitcnt vmcnt(10)
    v_mfma_f32_32x32x16_bf16 v[80:95], a[168:171], v[156:159], v[80:95]
    v_mfma_f32_32x32x16_bf16 v[64:79], a[164:167], v[156:159], v[64:79]
    s_add_u32 s64, s45, 129024
    buffer_load_dwordx4 v[136:139], v1, s[8:11], s64 offen sc1
    s_waitcnt vmcnt(10)
    v_mfma_f32_32x32x16_bf16 v[80:95], a[176:179], v[160:163], v[80:95]
    v_mfma_f32_32x32x16_bf16 v[64:79], a[172:175], v[160:163], v[64:79]
    buffer_load_dwordx4 v[140:143], v1, s[8:11], s64 offen offset:1024 sc1
    s_waitcnt vmcnt(10)
    v_mfma_f32_32x32x16_bf16 v[80:95], a[184:187], v[164:167], v[80:95]
    v_mfma_f32_32x32x16_bf16 v[64:79], a[180:183], v[164:167], v[64:79]
    buffer_load_dwordx4 v[144:147], v1, s[8:11], s64 offen offset:2048 sc1
    s_waitcnt vmcnt(10)
    v_mfma_f32_32x32x16_bf16 v[112:127], a[216:219], v[168:171], v[112:127]
    v_mfma_f32_32x32x16_bf16 v[96:111], a[212:215], v[168:171], v[96:111]
    s_add_u32 s64, s45, 136192
    buffer_load_dwordx4 v[148:151], v1, s[8:11], s64 offen sc1
    s_waitcnt vmcnt(10)
    v_mfma_f32_32x32x16_bf16 v[112:127], a[124:127], v[172:175], v[112:127]
    s_nop 2
    ds_write_b128 v17, v[80:83] offset:0
    v_mfma_f32_32x32x16_bf16 v[96:111], a[220:223], v[172:175], v[96:111]
    buffer_load_dwordx4 v[152:155], v1, s[8:11], s64 offen offset:1024 sc1
    s_waitcnt vmcnt(10)
    v_mfma_f32_32x32x16_bf16 v[112:127], a[4:7], v[176:179], v[112:127]
    ds_write_b128 v17, v[84:87] offset:1024
    v_mfma_f32_32x32x16_bf16 v[96:111], a[0:3], v[176:179], v[96:111]
    buffer_load_dwordx4 v[156:159], v1, s[8:11], s64 offen offset:2048 sc1
    s_waitcnt vmcnt(10)
    v_mfma_f32_32x32x16_bf16 v[112:127], a[12:15], v[180:183], v[112:127]
    ds_write_b128 v18, v[88:91] offset:0
    v_mfma_f32_32x32x16_bf16 v[96:111], a[8:11], v[180:183], v[96:111]
    s_waitcnt vmcnt(9)
    v_mfma_f32_32x32x16_bf16 v[112:127], a[20:23], v[184:187], v[112:127]
    ds_write_b128 v18, v[92:95] offset:1024
    v_mfma_f32_32x32x16_bf16 v[96:111], a[16:19], v[184:187], v[96:111]
    s_waitcnt vmcnt(8)
    v_mfma_f32_32x32x16_bf16 v[112:127], a[36:39], v[188:191], v[112:127]
    ds_write_b128 v16, v[72:75] offset:0
    v_mfma_f32_32x32x16_bf16 v[96:111], a[32:35], v[188:191], v[96:111]
    s_waitcnt vmcnt(7)
    v_mfma_f32_32x32x16_bf16 v[112:127], a[44:47], v[128:131], v[112:127]
    ds_write_b128 v16, v[76:79] offset:1024
    v_mfma_f32_32x32x16_bf16 v[96:111], a[40:43], v[128:131], v[96:111]
    s_waitcnt vmcnt(6)
    v_mfma_f32_32x32x16_bf16 v[112:127], a[52:55], v[132:135], v[112:127]
    v_mfma_f32_32x32x16_bf16 v[96:111], a[48:51], v[132:135], v[96:111]
    s_waitcnt vmcnt(5)
    v_mfma_f32_32x32x16_bf16 v[112:127], a[136:139], v[136:139], v[112:127]
    s_waitcnt lgkmcnt(0)
    s_barrier
    v_mfma_f32_32x32x16_bf16 v[96:111], a[132:135], v[136:139], v[96:111]
    ds_read_b128 v[20:23], v19 offset:0
    ds_read_b128 v[24:27], v19 offset:1024
    s_waitcnt vmcnt(4)
    v_mfma_f32_32x32x16_bf16 v[112:127], a[144:147], v[140:143], v[112:127]
    ds_read_b128 v[28:31], v19 offset:2048
    ds_read_b128 v[32:35], v19 offset:3072
    v_mfma_f32_32x32x16_bf16 v[96:111], a[140:143], v[140:143], v[96:111]
    ds_read_b128 v[36:39], v19 offset:4096
    ds_read_b128 v[40:43], v19 offset:5120
    s_waitcnt vmcnt(3)
    v_mfma_f32_32x32x16_bf16 v[112:127], a[152:155], v[144:147], v[112:127]
    v_mfma_f32_32x32x16_bf16 v[96:111], a[148:151], v[144:147], v[96:111]
    s_waitcnt vmcnt(2)
    v_mfma_f32_32x32x16_bf16 v[112:127], a[168:171], v[148:151], v[112:127]
    s_waitcnt lgkmcnt(0)
    s_barrier
    v_mfma_f32_32x32x16_bf16 v[96:111], a[164:167], v[148:151], v[96:111]
    v_pk_add_f32 v[64:65], v[64:65], v[20:21] op_sel:[0,0] op_sel_hi:[1,1]
    v_pk_add_f32 v[66:67], v[66:67], v[22:23] op_sel:[0,0] op_sel_hi:[1,1]
    v_pk_add_f32 v[68:69], v[68:69], v[24:25] op_sel:[0,0] op_sel_hi:[1,1]
    v_pk_add_f32 v[70:71], v[70:71], v[26:27] op_sel:[0,0] op_sel_hi:[1,1]
    s_waitcnt vmcnt(1)
    v_mfma_f32_32x32x16_bf16 v[112:127], a[176:179], v[152:155], v[112:127]
    v_pk_add_f32 v[64:65], v[64:65], v[28:29] op_sel:[0,0] op_sel_hi:[1,1]
    v_pk_add_f32 v[66:67], v[66:67], v[30:31] op_sel:[0,0] op_sel_hi:[1,1]
    v_pk_add_f32 v[68:69], v[68:69], v[32:33] op_sel:[0,0] op_sel_hi:[1,1]
    v_pk_add_f32 v[70:71], v[70:71], v[34:35] op_sel:[0,0] op_sel_hi:[1,1]
    v_mfma_f32_32x32x16_bf16 v[96:111], a[172:175], v[152:155], v[96:111]
    v_pk_add_f32 v[64:65], v[64:65], v[36:37] op_sel:[0,0] op_sel_hi:[1,1]
    v_pk_add_f32 v[66:67], v[66:67], v[38:39] op_sel:[0,0] op_sel_hi:[1,1]
    v_pk_add_f32 v[68:69], v[68:69], v[40:41] op_sel:[0,0] op_sel_hi:[1,1]
    v_pk_add_f32 v[70:71], v[70:71], v[42:43] op_sel:[0,0] op_sel_hi:[1,1]
    s_waitcnt vmcnt(0)
    v_mfma_f32_32x32x16_bf16 v[112:127], a[184:187], v[156:159], v[112:127]
    v_cvt_pk_bf16_f32 v44, v64, v65
    v_cvt_pk_bf16_f32 v45, v66, v67
    v_cvt_pk_bf16_f32 v46, v68, v69
    v_cvt_pk_bf16_f32 v47, v70, v71
    v_mfma_f32_32x32x16_bf16 v[96:111], a[180:183], v[156:159], v[96:111]
    v_permlane32_swap_b32 v44, v46
    v_permlane32_swap_b32 v45, v47
    s_add_u32 s65, s72, 0
    buffer_store_dwordx4 v[44:47], v12, s[68:71], s65 offen
    s_nop 2
    ds_write_b128 v17, v[112:115] offset:0
    ds_write_b128 v17, v[116:119] offset:1024
    ds_write_b128 v18, v[120:123] offset:0
    ds_write_b128 v18, v[124:127] offset:1024
    s_nop 0
    ds_write_b128 v16, v[104:107] offset:0
    ds_write_b128 v16, v[108:111] offset:1024
    s_waitcnt lgkmcnt(0)
    s_barrier
    ds_read_b128 v[20:23], v19 offset:0
    ds_read_b128 v[24:27], v19 offset:1024
    ds_read_b128 v[28:31], v19 offset:2048
    ds_read_b128 v[32:35], v19 offset:3072
    ds_read_b128 v[36:39], v19 offset:4096
    ds_read_b128 v[40:43], v19 offset:5120
    s_waitcnt lgkmcnt(5)
    v_pk_add_f32 v[96:97], v[96:97], v[20:21] op_sel:[0,0] op_sel_hi:[1,1]
    v_pk_add_f32 v[98:99], v[98:99], v[22:23] op_sel:[0,0] op_sel_hi:[1,1]
    s_waitcnt lgkmcnt(4)
    v_pk_add_f32 v[100:101], v[100:101], v[24:25] op_sel:[0,0] op_sel_hi:[1,1]
    v_pk_add_f32 v[102:103], v[102:103], v[26:27] op_sel:[0,0] op_sel_hi:[1,1]
    s_waitcnt lgkmcnt(3)
    v_pk_add_f32 v[96:97], v[96:97], v[28:29] op_sel:[0,0] op_sel_hi:[1,1]
    v_pk_add_f32 v[98:99], v[98:99], v[30:31] op_sel:[0,0] op_sel_hi:[1,1]
    s_waitcnt lgkmcnt(2)
    v_pk_add_f32 v[100:101], v[100:101], v[32:33] op_sel:[0,0] op_sel_hi:[1,1]
    v_pk_add_f32 v[102:103], v[102:103], v[34:35] op_sel:[0,0] op_sel_hi:[1,1]
    s_waitcnt lgkmcnt(1)
    v_pk_add_f32 v[96:97], v[96:97], v[36:37] op_sel:[0,0] op_sel_hi:[1,1]
    v_pk_add_f32 v[98:99], v[98:99], v[38:39] op_sel:[0,0] op_sel_hi:[1,1]
    s_waitcnt lgkmcnt(0)
    v_pk_add_f32 v[100:101], v[100:101], v[40:41] op_sel:[0,0] op_sel_hi:[1,1]
    v_pk_add_f32 v[102:103], v[102:103], v[42:43] op_sel:[0,0] op_sel_hi:[1,1]
    v_cvt_pk_bf16_f32 v44, v96, v97
    v_cvt_pk_bf16_f32 v45, v98, v99
    v_cvt_pk_bf16_f32 v46, v100, v101
    v_cvt_pk_bf16_f32 v47, v102, v103
    s_nop 0
    v_permlane32_swap_b32 v44, v46
    v_permlane32_swap_b32 v45, v47
    s_add_u32 s65, s72, 32768
    buffer_store_dwordx4 v[44:47], v12, s[68:71], s65 offen
    s_or_b32 s56, s2, s28
    s_cmp_eq_u32 s56, 0
    s_cbranch_scc0 SK_104
    s_add_u32 s56, s33, 1
    v_mov_b32 v14, s56
    s_mov_b64 exec, 1
    buffer_store_dword v14, v10, s[8:11], 0 offen
    s_mov_b64 exec, -1
SK_104:
L_fail:
L_end:
    s_endpgm
WT_14:
    s_nop 4
    buffer_store_dwordx4 v[40:43], v1, s[8:11], s42 offen sc1
    s_branch RT_15
WT_16:
    s_nop 4
    buffer_store_dwordx4 v[44:47], v1, s[8:11], s42 offen offset:1024 sc1
    s_branch RT_17
WT_18:
    s_nop 4
    buffer_store_dword v62, v10, s[8:11], s38 offen sc1
    s_branch RT_19
WT_21:
    s_nop 4
    buffer_store_dwordx4 v[44:47], v1, s[8:11], s65 offen sc1
    s_branch RT_22
WT_23:
    s_nop 4
    buffer_store_dwordx4 v[44:47], v1, s[8:11], s65 offen sc1
    s_branch RT_24
WT_25:
    s_nop 4
    buffer_store_dword v62, v10, s[8:11], s38 offen sc1
    s_branch RT_26
WT_27:
    s_nop 4
    buffer_store_dword v48, v1, s[8:11], s65 offen sc1
    s_branch RT_28
WT_29:
    s_nop 4
    buffer_store_dword v52, v1, s[8:11], s65 offen sc1
    s_branch RT_30
WT_31:
    s_nop 4
    buffer_store_dword v62, v10, s[8:11], s38 offen sc1
    s_branch RT_32
WT_33:
    s_nop 4
    buffer_store_dword v62, v10, s[8:11], s38 offen sc1
    s_branch RT_34
WT_42:
    s_nop 4
    buffer_store_dword v62, v10, s[8:11], s38 offen sc1
    s_branch RT_43
WT_44:
    s_nop 4
    buffer_store_dwordx4 v[44:47], v1, s[8:11], s65 offen sc1
    s_branch RT_45
WT_48:
    s_nop 4
    buffer_store_dwordx4 v[44:47], v1, s[8:11], s65 offen sc1
    s_branch RT_49
WT_50:
    s_nop 4
    buffer_store_dword v62, v10, s[8:11], s38 offen sc1
    s_branch RT_51
WT_52:
    s_nop 4
    buffer_store_dword v48, v1, s[8:11], s65 offen sc1
    s_branch RT_53
WT_54:
    s_nop 4
    buffer_store_dword v52, v1, s[8:11], s65 offen sc1
    s_branch RT_55
WT_56:
    s_nop 4
    buffer_store_dword v62, v10, s[8:11], s38 offen sc1
    s_branch RT_57
WT_72:
    s_nop 4
    buffer_store_dwordx4 v[40:43], v1, s[8:11], s42 offen sc1
    s_branch RT_73
WT_74:
    s_nop 4
    buffer_store_dwordx4 v[44:47], v1, s[8:11], s42 offen offset:1024 sc1
    s_branch RT_75
WT_76:
    s_nop 4
    buffer_store_dword v62, v10, s[8:11], s38 offen sc1
    s_branch RT_77
WT_79:
    s_nop 4
    buffer_store_dwordx4 v[44:47], v1, s[8:11], s65 offen sc1
    s_branch RT_80
WT_81:
    s_nop 4
    buffer_store_dwordx4 v[44:47], v1, s[8:11], s65 offen sc1
    s_branch RT_82
WT_83:
    s_nop 4
    buffer_store_dword v62, v10, s[8:11], s38 offen sc1
    s_branch RT_84
WT_85:
    s_nop 4
    buffer_store_dword v48, v1, s[8:11], s65 offen sc1
    s_branch RT_86
WT_87:
    s_nop 4
    buffer_store_dword v52, v1, s[8:11], s65 offen sc1
    s_branch RT_88
WT_89:
    s_nop 4
    buffer_store_dword v62, v10, s[8:11], s38 offen sc1
    s_branch RT_90
WT_91:
    s_nop 4
    buffer_store_dword v62, v10, s[8:11], s38 offen sc1
    s_branch RT_92
WT_98:
    s_nop 4
    buffer_store_dwordx4 v[40:43], v1, s[8:11], s65 offen sc1
    s_branch RT_99
WT_100:
    s_nop 4
    buffer_store_dword v62, v10, s[8:11], s38 offen sc1
    s_branch RT_101

.section .rodata,"a"
.p2align 6
.amdhsa_kernel interleave_layers__linear_kernel_hedgehog__glu_gated_glu__prompt_kernel
  .amdhsa_next_free_vgpr 512
  .amdhsa_next_free_sgpr 102
  .amdhsa_accum_offset 256
  .amdhsa_group_segment_fixed_size 0
  .amdhsa_kernarg_size 88
  .amdhsa_user_sgpr_count 2
  .amdhsa_user_sgpr_kernarg_segment_ptr 1
  .amdhsa_system_sgpr_workgroup_id_x 1
  .amdhsa_float_denorm_mode_32 3
.end_amdhsa_kernel
```
